```python
import torch

def _softmax(x, axis=-1):
    return torch.softmax(x, dim=axis)
def _gelu(x):
    return torch.nn.functional.gelu(x, approximate="tanh")
def _silu(x):
    return torch.nn.functional.silu(x)
def _sigmoid(x):
    return torch.sigmoid(x)
def _layernorm(x, axis=-1, eps=1e-5):
    m = x.mean(dim=axis, keepdim=True)
    v = x.var(dim=axis, keepdim=True, unbiased=False)
    return (x - m) / torch.sqrt(v + eps)
def _scatter_add(tgt, idx, src, axis=0):
    return tgt.clone().index_add_(axis, idx, src)
def _segment_sum(src, seg, n):
    out = torch.zeros((n,) + src.shape[1:], dtype=src.dtype)
    return out.index_add_(0, seg, src)
def _pad(x, pw):
    flat = tuple(v for pair in reversed(pw) for v in pair)
    return torch.nn.functional.pad(x, flat)

kernel_name = 'parallel_sum__grouped_kv_mqa__glu_gated_reglu__prompt'

def setup_inputs():

    _w = (lambda a: (lambda t: t.to(torch.bfloat16) if t.is_floating_point() else t)(torch.as_tensor(a)))
    def _A_setup():
        B, S, D, H = 1, 2048, 1024, 32
        Dh = D // H
        return {
            "x": _w((lambda *s: torch.randn(*s, dtype=torch.bfloat16) * 0.05)(B, S, D)),
            "wq": _w((lambda *s: torch.randn(*s, dtype=torch.bfloat16) * 0.05)(D, H * Dh)),
            "wk": _w((lambda *s: torch.randn(*s, dtype=torch.bfloat16) * 0.05)(D, Dh)),
            "wv": _w((lambda *s: torch.randn(*s, dtype=torch.bfloat16) * 0.05)(D, Dh)),
            "wo": _w((lambda *s: torch.randn(*s, dtype=torch.bfloat16) * 0.05)(H * Dh, D)),
        }
    _A_in = _A_setup()

    def _B_setup():
        B, S, D, F = 1, 2048, 1024, 3584
        return {
            "x": _w((lambda *s: torch.randn(*s, dtype=torch.bfloat16) * 0.05)(B, S, D)),
            "W_gate": _w((lambda *s: torch.randn(*s, dtype=torch.bfloat16) * 0.8)(D, F) * (2.0 / D) ** 0.5),
            "W_up": _w((lambda *s: torch.randn(*s, dtype=torch.bfloat16) * 0.8)(D, F) * (2.0 / D) ** 0.5),
            "W_down": _w((lambda *s: torch.randn(*s, dtype=torch.bfloat16) * 0.8)(F, D) * (1.0 / F) ** 0.5),
        }
    _B_in = _B_setup()

    return {
        "A_x": _A_in["x"],
        "A_wq": _A_in["wq"],
        "A_wk": _A_in["wk"],
        "A_wv": _A_in["wv"],
        "A_wo": _A_in["wo"],
        "B_x": _B_in["x"],
        "B_W_gate": _B_in["W_gate"],
        "B_W_up": _B_in["W_up"],
        "B_W_down": _B_in["W_down"],
    }

def reference(A_x, A_wq, A_wk, A_wv, A_wo, B_x, B_W_gate, B_W_up, B_W_down):
    def _A_ref(x, wq, wk, wv, wo):
        B, S, D = x.shape
        H = 32
        Dh = D // H
        q = (lambda x, *d: x.permute(*d))((x @ wq).reshape(B, S, H, Dh), 0, 2, 1, 3)
        k = x @ wk
        v = x @ wv
        scores = torch.einsum("bhqd,bkd->bhqk", q, k) * (Dh ** -0.5)
        p = _softmax(scores, axis=-1)
        o = torch.einsum("bhqk,bkd->bhqd", p, v)
        return (lambda x, *d: x.permute(*d))(o, 0, 2, 1, 3).reshape(B, S, H * Dh) @ wo

    def _B_ref(x, W_gate, W_up, W_down):
        gate = torch.einsum("bsd,df->bsf", x, W_gate)
        up = torch.einsum("bsd,df->bsf", x, W_up)
        gate = gate * (lambda x, dt: x.to(dt))(gate > 0, gate.dtype)
        h = gate * up
        return torch.einsum("bsf,fd->bsd", h, W_down)

    x = A_x
    xn = _layernorm(x, axis=-1)
    return x + _A_ref(xn, A_wq, A_wk, A_wv, A_wo) + _B_ref(xn, B_W_gate, B_W_up, B_W_down)
```

```asm
; @launch grid=(256,1,1) block=(512,1,1) lds=163840
.amdgcn_target "amdgcn-amd-amdhsa--gfx950"
.text
.globl parallel_sum__grouped_kv_mqa__glu_gated_reglu__prompt_kernel
.p2align 8
.type parallel_sum__grouped_kv_mqa__glu_gated_reglu__prompt_kernel,@function
parallel_sum__grouped_kv_mqa__glu_gated_reglu__prompt_kernel:
  s_cmp_ge_u32 s2, 256
  s_cbranch_scc1 F_END
  s_load_dwordx8 s[4:11], s[0:1], 0
  s_load_dwordx4 s[40:43], s[0:1], 48
  s_load_dwordx4 s[12:15], s[0:1], 80
  s_memrealtime s[48:49]
  v_lshrrev_b32 v2, 6, v0
  v_and_b32 v1, 63, v0
  v_readfirstlane_b32 s20, v2
  v_lshlrev_b32 v3, 4, v1
  s_lshr_b32 s21, s2, 4
  s_lshl_b32 s21, s21, 3
  s_and_b32 s16, s2, 7
  s_add_u32 s45, s21, s16
  s_lshl_b32 s23, s45, 15
  s_mov_b32 s54, s20
  s_lshl_b32 s16, s20, 12
  s_add_u32 s19, s23, s16
  s_waitcnt lgkmcnt(0)
  s_mov_b32 s32, s14
  s_mov_b32 s33, s15
  s_mov_b32 s34, 0x4000000
  s_mov_b32 s35, 0x20000
  s_mov_b32 s56, s12
  s_mov_b32 s57, s13
  s_mov_b32 s58, 0x100
  s_mov_b32 s59, 0x20000
  s_or_b32 s16, s2, s20
  s_cmp_lg_u32 s16, 0
  s_cbranch_scc1 F_NT
  s_or_b32 s16, s48, 1
  v_mov_b32 v2, s16
  v_mov_b32 v8, 0
  s_mov_b64 exec, 1
  buffer_store_dword v2, v8, s[56:59], 0 offen sc1
  s_mov_b64 exec, -1
F_NT:
  s_mov_b32 s24, s4
  s_mov_b32 s25, s5
  s_mov_b32 s26, 0x400000
  s_mov_b32 s27, 0x20000
  buffer_load_dwordx4 v[8:11], v3, s[24:27], s19 offen offset:0
  buffer_load_dwordx4 v[12:15], v3, s[24:27], s19 offen offset:1024
  buffer_load_dwordx4 v[16:19], v3, s[24:27], s19 offen offset:2048
  buffer_load_dwordx4 v[20:23], v3, s[24:27], s19 offen offset:3072
  v_mov_b32 v7, 0
  buffer_load_dword v6, v7, s[56:59], 0 offen sc1
  s_cmp_eq_u32 s20, 0
  s_cselect_b64 s[12:13], s[40:41], s[42:43]
  s_mov_b32 s16, 4480
  s_cmp_eq_u32 s20, 2
  s_cselect_b64 s[12:13], s[6:7], s[12:13]
  s_cselect_b32 s16, 1280, s16
  s_mov_b32 s88, s12
  s_mov_b32 s89, s13
  s_mov_b32 s90, 0x200000
  s_mov_b32 s91, 0x20000
  v_lshlrev_b32 v114, 7, v1
  s_sub_u32 s17, s16, 128
  v_min_u32 v114, s17, v114
  s_mul_i32 s92, s16, s2
  s_cmp_lg_u32 s20, 3
  s_cbranch_scc1 P0_N7
  s_bitcmp1_b32 s2, 3
  s_cselect_b64 s[88:89], s[10:11], s[8:9]
  s_mov_b32 s90, 0x10000
  v_and_b32 v114, 0xf80, v114
  s_lshr_b32 s92, s2, 4
  s_lshl_b32 s92, s92, 12
P0_N7:
  s_bfe_u32 s22, s2, 0x10003
  s_cmp_eq_u32 s22, 0
  s_cselect_b64 s[12:13], s[8:9], s[10:11]
  s_mov_b32 s28, s12
  s_mov_b32 s29, s13
  s_mov_b32 s30, 0x10000
  s_mov_b32 s31, 0x20000
  s_lshl_b32 s17, s20, 13
  s_and_b32 s16, s2, 7
  s_lshl_b32 s16, s16, 2
  s_bfe_u32 s21, s2, 0x20003
  s_add_u32 s21, s21, s16
  s_and_b32 s23, s20, 3
  s_cmp_lt_u32 s20, 4
  s_cselect_b64 s[12:13], s[42:43], s[40:41]
  s_cselect_b32 s18, 32, 0
  s_cselect_b32 s46, 8192, 0
  s_lshl_b32 s16, s23, 11
  s_add_u32 s46, s46, s16
  s_add_u32 s46, s46, 16384
  v_lshrrev_b32 v2, 4, v1
  s_lshl_b32 s16, s23, 3
  v_add_u32 v4, s16, v2
  s_and_b32 s16, s23, 1
  s_lshl_b32 s16, s16, 2
  v_add_u32 v2, s16, v2
  v_bfe_u32 v5, v1, 1, 3
  v_xor_b32 v2, v2, v5
  v_cmp_eq_u32 vcc, 7, v2
  v_mov_b32 v5, 7168
  v_mov_b32 v112, 2048
  v_cndmask_b32 v120, v5, v112, vcc
  v_mul_lo_u32 v4, v4, v120
  s_mul_i32 s16, s21, 224
  v_lshl_add_u32 v5, v2, 5, s16
  s_lshl_b32 s16, s21, 6
  s_add_u32 s16, s16, s18
  v_mov_b32 v112, s16
  v_cndmask_b32 v5, v5, v112, vcc
  v_add_u32 v4, v4, v5
  v_and_b32 v2, 1, v1
  v_lshl_add_u32 v4, v2, 4, v4
  v_mov_b32 v5, s12
  v_mov_b32 v112, s6
  v_cndmask_b32 v116, v5, v112, vcc
  v_mov_b32 v5, s13
  v_mov_b32 v112, s7
  v_cndmask_b32 v117, v5, v112, vcc
  v_mov_b32 v5, 0
  v_lshl_add_u64 v[116:117], v[4:5], 0, v[116:117]
  v_lshlrev_b32 v4, 2, v120
  v_subrev_u32 v4, 1024, v4
  v_lshl_add_u64 v[118:119], v[4:5], 0, v[116:117]
  v_lshlrev_b32 v120, 5, v120
  v_mov_b32 v121, 0
  s_mov_b32 s47, 0
  s_mov_b32 s24, s12
  s_mov_b32 s25, s13
  s_mov_b32 s26, 0x700000
  s_mov_b32 s27, 0x20000
  s_mov_b32 s21, s45
  s_lshl_b32 s23, s21, 15
  s_mov_b32 s36, 0xffff0000
  s_waitcnt vmcnt(1)
  s_cmp_ge_u32 s20, 4
  s_cbranch_scc1 P0_NS
  buffer_load_dword v122, v114, s[88:91], s92 offen
P0_NS:
  v_lshlrev_b32 v32, 16, v8
  v_and_b32 v33, s36, v8
  v_lshlrev_b32 v34, 16, v9
  v_and_b32 v35, s36, v9
  v_lshlrev_b32 v36, 16, v10
  v_and_b32 v37, s36, v10
  v_lshlrev_b32 v38, 16, v11
  v_and_b32 v39, s36, v11
  v_lshlrev_b32 v40, 16, v12
  v_and_b32 v41, s36, v12
  v_lshlrev_b32 v42, 16, v13
  v_and_b32 v43, s36, v13
  v_lshlrev_b32 v44, 16, v14
  v_and_b32 v45, s36, v14
  v_lshlrev_b32 v46, 16, v15
  v_and_b32 v47, s36, v15
  v_lshlrev_b32 v48, 16, v16
  v_and_b32 v49, s36, v16
  v_lshlrev_b32 v50, 16, v17
  v_and_b32 v51, s36, v17
  v_lshlrev_b32 v52, 16, v18
  v_and_b32 v53, s36, v18
  v_lshlrev_b32 v54, 16, v19
  v_and_b32 v55, s36, v19
  v_lshlrev_b32 v56, 16, v20
  v_and_b32 v57, s36, v20
  v_lshlrev_b32 v58, 16, v21
  v_and_b32 v59, s36, v21
  v_lshlrev_b32 v60, 16, v22
  v_and_b32 v61, s36, v22
  v_lshlrev_b32 v62, 16, v23
  v_and_b32 v63, s36, v23
  v_add_f32 v64, v32, v33
  v_add_f32 v65, v34, v35
  v_add_f32 v66, v36, v37
  v_add_f32 v67, v38, v39
  v_add_f32 v68, v40, v41
  v_add_f32 v69, v42, v43
  v_add_f32 v70, v44, v45
  v_add_f32 v71, v46, v47
  v_add_f32 v72, v48, v49
  v_add_f32 v73, v50, v51
  v_add_f32 v74, v52, v53
  v_add_f32 v75, v54, v55
  v_add_f32 v76, v56, v57
  v_add_f32 v77, v58, v59
  v_add_f32 v78, v60, v61
  v_add_f32 v79, v62, v63
  v_add_f32 v64, v64, v68
  v_add_f32 v65, v65, v69
  v_add_f32 v66, v66, v70
  v_add_f32 v67, v67, v71
  v_add_f32 v72, v72, v76
  v_add_f32 v73, v73, v77
  v_add_f32 v74, v74, v78
  v_add_f32 v75, v75, v79
  v_add_f32 v64, v64, v66
  v_add_f32 v65, v65, v67
  v_add_f32 v72, v72, v74
  v_add_f32 v73, v73, v75
  v_add_f32 v24, v64, v65
  v_add_f32 v25, v72, v73
  s_nop 0
  v_add_f32_dpp v24, v24, v24 row_shr:1 row_mask:0xf bank_mask:0xf bound_ctrl:0
  v_add_f32_dpp v25, v25, v25 row_shr:1 row_mask:0xf bank_mask:0xf bound_ctrl:0
  s_nop 0
  v_add_f32_dpp v24, v24, v24 row_shr:2 row_mask:0xf bank_mask:0xf bound_ctrl:0
  v_add_f32_dpp v25, v25, v25 row_shr:2 row_mask:0xf bank_mask:0xf bound_ctrl:0
  s_nop 0
  v_add_f32_dpp v24, v24, v24 row_shr:4 row_mask:0xf bank_mask:0xf bound_ctrl:0
  v_add_f32_dpp v25, v25, v25 row_shr:4 row_mask:0xf bank_mask:0xf bound_ctrl:0
  s_nop 0
  v_add_f32_dpp v24, v24, v24 row_shr:8 row_mask:0xf bank_mask:0xf bound_ctrl:0
  v_add_f32_dpp v25, v25, v25 row_shr:8 row_mask:0xf bank_mask:0xf bound_ctrl:0
  s_nop 0
  v_add_f32_dpp v24, v24, v24 row_bcast:15 row_mask:0xa bank_mask:0xf
  v_add_f32_dpp v25, v25, v25 row_bcast:15 row_mask:0xa bank_mask:0xf
  s_nop 0
  v_add_f32_dpp v24, v24, v24 row_bcast:31 row_mask:0xc bank_mask:0xf
  v_add_f32_dpp v25, v25, v25 row_bcast:31 row_mask:0xc bank_mask:0xf
  v_readlane_b32 s40, v24, 63
  v_readlane_b32 s41, v25, 63
  s_mov_b32 s37, 0x3a800000
  v_mov_b32 v26, s40
  v_mov_b32 v27, s41
  v_mul_f32 v26, s37, v26
  v_mul_f32 v27, s37, v27
  v_sub_f32 v80, v32, v26
  v_sub_f32 v81, v33, v26
  v_sub_f32 v82, v34, v26
  v_sub_f32 v83, v35, v26
  v_sub_f32 v84, v36, v26
  v_sub_f32 v85, v37, v26
  v_sub_f32 v86, v38, v26
  v_sub_f32 v87, v39, v26
  v_sub_f32 v88, v40, v26
  v_sub_f32 v89, v41, v26
  v_sub_f32 v90, v42, v26
  v_sub_f32 v91, v43, v26
  v_sub_f32 v92, v44, v26
  v_sub_f32 v93, v45, v26
  v_sub_f32 v94, v46, v26
  v_sub_f32 v95, v47, v26
  v_sub_f32 v96, v48, v27
  v_sub_f32 v97, v49, v27
  v_sub_f32 v98, v50, v27
  v_sub_f32 v99, v51, v27
  v_sub_f32 v100, v52, v27
  v_sub_f32 v101, v53, v27
  v_sub_f32 v102, v54, v27
  v_sub_f32 v103, v55, v27
  v_sub_f32 v104, v56, v27
  v_sub_f32 v105, v57, v27
  v_sub_f32 v106, v58, v27
  v_sub_f32 v107, v59, v27
  v_sub_f32 v108, v60, v27
  v_sub_f32 v109, v61, v27
  v_sub_f32 v110, v62, v27
  v_sub_f32 v111, v63, v27
  v_mul_f32 v64, v80, v80
  v_mul_f32 v65, v82, v82
  v_mul_f32 v66, v84, v84
  v_mul_f32 v67, v86, v86
  v_mul_f32 v68, v88, v88
  v_mul_f32 v69, v90, v90
  v_mul_f32 v70, v92, v92
  v_mul_f32 v71, v94, v94
  v_mul_f32 v72, v96, v96
  v_mul_f32 v73, v98, v98
  v_mul_f32 v74, v100, v100
  v_mul_f32 v75, v102, v102
  v_mul_f32 v76, v104, v104
  v_mul_f32 v77, v106, v106
  v_mul_f32 v78, v108, v108
  v_mul_f32 v79, v110, v110
  v_fmac_f32 v64, v81, v81
  v_fmac_f32 v65, v83, v83
  v_fmac_f32 v66, v85, v85
  v_fmac_f32 v67, v87, v87
  v_fmac_f32 v68, v89, v89
  v_fmac_f32 v69, v91, v91
  v_fmac_f32 v70, v93, v93
  v_fmac_f32 v71, v95, v95
  v_fmac_f32 v72, v97, v97
  v_fmac_f32 v73, v99, v99
  v_fmac_f32 v74, v101, v101
  v_fmac_f32 v75, v103, v103
  v_fmac_f32 v76, v105, v105
  v_fmac_f32 v77, v107, v107
  v_fmac_f32 v78, v109, v109
  v_fmac_f32 v79, v111, v111
  v_add_f32 v64, v64, v68
  v_add_f32 v65, v65, v69
  v_add_f32 v66, v66, v70
  v_add_f32 v67, v67, v71
  v_add_f32 v72, v72, v76
  v_add_f32 v73, v73, v77
  v_add_f32 v74, v74, v78
  v_add_f32 v75, v75, v79
  v_add_f32 v64, v64, v66
  v_add_f32 v65, v65, v67
  v_add_f32 v72, v72, v74
  v_add_f32 v73, v73, v75
  v_add_f32 v24, v64, v65
  v_add_f32 v25, v72, v73
  s_nop 0
  v_add_f32_dpp v24, v24, v24 row_shr:1 row_mask:0xf bank_mask:0xf bound_ctrl:0
  v_add_f32_dpp v25, v25, v25 row_shr:1 row_mask:0xf bank_mask:0xf bound_ctrl:0
  s_nop 0
  v_add_f32_dpp v24, v24, v24 row_shr:2 row_mask:0xf bank_mask:0xf bound_ctrl:0
  v_add_f32_dpp v25, v25, v25 row_shr:2 row_mask:0xf bank_mask:0xf bound_ctrl:0
  s_nop 0
  v_add_f32_dpp v24, v24, v24 row_shr:4 row_mask:0xf bank_mask:0xf bound_ctrl:0
  v_add_f32_dpp v25, v25, v25 row_shr:4 row_mask:0xf bank_mask:0xf bound_ctrl:0
  s_nop 0
  v_add_f32_dpp v24, v24, v24 row_shr:8 row_mask:0xf bank_mask:0xf bound_ctrl:0
  v_add_f32_dpp v25, v25, v25 row_shr:8 row_mask:0xf bank_mask:0xf bound_ctrl:0
  s_nop 0
  v_add_f32_dpp v24, v24, v24 row_bcast:15 row_mask:0xa bank_mask:0xf
  v_add_f32_dpp v25, v25, v25 row_bcast:15 row_mask:0xa bank_mask:0xf
  s_nop 0
  v_add_f32_dpp v24, v24, v24 row_bcast:31 row_mask:0xc bank_mask:0xf
  v_add_f32_dpp v25, v25, v25 row_bcast:31 row_mask:0xc bank_mask:0xf
  v_readlane_b32 s42, v24, 63
  v_readlane_b32 s43, v25, 63
  s_nop 0
  v_mov_b32 v28, s42
  v_mov_b32 v29, s43
  v_mul_f32 v28, s37, v28
  v_mul_f32 v29, s37, v29
  s_mov_b32 s38, 0x3727c5ac
  v_cvt_pk_bf16_f32 v28, v28, v28
  v_cvt_pk_bf16_f32 v29, v29, v29
  v_cvt_pk_bf16_f32 v26, v26, v26
  v_cvt_pk_bf16_f32 v27, v27, v27
  v_lshlrev_b32 v28, 16, v28
  v_lshlrev_b32 v29, 16, v29
  v_lshlrev_b32 v26, 16, v26
  v_lshlrev_b32 v27, 16, v27
  v_add_f32 v28, s38, v28
  v_add_f32 v29, s38, v29
  v_cvt_pk_bf16_f32 v28, v28, v28
  v_cvt_pk_bf16_f32 v29, v29, v29
  v_lshlrev_b32 v28, 16, v28
  v_lshlrev_b32 v29, 16, v29
  v_sqrt_f32 v28, v28
  v_sqrt_f32 v29, v29
  v_cvt_pk_bf16_f32 v28, v28, v28
  v_cvt_pk_bf16_f32 v29, v29, v29
  v_lshlrev_b32 v28, 16, v28
  v_lshlrev_b32 v29, 16, v29
  v_rcp_f32 v28, v28
  v_rcp_f32 v29, v29
  v_sub_f32 v32, v32, v26
  v_sub_f32 v33, v33, v26
  v_sub_f32 v34, v34, v26
  v_sub_f32 v35, v35, v26
  v_sub_f32 v36, v36, v26
  v_sub_f32 v37, v37, v26
  v_sub_f32 v38, v38, v26
  v_sub_f32 v39, v39, v26
  v_sub_f32 v40, v40, v26
  v_sub_f32 v41, v41, v26
  v_sub_f32 v42, v42, v26
  v_sub_f32 v43, v43, v26
  v_sub_f32 v44, v44, v26
  v_sub_f32 v45, v45, v26
  v_sub_f32 v46, v46, v26
  v_sub_f32 v47, v47, v26
  v_sub_f32 v48, v48, v27
  v_sub_f32 v49, v49, v27
  v_sub_f32 v50, v50, v27
  v_sub_f32 v51, v51, v27
  v_sub_f32 v52, v52, v27
  v_sub_f32 v53, v53, v27
  v_sub_f32 v54, v54, v27
  v_sub_f32 v55, v55, v27
  v_sub_f32 v56, v56, v27
  v_sub_f32 v57, v57, v27
  v_sub_f32 v58, v58, v27
  v_sub_f32 v59, v59, v27
  v_sub_f32 v60, v60, v27
  v_sub_f32 v61, v61, v27
  v_sub_f32 v62, v62, v27
  v_sub_f32 v63, v63, v27
  v_cvt_pk_bf16_f32 v80, v32, v33
  v_cvt_pk_bf16_f32 v81, v34, v35
  v_cvt_pk_bf16_f32 v82, v36, v37
  v_cvt_pk_bf16_f32 v83, v38, v39
  v_cvt_pk_bf16_f32 v84, v40, v41
  v_cvt_pk_bf16_f32 v85, v42, v43
  v_cvt_pk_bf16_f32 v86, v44, v45
  v_cvt_pk_bf16_f32 v87, v46, v47
  v_cvt_pk_bf16_f32 v88, v48, v49
  v_cvt_pk_bf16_f32 v89, v50, v51
  v_cvt_pk_bf16_f32 v90, v52, v53
  v_cvt_pk_bf16_f32 v91, v54, v55
  v_cvt_pk_bf16_f32 v92, v56, v57
  v_cvt_pk_bf16_f32 v93, v58, v59
  v_cvt_pk_bf16_f32 v94, v60, v61
  v_cvt_pk_bf16_f32 v95, v62, v63
  v_lshlrev_b32 v32, 16, v80
  v_and_b32 v33, s36, v80
  v_lshlrev_b32 v34, 16, v81
  v_and_b32 v35, s36, v81
  v_lshlrev_b32 v36, 16, v82
  v_and_b32 v37, s36, v82
  v_lshlrev_b32 v38, 16, v83
  v_and_b32 v39, s36, v83
  v_lshlrev_b32 v40, 16, v84
  v_and_b32 v41, s36, v84
  v_lshlrev_b32 v42, 16, v85
  v_and_b32 v43, s36, v85
  v_lshlrev_b32 v44, 16, v86
  v_and_b32 v45, s36, v86
  v_lshlrev_b32 v46, 16, v87
  v_and_b32 v47, s36, v87
  v_lshlrev_b32 v48, 16, v88
  v_and_b32 v49, s36, v88
  v_lshlrev_b32 v50, 16, v89
  v_and_b32 v51, s36, v89
  v_lshlrev_b32 v52, 16, v90
  v_and_b32 v53, s36, v90
  v_lshlrev_b32 v54, 16, v91
  v_and_b32 v55, s36, v91
  v_lshlrev_b32 v56, 16, v92
  v_and_b32 v57, s36, v92
  v_lshlrev_b32 v58, 16, v93
  v_and_b32 v59, s36, v93
  v_lshlrev_b32 v60, 16, v94
  v_and_b32 v61, s36, v94
  v_lshlrev_b32 v62, 16, v95
  v_and_b32 v63, s36, v95
  v_mul_f32 v32, v32, v28
  v_mul_f32 v33, v33, v28
  v_mul_f32 v34, v34, v28
  v_mul_f32 v35, v35, v28
  v_mul_f32 v36, v36, v28
  v_mul_f32 v37, v37, v28
  v_mul_f32 v38, v38, v28
  v_mul_f32 v39, v39, v28
  v_mul_f32 v40, v40, v28
  v_mul_f32 v41, v41, v28
  v_mul_f32 v42, v42, v28
  v_mul_f32 v43, v43, v28
  v_mul_f32 v44, v44, v28
  v_mul_f32 v45, v45, v28
  v_mul_f32 v46, v46, v28
  v_mul_f32 v47, v47, v28
  v_mul_f32 v48, v48, v29
  v_mul_f32 v49, v49, v29
  v_mul_f32 v50, v50, v29
  v_mul_f32 v51, v51, v29
  v_mul_f32 v52, v52, v29
  v_mul_f32 v53, v53, v29
  v_mul_f32 v54, v54, v29
  v_mul_f32 v55, v55, v29
  v_mul_f32 v56, v56, v29
  v_mul_f32 v57, v57, v29
  v_mul_f32 v58, v58, v29
  v_mul_f32 v59, v59, v29
  v_mul_f32 v60, v60, v29
  v_mul_f32 v61, v61, v29
  v_mul_f32 v62, v62, v29
  v_mul_f32 v63, v63, v29
  v_cvt_pk_bf16_f32 v8, v32, v33
  v_cvt_pk_bf16_f32 v9, v34, v35
  v_cvt_pk_bf16_f32 v10, v36, v37
  v_cvt_pk_bf16_f32 v11, v38, v39
  v_cvt_pk_bf16_f32 v12, v40, v41
  v_cvt_pk_bf16_f32 v13, v42, v43
  v_cvt_pk_bf16_f32 v14, v44, v45
  v_cvt_pk_bf16_f32 v15, v46, v47
  v_cvt_pk_bf16_f32 v16, v48, v49
  v_cvt_pk_bf16_f32 v17, v50, v51
  v_cvt_pk_bf16_f32 v18, v52, v53
  v_cvt_pk_bf16_f32 v19, v54, v55
  v_cvt_pk_bf16_f32 v20, v56, v57
  v_cvt_pk_bf16_f32 v21, v58, v59
  v_cvt_pk_bf16_f32 v22, v60, v61
  v_cvt_pk_bf16_f32 v23, v62, v63
  s_lshl_b32 s16, s20, 1
  v_and_b32 v2, 15, v1
  v_xor_b32 v2, s16, v2
  v_lshlrev_b32 v4, 8, v1
  v_lshl_add_u32 v4, v2, 4, v4
  v_add_u32 v4, 114688, v4
  v_xor_b32 v25, 16, v4
  ds_write_b128 v4, v[8:11] offset:0
  ds_write_b128 v4, v[12:15] offset:16384
  ds_write_b128 v25, v[16:19] offset:0
  ds_write_b128 v25, v[20:23] offset:16384
  v_lshrrev_b32 v5, 4, v1
  v_lshlrev_b32 v2, 4, v5
  v_xor_b32 v26, v2, v3
  s_lshl_b32 s16, s20, 12
  s_add_u32 s16, s16, 114688
  v_add_u32 v30, s16, v26
  v_xor_b32 v27, 64, v30
  v_xor_b32 v28, 0x80, v30
  v_xor_b32 v29, 0xc0, v30
  v_lshlrev_b32 v31, 9, v5
  v_bfe_u32 v2, v1, 2, 2
  v_lshl_add_u32 v31, v2, 6, v31
  v_and_b32 v2, 3, v1
  v_lshl_add_u32 v31, v2, 3, v31
  s_add_u32 s16, s17, 49152
  v_add_u32 v31, s16, v31
  s_lshl_b32 s16, s22, 14
  s_and_b32 s18, s20, 3
  s_lshl_b32 s18, s18, 12
  s_add_u32 s16, s16, s18
  s_add_u32 s39, s23, s16
  s_add_u32 s16, s16, 114688
  v_add_u32 v24, s16, v26
  v_xor_b32 v25, 64, v24
  v_xor_b32 v4, 0x80, v24
  v_xor_b32 v26, 0xc0, v24
  s_cmp_ge_u32 s20, 4
  s_cbranch_scc1 P0_B
  s_lshl_b32 s18, s20, 14
  s_add_u32 m0, s18, 49152
  s_add_u32 s16, s18, 0
  buffer_load_dwordx4 v3, s[28:31], s16 offen offset:0 lds
  buffer_load_dwordx4 v3, s[28:31], s16 offen offset:1024 lds
  buffer_load_dwordx4 v3, s[28:31], s16 offen offset:2048 lds
  buffer_load_dwordx4 v3, s[28:31], s16 offen offset:3072 lds
  s_add_u32 m0, s18, 53248
  s_add_u32 s16, s18, 4096
  buffer_load_dwordx4 v3, s[28:31], s16 offen offset:0 lds
  buffer_load_dwordx4 v3, s[28:31], s16 offen offset:1024 lds
  buffer_load_dwordx4 v3, s[28:31], s16 offen offset:2048 lds
  buffer_load_dwordx4 v3, s[28:31], s16 offen offset:3072 lds
  s_add_u32 m0, s18, 57344
  s_add_u32 s16, s18, 8192
  buffer_load_dwordx4 v3, s[28:31], s16 offen offset:0 lds
  buffer_load_dwordx4 v3, s[28:31], s16 offen offset:1024 lds
  buffer_load_dwordx4 v3, s[28:31], s16 offen offset:2048 lds
  buffer_load_dwordx4 v3, s[28:31], s16 offen offset:3072 lds
  s_add_u32 m0, s18, 61440
  s_add_u32 s16, s18, 12288
  buffer_load_dwordx4 v3, s[28:31], s16 offen offset:0 lds
  buffer_load_dwordx4 v3, s[28:31], s16 offen offset:1024 lds
  buffer_load_dwordx4 v3, s[28:31], s16 offen offset:2048 lds
  buffer_load_dwordx4 v3, s[28:31], s16 offen offset:3072 lds
  s_add_u32 m0, s47, s46
  s_nop 0
  global_load_lds_dwordx4 v[116:117], off
  global_load_lds_dwordx4 v[118:119], off offset:1024
  v_lshl_add_u64 v[116:117], v[120:121], 0, v[116:117]
  v_lshl_add_u64 v[118:119], v[120:121], 0, v[118:119]
  s_waitcnt lgkmcnt(0)
  s_barrier
  s_waitcnt vmcnt(2)
  v_readfirstlane_b32 s55, v6
  s_mov_b32 s17, 0x40000
P0_TAGA:
  s_cmp_eq_u32 s55, 0
  s_cbranch_scc1 P0_TAGLDA
  s_sub_u32 s16, s48, s55
  s_add_u32 s16, s16, 3000
  s_cmp_lt_u32 s16, 6000
  s_cbranch_scc1 P0_TAGOKA
  s_cmp_lt_u32 s17, 0x3f800
  s_cbranch_scc1 P0_TAGOKA
P0_TAGLDA:
  buffer_load_dword v6, v7, s[56:59], 0 offen sc1
  s_waitcnt vmcnt(0)
  v_readfirstlane_b32 s55, v6
  s_sub_u32 s17, s17, 1
  s_cmp_lg_u32 s17, 0
  s_cbranch_scc1 P0_TAGA
P0_TAGOKA:
  s_branch P0_C
P0_B:
  s_waitcnt lgkmcnt(0)
  s_barrier
  ds_read_b128 v[8:11], v24 offset:0
  ds_read_b128 v[12:15], v25 offset:1024
  ds_read_b128 v[16:19], v4 offset:2048
  ds_read_b128 v[20:23], v26 offset:3072
  s_waitcnt lgkmcnt(3)
  buffer_store_dwordx4 v[8:11], v3, s[32:35], s39 offen offset:0 sc1
  s_waitcnt lgkmcnt(2)
  buffer_store_dwordx4 v[12:15], v3, s[32:35], s39 offen offset:1024 sc1
  s_waitcnt lgkmcnt(1)
  buffer_store_dwordx4 v[16:19], v3, s[32:35], s39 offen offset:2048 sc1
  s_waitcnt lgkmcnt(0)
  buffer_store_dwordx4 v[20:23], v3, s[32:35], s39 offen offset:3072 sc1
  s_add_u32 m0, s47, s46
  s_nop 0
  global_load_lds_dwordx4 v[116:117], off
  global_load_lds_dwordx4 v[118:119], off offset:1024
  v_lshl_add_u64 v[116:117], v[120:121], 0, v[116:117]
  v_lshl_add_u64 v[118:119], v[120:121], 0, v[118:119]
  s_waitcnt vmcnt(6)
  v_readfirstlane_b32 s55, v6
  s_mov_b32 s17, 0x40000
P0_TAGB:
  s_cmp_eq_u32 s55, 0
  s_cbranch_scc1 P0_TAGLDB
  s_sub_u32 s16, s48, s55
  s_add_u32 s16, s16, 3000
  s_cmp_lt_u32 s16, 6000
  s_cbranch_scc1 P0_TAGOKB
  s_cmp_lt_u32 s17, 0x3f800
  s_cbranch_scc1 P0_TAGOKB
P0_TAGLDB:
  buffer_load_dword v6, v7, s[56:59], 0 offen sc1
  s_waitcnt vmcnt(0)
  v_readfirstlane_b32 s55, v6
  s_sub_u32 s17, s17, 1
  s_cmp_lg_u32 s17, 0
  s_cbranch_scc1 P0_TAGB
P0_TAGOKB:
  s_lshl_b32 s18, s2, 3
  s_add_u32 s18, s18, s54
  s_lshl_b32 s18, s18, 2
  s_add_u32 s18, s18, 4722688
  s_waitcnt vmcnt(2)
  v_mov_b32 v2, s55
  v_mov_b32 v8, 0
  s_mov_b64 exec, 1
  buffer_store_dword v2, v8, s[32:35], s18 offen sc1
  s_mov_b64 exec, -1
P0_C:
  s_barrier
  ds_read_b128 v[32:35], v30 offset:0
  ds_read_b64_tr_b16 v[64:65], v31 offset:0
  ds_read_b64_tr_b16 v[66:67], v31 offset:256
  ds_read_b64_tr_b16 v[68:69], v31 offset:32
  ds_read_b64_tr_b16 v[70:71], v31 offset:288
  ds_read_b128 v[36:39], v27 offset:1024
  ds_read_b64_tr_b16 v[72:73], v31 offset:2048
  ds_read_b64_tr_b16 v[74:75], v31 offset:2304
  ds_read_b64_tr_b16 v[76:77], v31 offset:2080
  ds_read_b64_tr_b16 v[78:79], v31 offset:2336
  ds_read_b128 v[40:43], v28 offset:2048
  ds_read_b64_tr_b16 v[80:81], v31 offset:4096
  ds_read_b64_tr_b16 v[82:83], v31 offset:4352
  ds_read_b64_tr_b16 v[84:85], v31 offset:4128
  ds_read_b64_tr_b16 v[86:87], v31 offset:4384
  ds_read_b128 v[44:47], v29 offset:3072
  ds_read_b64_tr_b16 v[88:89], v31 offset:6144
  ds_read_b64_tr_b16 v[90:91], v31 offset:6400
  ds_read_b64_tr_b16 v[92:93], v31 offset:6176
  ds_read_b64_tr_b16 v[94:95], v31 offset:6432
  s_waitcnt lgkmcnt(0)
  s_cmp_eq_u32 s22, 0
  s_cbranch_scc0 P0_V
  v_mfma_f32_16x16x32_bf16 v[96:99], v[64:67], v[32:35], 0
  v_mfma_f32_16x16x32_bf16 v[100:103], v[68:71], v[32:35], 0
  v_mfma_f32_16x16x32_bf16 v[96:99], v[72:75], v[36:39], v[96:99]
  v_mfma_f32_16x16x32_bf16 v[100:103], v[76:79], v[36:39], v[100:103]
  v_mfma_f32_16x16x32_bf16 v[96:99], v[80:83], v[40:43], v[96:99]
  v_mfma_f32_16x16x32_bf16 v[100:103], v[84:87], v[40:43], v[100:103]
  v_mfma_f32_16x16x32_bf16 v[96:99], v[88:91], v[44:47], v[96:99]
  v_mfma_f32_16x16x32_bf16 v[100:103], v[92:95], v[44:47], v[100:103]
  s_branch P0_R
P0_V:
  v_mfma_f32_16x16x32_bf16 v[96:99], v[32:35], v[64:67], 0
  v_mfma_f32_16x16x32_bf16 v[100:103], v[32:35], v[68:71], 0
  v_mfma_f32_16x16x32_bf16 v[96:99], v[36:39], v[72:75], v[96:99]
  v_mfma_f32_16x16x32_bf16 v[100:103], v[36:39], v[76:79], v[100:103]
  v_mfma_f32_16x16x32_bf16 v[96:99], v[40:43], v[80:83], v[96:99]
  v_mfma_f32_16x16x32_bf16 v[100:103], v[40:43], v[84:87], v[100:103]
  v_mfma_f32_16x16x32_bf16 v[96:99], v[44:47], v[88:91], v[96:99]
  v_mfma_f32_16x16x32_bf16 v[100:103], v[44:47], v[92:95], v[100:103]
P0_R:
  s_lshl_b32 s16, s20, 11
  s_add_u32 s16, s16, 147456
  v_add_u32 v4, s16, v3
  s_nop 3
  ds_write_b128 v4, v[96:99] offset:0
  ds_write_b128 v4, v[100:103] offset:1024
  s_waitcnt lgkmcnt(0)
  s_barrier
  s_cmp_lg_u32 s20, 0
  s_cbranch_scc1 P0_END
  v_add_u32 v4, 147456, v3
  ds_read_b128 v[32:35], v4 offset:0
  ds_read_b128 v[36:39], v4 offset:1024
  ds_read_b128 v[40:43], v4 offset:2048
  ds_read_b128 v[44:47], v4 offset:3072
  ds_read_b128 v[48:51], v4 offset:4096
  ds_read_b128 v[52:55], v4 offset:5120
  ds_read_b128 v[56:59], v4 offset:6144
  ds_read_b128 v[60:63], v4 offset:7168
  ds_read_b128 v[64:67], v4 offset:8192
  ds_read_b128 v[68:71], v4 offset:9216
  ds_read_b128 v[72:75], v4 offset:10240
  ds_read_b128 v[76:79], v4 offset:11264
  ds_read_b128 v[80:83], v4 offset:12288
  ds_read_b128 v[84:87], v4 offset:13312
  ds_read_b128 v[88:91], v4 offset:14336
  ds_read_b128 v[92:95], v4 offset:15360
  s_waitcnt lgkmcnt(0)
  v_add_f32 v32, v32, v64
  v_add_f32 v33, v33, v65
  v_add_f32 v34, v34, v66
  v_add_f32 v35, v35, v67
  v_add_f32 v36, v36, v68
  v_add_f32 v37, v37, v69
  v_add_f32 v38, v38, v70
  v_add_f32 v39, v39, v71
  v_add_f32 v40, v40, v72
  v_add_f32 v41, v41, v73
  v_add_f32 v42, v42, v74
  v_add_f32 v43, v43, v75
  v_add_f32 v44, v44, v76
  v_add_f32 v45, v45, v77
  v_add_f32 v46, v46, v78
  v_add_f32 v47, v47, v79
  v_add_f32 v48, v48, v80
  v_add_f32 v49, v49, v81
  v_add_f32 v50, v50, v82
  v_add_f32 v51, v51, v83
  v_add_f32 v52, v52, v84
  v_add_f32 v53, v53, v85
  v_add_f32 v54, v54, v86
  v_add_f32 v55, v55, v87
  v_add_f32 v56, v56, v88
  v_add_f32 v57, v57, v89
  v_add_f32 v58, v58, v90
  v_add_f32 v59, v59, v91
  v_add_f32 v60, v60, v92
  v_add_f32 v61, v61, v93
  v_add_f32 v62, v62, v94
  v_add_f32 v63, v63, v95
  v_add_f32 v32, v32, v48
  v_add_f32 v33, v33, v49
  v_add_f32 v34, v34, v50
  v_add_f32 v35, v35, v51
  v_add_f32 v36, v36, v52
  v_add_f32 v37, v37, v53
  v_add_f32 v38, v38, v54
  v_add_f32 v39, v39, v55
  v_add_f32 v40, v40, v56
  v_add_f32 v41, v41, v57
  v_add_f32 v42, v42, v58
  v_add_f32 v43, v43, v59
  v_add_f32 v44, v44, v60
  v_add_f32 v45, v45, v61
  v_add_f32 v46, v46, v62
  v_add_f32 v47, v47, v63
  v_add_f32 v32, v32, v40
  v_add_f32 v33, v33, v41
  v_add_f32 v34, v34, v42
  v_add_f32 v35, v35, v43
  v_add_f32 v36, v36, v44
  v_add_f32 v37, v37, v45
  v_add_f32 v38, v38, v46
  v_add_f32 v39, v39, v47
  v_cvt_pk_bf16_f32 v8, v32, v33
  v_cvt_pk_bf16_f32 v9, v34, v35
  v_cvt_pk_bf16_f32 v10, v36, v37
  v_cvt_pk_bf16_f32 v11, v38, v39
  s_lshr_b32 s16, s21, 1
  s_lshl_b32 s19, s16, 12
  s_add_u32 s19, s19, 4194304
  s_and_b32 s16, s21, 1
  s_lshl_b32 s16, s16, 10
  s_add_u32 s19, s19, s16
  s_cmp_eq_u32 s22, 0
  s_cbranch_scc0 P0_SV
  buffer_store_dwordx4 v[8:11], v3, s[32:35], s19 offen sc1
  s_branch P0_KF
P0_SV:
  v_and_b32 v2, 1, v5
  v_lshlrev_b32 v4, 9, v2
  v_and_b32 v2, 15, v1
  v_lshl_add_u32 v4, v2, 4, v4
  v_lshrrev_b32 v2, 1, v5
  v_lshl_add_u32 v4, v2, 3, v4
  buffer_store_dwordx2 v[8:9], v4, s[32:35], s19 offen offset:2048 sc1
  buffer_store_dwordx2 v[10:11], v4, s[32:35], s19 offen offset:2304 sc1
P0_KF:
P0_END:
  s_and_b32 s16, s2, 7
  s_lshl_b32 s16, s16, 2
  s_bfe_u32 s21, s2, 0x20003
  s_add_u32 s21, s21, s16
  s_lshr_b32 s22, s2, 5
  s_and_b32 s23, s20, 3
  v_add_u32 v10, 31744, v3
  s_lshl_b32 s16, s22, 4
  s_lshl_b32 s17, s20, 1
  s_add_u32 s16, s16, s17
  s_lshl_b32 s44, s16, 15
  s_lshl_b32 s45, s20, 11
  s_mov_b32 s47, 0
  s_mov_b32 s50, 0
  s_mov_b32 s52, 32768
  s_load_dwordx2 s[4:5], s[0:1], 8
  s_load_dwordx2 s[6:7], s[0:1], 64
  s_load_dwordx2 s[8:9], s[0:1], 32
  v_min_u32 v2, 6, v1
  v_lshlrev_b32 v14, 7, v2
  s_mul_i32 s16, s2, 896
  v_add_u32 v14, s16, v14
  s_mov_b32 s31, 229376
  s_mov_b32 s30, 1146880
  s_cmp_eq_u32 s23, 0
  s_cbranch_scc1 G1_T0
  s_mov_b32 s30, 0x7f000000
  s_mov_b32 s31, 0
  s_cmp_ge_u32 s20, 4
  s_cbranch_scc1 G1_T0
  s_waitcnt lgkmcnt(0)
  s_cmp_eq_u32 s20, 1
  s_cbranch_scc0 G1_T2
  s_mov_b32 s24, s4
  s_mov_b32 s25, s5
  s_mov_b32 s26, 0x200000
  s_mov_b32 s27, 0x20000
  v_and_b32 v2, 1, v1
  v_lshlrev_b32 v14, 7, v2
  s_lshl_b32 s16, s2, 8
  v_add_u32 v14, s16, v14
  s_mov_b32 s31, 65536
  s_mov_b32 s30, 327680
  s_branch G1_T0
G1_T2:
  s_cmp_eq_u32 s20, 2
  s_cbranch_scc0 G1_T3
  s_mov_b32 s24, s6
  s_mov_b32 s25, s7
  s_mov_b32 s26, 0x700000
  s_mov_b32 s27, 0x20000
  s_branch G1_T0
G1_T3:
  s_mov_b32 s24, s8
  s_mov_b32 s25, s9
  s_mov_b32 s26, 0x200000
  s_mov_b32 s27, 0x20000
  v_min_u32 v2, 2, v1
  v_lshlrev_b32 v14, 7, v2
  s_mov_b32 s31, 384
  s_lshl_b32 s30, s2, 13
G1_T0:
  s_and_b32 s18, s2, 0xe0
  s_lshr_b32 s16, s20, 2
  s_lshl_b32 s16, s16, 4
  s_add_u32 s18, s18, s16
  s_and_b32 s16, s20, 3
  s_lshl_b32 s16, s16, 1
  s_add_u32 s18, s18, s16
  s_lshl_b32 s18, s18, 5
  s_add_u32 s18, s18, 4722704
  v_and_b32 v2, 3, v1
  v_lshlrev_b32 v8, 2, v2
  v_bfe_u32 v2, v1, 2, 1
  v_lshl_add_u32 v8, v2, 5, v8
  v_lshrrev_b32 v2, 3, v1
  v_lshl_add_u32 v8, v2, 8, v8
  s_mov_b32 exec_lo, 0xffff
  s_mov_b32 exec_hi, 0x0
  s_mov_b32 s17, 0x20000
  buffer_load_dword v17, v8, s[32:35], s18 offen sc1
  s_sleep 3
G1_PP:
  buffer_load_dword v18, v8, s[32:35], s18 offen sc1
  s_waitcnt vmcnt(1)
  v_cmp_ne_u32 vcc, s55, v17
  s_nop 0
  s_cbranch_vccz G1_PD
  buffer_load_dword v17, v8, s[32:35], s18 offen sc1
  s_waitcnt vmcnt(1)
  v_cmp_ne_u32 vcc, s55, v18
  s_nop 0
  s_cbranch_vccz G1_PD
  s_sub_u32 s17, s17, 1
  s_cmp_lg_u32 s17, 0
  s_cbranch_scc1 G1_PP
G1_PD:
  s_mov_b64 exec, -1
  s_cmp_ge_u32 s20, 4
  s_cbranch_scc1 G1_B
  s_add_u32 m0, s47, s45
  s_nop 0
  buffer_load_dwordx4 v3, s[32:35], s44 offen lds
  buffer_load_dwordx4 v10, s[32:35], s44 offen offset:1024 lds
  s_add_u32 s44, s44, 1024
  s_add_u32 s47, s47, 32768
  s_cmp_eq_u32 s47, 163840
  s_cselect_b32 s47, 0, s47
  s_add_u32 m0, s52, s46
  s_nop 0
  global_load_lds_dwordx4 v[116:117], off
  global_load_lds_dwordx4 v[118:119], off offset:1024
  v_lshl_add_u64 v[116:117], v[120:121], 0, v[116:117]
  v_lshl_add_u64 v[118:119], v[120:121], 0, v[118:119]
  s_add_u32 s52, s52, 32768
  s_cmp_eq_u32 s52, 163840
  s_cselect_b32 s52, 0, s52
  s_add_u32 m0, s47, s45
  s_nop 0
  buffer_load_dwordx4 v3, s[32:35], s44 offen lds
  buffer_load_dwordx4 v10, s[32:35], s44 offen offset:1024 lds
  s_add_u32 s44, s44, 1024
  s_add_u32 s47, s47, 32768
  s_cmp_eq_u32 s47, 163840
  s_cselect_b32 s47, 0, s47
  s_lshl_b32 s18, s2, 2
  s_add_u32 s18, s18, 4718592
  s_cmp_eq_u32 s20, 0
  s_cselect_b32 s18, s18, 0x7f000000
  v_mov_b32 v2, s55
  v_mov_b32 v8, 0
  s_mov_b64 exec, 1
  buffer_store_dword v2, v8, s[32:35], s18 offen sc1
  s_mov_b64 exec, -1
  s_lshr_b32 s17, s20, 2
  s_lshl_b32 s16, s17, 13
  v_add_u32 v6, s16, v3
  s_and_b32 s19, s21, 1
  s_lshl_b32 s16, s23, 1
  s_add_u32 s40, s16, s19
  s_add_u32 s41, s40, 1
  s_mul_i32 s16, s19, 6
  s_sub_u32 s16, 6, s16
  s_cmp_eq_u32 s23, 3
  s_cselect_b32 s40, s16, s40
  s_cselect_b32 s41, 7, s41
  v_lshrrev_b32 v2, 4, v1
  v_lshlrev_b32 v7, 11, v2
  v_and_b32 v2, 1, v2
  v_lshlrev_b32 v12, 2, v2
  v_bfe_u32 v2, v1, 2, 2
  v_lshl_add_u32 v7, v2, 8, v7
  v_add_u32 v12, v12, v2
  v_and_b32 v2, 3, v1
  v_lshl_add_u32 v7, v2, 3, v7
  v_add_u32 v7, 16384, v7
  v_xor_b32 v2, s41, v12
  v_lshl_add_u32 v11, v2, 5, v7
  v_xor_b32 v2, s40, v12
  v_lshl_add_u32 v7, v2, 5, v7
  s_waitcnt vmcnt(5)
G1_W0:
  s_barrier
  v_add_u32 v8, s50, v6
  v_add_u32 v9, s50, v7
  v_add_u32 v13, s50, v11
  ds_read_b64_tr_b16 v[96:97], v9 offset:0
  s_add_u32 m0, s52, s46
  s_nop 0
  global_load_lds_dwordx4 v[116:117], off
  ds_read_b64_tr_b16 v[98:99], v9 offset:1024
  global_load_lds_dwordx4 v[118:119], off offset:1024
  ds_read_b64_tr_b16 v[100:101], v13 offset:0
  v_lshl_add_u64 v[116:117], v[120:121], 0, v[116:117]
  v_lshl_add_u64 v[118:119], v[120:121], 0, v[118:119]
  s_add_u32 s52, s52, 32768
  s_cmp_eq_u32 s52, 163840
  s_cselect_b32 s52, 0, s52
  s_add_u32 m0, s47, s45
  s_nop 0
  buffer_load_dwordx4 v3, s[32:35], s44 offen lds
  ds_read_b64_tr_b16 v[102:103], v13 offset:1024
  buffer_load_dwordx4 v10, s[32:35], s44 offen offset:1024 lds
  ds_read_b64_tr_b16 v[104:105], v9 offset:8192
  s_add_u32 s44, s44, 1024
  s_add_u32 s47, s47, 32768
  s_cmp_eq_u32 s47, 163840
  s_cselect_b32 s47, 0, s47
  s_add_u32 m0, s52, s46
  s_nop 0
  global_load_lds_dwordx4 v[116:117], off
  ds_read_b64_tr_b16 v[106:107], v9 offset:9216
  global_load_lds_dwordx4 v[118:119], off offset:1024
  ds_read_b64_tr_b16 v[108:109], v13 offset:8192
  v_lshl_add_u64 v[116:117], v[120:121], 0, v[116:117]
  v_lshl_add_u64 v[118:119], v[120:121], 0, v[118:119]
  s_add_u32 s52, s52, 32768
  s_cmp_eq_u32 s52, 163840
  s_cselect_b32 s52, 0, s52
  s_add_u32 m0, s47, s45
  s_nop 0
  buffer_load_dwordx4 v3, s[32:35], s44 offen lds
  ds_read_b64_tr_b16 v[110:111], v13 offset:9216
  buffer_load_dwordx4 v10, s[32:35], s44 offen offset:1024 lds
  ds_read_b128 v[64:67], v8 offset:0
  s_add_u32 s44, s44, 1024
  s_add_u32 s47, s47, 32768
  s_cmp_eq_u32 s47, 163840
  s_cselect_b32 s47, 0, s47
  s_add_u32 m0, s47, s45
  s_nop 0
  buffer_load_dwordx4 v3, s[32:35], s44 offen lds
  ds_read_b128 v[68:71], v8 offset:1024
  ds_read_b128 v[72:75], v8 offset:2048
  ds_read_b128 v[76:79], v8 offset:3072
  ds_read_b128 v[80:83], v8 offset:4096
  ds_read_b128 v[84:87], v8 offset:5120
  ds_read_b128 v[88:91], v8 offset:6144
  ds_read_b128 v[92:95], v8 offset:7168
  buffer_load_dwordx4 v10, s[32:35], s44 offen offset:1024 lds
  s_add_u32 s44, s44, 1024
  s_add_u32 s47, s47, 32768
  s_cmp_eq_u32 s47, 163840
  s_cselect_b32 s47, 0, s47
  s_add_u32 s50, s50, 32768
  s_cmp_eq_u32 s50, 163840
  s_cselect_b32 s50, 0, s50
  s_waitcnt lgkmcnt(0)
  s_barrier
  v_mfma_f32_16x16x32_bf16 v[128:131], v[96:99], v[64:67], 0
  v_mfma_f32_16x16x32_bf16 v[144:147], v[96:99], v[68:71], 0
  v_mfma_f32_16x16x32_bf16 v[160:163], v[96:99], v[72:75], 0
  v_mfma_f32_16x16x32_bf16 v[176:179], v[96:99], v[76:79], 0
  v_mfma_f32_16x16x32_bf16 v[192:195], v[96:99], v[80:83], 0
  v_mfma_f32_16x16x32_bf16 v[208:211], v[96:99], v[84:87], 0
  v_mfma_f32_16x16x32_bf16 v[224:227], v[96:99], v[88:91], 0
  v_mfma_f32_16x16x32_bf16 v[240:243], v[96:99], v[92:95], 0
  v_mfma_f32_16x16x32_bf16 v[244:247], v[100:103], v[92:95], 0
  v_mfma_f32_16x16x32_bf16 v[228:231], v[100:103], v[88:91], 0
  v_mfma_f32_16x16x32_bf16 v[212:215], v[100:103], v[84:87], 0
  v_mfma_f32_16x16x32_bf16 v[196:199], v[100:103], v[80:83], 0
  v_mfma_f32_16x16x32_bf16 v[180:183], v[100:103], v[76:79], 0
  v_mfma_f32_16x16x32_bf16 v[164:167], v[100:103], v[72:75], 0
  v_mfma_f32_16x16x32_bf16 v[148:151], v[100:103], v[68:71], 0
  v_mfma_f32_16x16x32_bf16 v[132:135], v[100:103], v[64:67], 0
  v_mfma_f32_16x16x32_bf16 v[136:139], v[104:107], v[64:67], 0
  v_mfma_f32_16x16x32_bf16 v[152:155], v[104:107], v[68:71], 0
  v_mfma_f32_16x16x32_bf16 v[168:171], v[104:107], v[72:75], 0
  v_mfma_f32_16x16x32_bf16 v[184:187], v[104:107], v[76:79], 0
  v_mfma_f32_16x16x32_bf16 v[200:203], v[104:107], v[80:83], 0
  v_mfma_f32_16x16x32_bf16 v[216:219], v[104:107], v[84:87], 0
  v_mfma_f32_16x16x32_bf16 v[232:235], v[104:107], v[88:91], 0
  v_mfma_f32_16x16x32_bf16 v[248:251], v[104:107], v[92:95], 0
  v_mfma_f32_16x16x32_bf16 v[252:255], v[108:111], v[92:95], 0
  v_mfma_f32_16x16x32_bf16 v[236:239], v[108:111], v[88:91], 0
  v_mfma_f32_16x16x32_bf16 v[220:223], v[108:111], v[84:87], 0
  v_mfma_f32_16x16x32_bf16 v[204:207], v[108:111], v[80:83], 0
  v_mfma_f32_16x16x32_bf16 v[188:191], v[108:111], v[76:79], 0
  v_mfma_f32_16x16x32_bf16 v[172:175], v[108:111], v[72:75], 0
  v_mfma_f32_16x16x32_bf16 v[156:159], v[108:111], v[68:71], 0
  v_mfma_f32_16x16x32_bf16 v[140:143], v[108:111], v[64:67], 0
  s_waitcnt vmcnt(11)
  s_barrier
  v_add_u32 v8, s50, v6
  v_add_u32 v9, s50, v7
  v_add_u32 v13, s50, v11
  s_add_u32 m0, s52, s46
  s_nop 0
  global_load_lds_dwordx4 v[116:117], off
  ds_read_b64_tr_b16 v[96:97], v9 offset:0
  ds_read_b64_tr_b16 v[98:99], v9 offset:1024
  ds_read_b64_tr_b16 v[100:101], v13 offset:0
  global_load_lds_dwordx4 v[118:119], off offset:1024
  ds_read_b64_tr_b16 v[102:103], v13 offset:1024
  ds_read_b64_tr_b16 v[104:105], v9 offset:8192
  ds_read_b64_tr_b16 v[106:107], v9 offset:9216
  v_lshl_add_u64 v[116:117], v[120:121], 0, v[116:117]
  v_lshl_add_u64 v[118:119], v[120:121], 0, v[118:119]
  s_add_u32 s52, s52, 32768
  s_cmp_eq_u32 s52, 163840
  s_cselect_b32 s52, 0, s52
  s_add_u32 m0, s47, s45
  s_nop 0
  buffer_load_dwordx4 v3, s[32:35], s44 offen lds
  ds_read_b64_tr_b16 v[108:109], v13 offset:8192
  ds_read_b64_tr_b16 v[110:111], v13 offset:9216
  ds_read_b128 v[64:67], v8 offset:0
  buffer_load_dwordx4 v10, s[32:35], s44 offen offset:1024 lds
  ds_read_b128 v[68:71], v8 offset:1024
  ds_read_b128 v[72:75], v8 offset:2048
  ds_read_b128 v[76:79], v8 offset:3072
  s_add_u32 s44, s44, 1024
  s_add_u32 s47, s47, 32768
  s_cmp_eq_u32 s47, 163840
  s_cselect_b32 s47, 0, s47
  buffer_load_dword v16, v14, s[24:27], s30 offen
  s_add_u32 s30, s30, s31
  ds_read_b128 v[80:83], v8 offset:4096
  ds_read_b128 v[84:87], v8 offset:5120
  ds_read_b128 v[88:91], v8 offset:6144
  ds_read_b128 v[92:95], v8 offset:7168
  s_add_u32 s50, s50, 32768
  s_cmp_eq_u32 s50, 163840
  s_cselect_b32 s50, 0, s50
  s_waitcnt vmcnt(11) lgkmcnt(0)
  s_barrier
  v_mfma_f32_16x16x32_bf16 v[128:131], v[96:99], v[64:67], v[128:131]
  v_mfma_f32_16x16x32_bf16 v[144:147], v[96:99], v[68:71], v[144:147]
  v_mfma_f32_16x16x32_bf16 v[160:163], v[96:99], v[72:75], v[160:163]
  v_mfma_f32_16x16x32_bf16 v[176:179], v[96:99], v[76:79], v[176:179]
  v_mfma_f32_16x16x32_bf16 v[192:195], v[96:99], v[80:83], v[192:195]
  v_mfma_f32_16x16x32_bf16 v[208:211], v[96:99], v[84:87], v[208:211]
  v_mfma_f32_16x16x32_bf16 v[224:227], v[96:99], v[88:91], v[224:227]
  v_mfma_f32_16x16x32_bf16 v[240:243], v[96:99], v[92:95], v[240:243]
  v_mfma_f32_16x16x32_bf16 v[244:247], v[100:103], v[92:95], v[244:247]
  v_mfma_f32_16x16x32_bf16 v[228:231], v[100:103], v[88:91], v[228:231]
  v_mfma_f32_16x16x32_bf16 v[212:215], v[100:103], v[84:87], v[212:215]
  v_mfma_f32_16x16x32_bf16 v[196:199], v[100:103], v[80:83], v[196:199]
  v_mfma_f32_16x16x32_bf16 v[180:183], v[100:103], v[76:79], v[180:183]
  v_mfma_f32_16x16x32_bf16 v[164:167], v[100:103], v[72:75], v[164:167]
  v_mfma_f32_16x16x32_bf16 v[148:151], v[100:103], v[68:71], v[148:151]
  v_mfma_f32_16x16x32_bf16 v[132:135], v[100:103], v[64:67], v[132:135]
  v_mfma_f32_16x16x32_bf16 v[136:139], v[104:107], v[64:67], v[136:139]
  v_mfma_f32_16x16x32_bf16 v[152:155], v[104:107], v[68:71], v[152:155]
  v_mfma_f32_16x16x32_bf16 v[168:171], v[104:107], v[72:75], v[168:171]
  v_mfma_f32_16x16x32_bf16 v[184:187], v[104:107], v[76:79], v[184:187]
  v_mfma_f32_16x16x32_bf16 v[200:203], v[104:107], v[80:83], v[200:203]
  v_mfma_f32_16x16x32_bf16 v[216:219], v[104:107], v[84:87], v[216:219]
  v_mfma_f32_16x16x32_bf16 v[232:235], v[104:107], v[88:91], v[232:235]
  v_mfma_f32_16x16x32_bf16 v[248:251], v[104:107], v[92:95], v[248:251]
  v_mfma_f32_16x16x32_bf16 v[252:255], v[108:111], v[92:95], v[252:255]
  v_mfma_f32_16x16x32_bf16 v[236:239], v[108:111], v[88:91], v[236:239]
  v_mfma_f32_16x16x32_bf16 v[220:223], v[108:111], v[84:87], v[220:223]
  v_mfma_f32_16x16x32_bf16 v[204:207], v[108:111], v[80:83], v[204:207]
  v_mfma_f32_16x16x32_bf16 v[188:191], v[108:111], v[76:79], v[188:191]
  v_mfma_f32_16x16x32_bf16 v[172:175], v[108:111], v[72:75], v[172:175]
  v_mfma_f32_16x16x32_bf16 v[156:159], v[108:111], v[68:71], v[156:159]
  v_mfma_f32_16x16x32_bf16 v[140:143], v[108:111], v[64:67], v[140:143]
  v_add_u32 v8, s50, v6
  v_add_u32 v9, s50, v7
  v_add_u32 v13, s50, v11
  s_add_u32 m0, s52, s46
  s_nop 0
  global_load_lds_dwordx4 v[116:117], off
  ds_read_b64_tr_b16 v[96:97], v9 offset:0
  ds_read_b64_tr_b16 v[98:99], v9 offset:1024
  ds_read_b64_tr_b16 v[100:101], v13 offset:0
  global_load_lds_dwordx4 v[118:119], off offset:1024
  ds_read_b64_tr_b16 v[102:103], v13 offset:1024
  ds_read_b64_tr_b16 v[104:105], v9 offset:8192
  ds_read_b64_tr_b16 v[106:107], v9 offset:9216
  v_lshl_add_u64 v[116:117], v[120:121], 0, v[116:117]
  v_lshl_add_u64 v[118:119], v[120:121], 0, v[118:119]
  s_add_u32 s52, s52, 32768
  s_cmp_eq_u32 s52, 163840
  s_cselect_b32 s52, 0, s52
  s_add_u32 m0, s47, s45
  s_nop 0
  buffer_load_dwordx4 v3, s[32:35], s44 offen lds
  ds_read_b64_tr_b16 v[108:109], v13 offset:8192
  ds_read_b64_tr_b16 v[110:111], v13 offset:9216
  ds_read_b128 v[64:67], v8 offset:0
  buffer_load_dwordx4 v10, s[32:35], s44 offen offset:1024 lds
  ds_read_b128 v[68:71], v8 offset:1024
  ds_read_b128 v[72:75], v8 offset:2048
  ds_read_b128 v[76:79], v8 offset:3072
  s_add_u32 s44, s44, 1024
  s_add_u32 s47, s47, 32768
  s_cmp_eq_u32 s47, 163840
  s_cselect_b32 s47, 0, s47
  buffer_load_dword v16, v14, s[24:27], s30 offen
  s_add_u32 s30, s30, s31
  ds_read_b128 v[80:83], v8 offset:4096
  ds_read_b128 v[84:87], v8 offset:5120
  ds_read_b128 v[88:91], v8 offset:6144
  ds_read_b128 v[92:95], v8 offset:7168
  s_add_u32 s50, s50, 32768
  s_cmp_eq_u32 s50, 163840
  s_cselect_b32 s50, 0, s50
  s_waitcnt vmcnt(12) lgkmcnt(0)
  s_barrier
  s_mov_b32 s51, 25
G1_A_LOOP:
  v_mfma_f32_16x16x32_bf16 v[128:131], v[96:99], v[64:67], v[128:131]
  v_mfma_f32_16x16x32_bf16 v[144:147], v[96:99], v[68:71], v[144:147]
  v_mfma_f32_16x16x32_bf16 v[160:163], v[96:99], v[72:75], v[160:163]
  v_mfma_f32_16x16x32_bf16 v[176:179], v[96:99], v[76:79], v[176:179]
  v_mfma_f32_16x16x32_bf16 v[192:195], v[96:99], v[80:83], v[192:195]
  v_mfma_f32_16x16x32_bf16 v[208:211], v[96:99], v[84:87], v[208:211]
  v_mfma_f32_16x16x32_bf16 v[224:227], v[96:99], v[88:91], v[224:227]
  v_mfma_f32_16x16x32_bf16 v[240:243], v[96:99], v[92:95], v[240:243]
  v_mfma_f32_16x16x32_bf16 v[244:247], v[100:103], v[92:95], v[244:247]
  v_mfma_f32_16x16x32_bf16 v[228:231], v[100:103], v[88:91], v[228:231]
  v_mfma_f32_16x16x32_bf16 v[212:215], v[100:103], v[84:87], v[212:215]
  v_mfma_f32_16x16x32_bf16 v[196:199], v[100:103], v[80:83], v[196:199]
  v_mfma_f32_16x16x32_bf16 v[180:183], v[100:103], v[76:79], v[180:183]
  v_mfma_f32_16x16x32_bf16 v[164:167], v[100:103], v[72:75], v[164:167]
  v_mfma_f32_16x16x32_bf16 v[148:151], v[100:103], v[68:71], v[148:151]
  v_mfma_f32_16x16x32_bf16 v[132:135], v[100:103], v[64:67], v[132:135]
  v_mfma_f32_16x16x32_bf16 v[136:139], v[104:107], v[64:67], v[136:139]
  v_mfma_f32_16x16x32_bf16 v[152:155], v[104:107], v[68:71], v[152:155]
  v_mfma_f32_16x16x32_bf16 v[168:171], v[104:107], v[72:75], v[168:171]
  v_mfma_f32_16x16x32_bf16 v[184:187], v[104:107], v[76:79], v[184:187]
  v_mfma_f32_16x16x32_bf16 v[200:203], v[104:107], v[80:83], v[200:203]
  v_mfma_f32_16x16x32_bf16 v[216:219], v[104:107], v[84:87], v[216:219]
  v_mfma_f32_16x16x32_bf16 v[232:235], v[104:107], v[88:91], v[232:235]
  v_mfma_f32_16x16x32_bf16 v[248:251], v[104:107], v[92:95], v[248:251]
  v_mfma_f32_16x16x32_bf16 v[252:255], v[108:111], v[92:95], v[252:255]
  v_mfma_f32_16x16x32_bf16 v[236:239], v[108:111], v[88:91], v[236:239]
  v_mfma_f32_16x16x32_bf16 v[220:223], v[108:111], v[84:87], v[220:223]
  v_mfma_f32_16x16x32_bf16 v[204:207], v[108:111], v[80:83], v[204:207]
  v_mfma_f32_16x16x32_bf16 v[188:191], v[108:111], v[76:79], v[188:191]
  v_mfma_f32_16x16x32_bf16 v[172:175], v[108:111], v[72:75], v[172:175]
  v_mfma_f32_16x16x32_bf16 v[156:159], v[108:111], v[68:71], v[156:159]
  v_mfma_f32_16x16x32_bf16 v[140:143], v[108:111], v[64:67], v[140:143]
  v_add_u32 v8, s50, v6
  v_add_u32 v9, s50, v7
  v_add_u32 v13, s50, v11
  s_add_u32 m0, s52, s46
  s_nop 0
  global_load_lds_dwordx4 v[116:117], off
  ds_read_b64_tr_b16 v[96:97], v9 offset:0
  ds_read_b64_tr_b16 v[98:99], v9 offset:1024
  ds_read_b64_tr_b16 v[100:101], v13 offset:0
  global_load_lds_dwordx4 v[118:119], off offset:1024
  ds_read_b64_tr_b16 v[102:103], v13 offset:1024
  ds_read_b64_tr_b16 v[104:105], v9 offset:8192
  ds_read_b64_tr_b16 v[106:107], v9 offset:9216
  v_lshl_add_u64 v[116:117], v[120:121], 0, v[116:117]
  v_lshl_add_u64 v[118:119], v[120:121], 0, v[118:119]
  s_add_u32 s52, s52, 32768
  s_cmp_eq_u32 s52, 163840
  s_cselect_b32 s52, 0, s52
  s_add_u32 m0, s47, s45
  s_nop 0
  buffer_load_dwordx4 v3, s[32:35], s44 offen lds
  ds_read_b64_tr_b16 v[108:109], v13 offset:8192
  ds_read_b64_tr_b16 v[110:111], v13 offset:9216
  ds_read_b128 v[64:67], v8 offset:0
  buffer_load_dwordx4 v10, s[32:35], s44 offen offset:1024 lds
  ds_read_b128 v[68:71], v8 offset:1024
  ds_read_b128 v[72:75], v8 offset:2048
  ds_read_b128 v[76:79], v8 offset:3072
  s_add_u32 s44, s44, 1024
  s_add_u32 s47, s47, 32768
  s_cmp_eq_u32 s47, 163840
  s_cselect_b32 s47, 0, s47
  buffer_load_dword v16, v14, s[24:27], s30 offen
  s_add_u32 s30, s30, s31
  ds_read_b128 v[80:83], v8 offset:4096
  ds_read_b128 v[84:87], v8 offset:5120
  ds_read_b128 v[88:91], v8 offset:6144
  ds_read_b128 v[92:95], v8 offset:7168
  s_add_u32 s50, s50, 32768
  s_cmp_eq_u32 s50, 163840
  s_cselect_b32 s50, 0, s50
  s_waitcnt vmcnt(13) lgkmcnt(0)
  s_barrier
  s_sub_u32 s51, s51, 1
  s_cmp_lg_u32 s51, 0
  s_cbranch_scc1 G1_A_LOOP
  v_mfma_f32_16x16x32_bf16 v[128:131], v[96:99], v[64:67], v[128:131]
  v_mfma_f32_16x16x32_bf16 v[144:147], v[96:99], v[68:71], v[144:147]
  v_mfma_f32_16x16x32_bf16 v[160:163], v[96:99], v[72:75], v[160:163]
  v_mfma_f32_16x16x32_bf16 v[176:179], v[96:99], v[76:79], v[176:179]
  v_mfma_f32_16x16x32_bf16 v[192:195], v[96:99], v[80:83], v[192:195]
  v_mfma_f32_16x16x32_bf16 v[208:211], v[96:99], v[84:87], v[208:211]
  v_mfma_f32_16x16x32_bf16 v[224:227], v[96:99], v[88:91], v[224:227]
  v_mfma_f32_16x16x32_bf16 v[240:243], v[96:99], v[92:95], v[240:243]
  v_mfma_f32_16x16x32_bf16 v[244:247], v[100:103], v[92:95], v[244:247]
  v_mfma_f32_16x16x32_bf16 v[228:231], v[100:103], v[88:91], v[228:231]
  v_mfma_f32_16x16x32_bf16 v[212:215], v[100:103], v[84:87], v[212:215]
  v_mfma_f32_16x16x32_bf16 v[196:199], v[100:103], v[80:83], v[196:199]
  v_mfma_f32_16x16x32_bf16 v[180:183], v[100:103], v[76:79], v[180:183]
  v_mfma_f32_16x16x32_bf16 v[164:167], v[100:103], v[72:75], v[164:167]
  v_mfma_f32_16x16x32_bf16 v[148:151], v[100:103], v[68:71], v[148:151]
  v_mfma_f32_16x16x32_bf16 v[132:135], v[100:103], v[64:67], v[132:135]
  v_mfma_f32_16x16x32_bf16 v[136:139], v[104:107], v[64:67], v[136:139]
  v_mfma_f32_16x16x32_bf16 v[152:155], v[104:107], v[68:71], v[152:155]
  v_mfma_f32_16x16x32_bf16 v[168:171], v[104:107], v[72:75], v[168:171]
  v_mfma_f32_16x16x32_bf16 v[184:187], v[104:107], v[76:79], v[184:187]
  v_mfma_f32_16x16x32_bf16 v[200:203], v[104:107], v[80:83], v[200:203]
  v_mfma_f32_16x16x32_bf16 v[216:219], v[104:107], v[84:87], v[216:219]
  v_mfma_f32_16x16x32_bf16 v[232:235], v[104:107], v[88:91], v[232:235]
  v_mfma_f32_16x16x32_bf16 v[248:251], v[104:107], v[92:95], v[248:251]
  v_mfma_f32_16x16x32_bf16 v[252:255], v[108:111], v[92:95], v[252:255]
  v_mfma_f32_16x16x32_bf16 v[236:239], v[108:111], v[88:91], v[236:239]
  v_mfma_f32_16x16x32_bf16 v[220:223], v[108:111], v[84:87], v[220:223]
  v_mfma_f32_16x16x32_bf16 v[204:207], v[108:111], v[80:83], v[204:207]
  v_mfma_f32_16x16x32_bf16 v[188:191], v[108:111], v[76:79], v[188:191]
  v_mfma_f32_16x16x32_bf16 v[172:175], v[108:111], v[72:75], v[172:175]
  v_mfma_f32_16x16x32_bf16 v[156:159], v[108:111], v[68:71], v[156:159]
  v_mfma_f32_16x16x32_bf16 v[140:143], v[108:111], v[64:67], v[140:143]
  v_add_u32 v8, s50, v6
  v_add_u32 v9, s50, v7
  v_add_u32 v13, s50, v11
  s_mov_b32 s18, 4718592
  buffer_load_dwordx4 v[28:31], v3, s[32:35], s18 offen sc1
  ds_read_b64_tr_b16 v[96:97], v9 offset:0
  ds_read_b64_tr_b16 v[98:99], v9 offset:1024
  ds_read_b64_tr_b16 v[100:101], v13 offset:0
  ds_read_b64_tr_b16 v[102:103], v13 offset:1024
  ds_read_b64_tr_b16 v[104:105], v9 offset:8192
  s_add_u32 m0, s52, s46
  s_nop 0
  global_load_lds_dwordx4 v[116:117], off
  ds_read_b64_tr_b16 v[106:107], v9 offset:9216
  ds_read_b64_tr_b16 v[108:109], v13 offset:8192
  ds_read_b64_tr_b16 v[110:111], v13 offset:9216
  ds_read_b128 v[64:67], v8 offset:0
  ds_read_b128 v[68:71], v8 offset:1024
  global_load_lds_dwordx4 v[118:119], off offset:1024
  v_lshl_add_u64 v[116:117], v[120:121], 0, v[116:117]
  v_lshl_add_u64 v[118:119], v[120:121], 0, v[118:119]
  s_add_u32 s52, s52, 32768
  s_cmp_eq_u32 s52, 163840
  s_cselect_b32 s52, 0, s52
  ds_read_b128 v[72:75], v8 offset:2048
  ds_read_b128 v[76:79], v8 offset:3072
  ds_read_b128 v[80:83], v8 offset:4096
  ds_read_b128 v[84:87], v8 offset:5120
  ds_read_b128 v[88:91], v8 offset:6144
  ds_read_b128 v[92:95], v8 offset:7168
  s_add_u32 s50, s50, 32768
  s_cmp_eq_u32 s50, 163840
  s_cselect_b32 s50, 0, s50
  s_waitcnt vmcnt(11) lgkmcnt(0)
  s_barrier
  v_mfma_f32_16x16x32_bf16 v[128:131], v[96:99], v[64:67], v[128:131]
  v_mfma_f32_16x16x32_bf16 v[144:147], v[96:99], v[68:71], v[144:147]
  v_mfma_f32_16x16x32_bf16 v[160:163], v[96:99], v[72:75], v[160:163]
  v_mfma_f32_16x16x32_bf16 v[176:179], v[96:99], v[76:79], v[176:179]
  v_mfma_f32_16x16x32_bf16 v[192:195], v[96:99], v[80:83], v[192:195]
  v_mfma_f32_16x16x32_bf16 v[208:211], v[96:99], v[84:87], v[208:211]
  v_mfma_f32_16x16x32_bf16 v[224:227], v[96:99], v[88:91], v[224:227]
  v_mfma_f32_16x16x32_bf16 v[240:243], v[96:99], v[92:95], v[240:243]
  v_mfma_f32_16x16x32_bf16 v[244:247], v[100:103], v[92:95], v[244:247]
  v_mfma_f32_16x16x32_bf16 v[228:231], v[100:103], v[88:91], v[228:231]
  v_mfma_f32_16x16x32_bf16 v[212:215], v[100:103], v[84:87], v[212:215]
  v_mfma_f32_16x16x32_bf16 v[196:199], v[100:103], v[80:83], v[196:199]
  v_mfma_f32_16x16x32_bf16 v[180:183], v[100:103], v[76:79], v[180:183]
  v_mfma_f32_16x16x32_bf16 v[164:167], v[100:103], v[72:75], v[164:167]
  v_mfma_f32_16x16x32_bf16 v[148:151], v[100:103], v[68:71], v[148:151]
  v_mfma_f32_16x16x32_bf16 v[132:135], v[100:103], v[64:67], v[132:135]
  v_mfma_f32_16x16x32_bf16 v[136:139], v[104:107], v[64:67], v[136:139]
  v_mfma_f32_16x16x32_bf16 v[152:155], v[104:107], v[68:71], v[152:155]
  v_mfma_f32_16x16x32_bf16 v[168:171], v[104:107], v[72:75], v[168:171]
  v_mfma_f32_16x16x32_bf16 v[184:187], v[104:107], v[76:79], v[184:187]
  v_mfma_f32_16x16x32_bf16 v[200:203], v[104:107], v[80:83], v[200:203]
  v_mfma_f32_16x16x32_bf16 v[216:219], v[104:107], v[84:87], v[216:219]
  v_mfma_f32_16x16x32_bf16 v[232:235], v[104:107], v[88:91], v[232:235]
  v_mfma_f32_16x16x32_bf16 v[248:251], v[104:107], v[92:95], v[248:251]
  v_mfma_f32_16x16x32_bf16 v[252:255], v[108:111], v[92:95], v[252:255]
  v_mfma_f32_16x16x32_bf16 v[236:239], v[108:111], v[88:91], v[236:239]
  v_mfma_f32_16x16x32_bf16 v[220:223], v[108:111], v[84:87], v[220:223]
  v_mfma_f32_16x16x32_bf16 v[204:207], v[108:111], v[80:83], v[204:207]
  v_mfma_f32_16x16x32_bf16 v[188:191], v[108:111], v[76:79], v[188:191]
  v_mfma_f32_16x16x32_bf16 v[172:175], v[108:111], v[72:75], v[172:175]
  v_mfma_f32_16x16x32_bf16 v[156:159], v[108:111], v[68:71], v[156:159]
  v_mfma_f32_16x16x32_bf16 v[140:143], v[108:111], v[64:67], v[140:143]
  s_waitcnt vmcnt(2)
  v_xor_b32 v28, s55, v28
  v_xor_b32 v29, s55, v29
  v_xor_b32 v30, s55, v30
  v_xor_b32 v31, s55, v31
  v_or3_b32 v28, v28, v29, v30
  v_or_b32 v28, v28, v31
  v_cmp_ne_u32 vcc, 0, v28
  s_nop 0
  s_cbranch_vccz POLL1_D
  s_mov_b32 s17, 0x40000
POLL1:
  buffer_load_dwordx4 v[28:31], v3, s[32:35], s18 offen sc1
  s_waitcnt vmcnt(0)
  v_xor_b32 v28, s55, v28
  v_xor_b32 v29, s55, v29
  v_xor_b32 v30, s55, v30
  v_xor_b32 v31, s55, v31
  v_or3_b32 v28, v28, v29, v30
  v_or_b32 v28, v28, v31
  v_cmp_ne_u32 vcc, 0, v28
  s_nop 0
  s_cbranch_vccz POLL1_D
  s_sleep 2
  s_sub_u32 s17, s17, 1
  s_cmp_lg_u32 s17, 0
  s_cbranch_scc1 POLL1
POLL1_D:
  s_lshl_b32 s24, s20, 13
  s_add_u32 s25, s24, 65536
  s_add_u32 s36, s32, 4194304
  s_addc_u32 s37, s33, 0
  s_mov_b32 s38, 0x40000
  s_mov_b32 s39, 0x20000
  v_add_u32 v8, s50, v6
  v_add_u32 v9, s50, v7
  v_add_u32 v13, s50, v11
  s_add_u32 m0, s25, 0
  s_add_u32 s26, s24, 0
  buffer_load_dwordx4 v3, s[36:39], s26 offen offset:0 lds
  ds_read_b64_tr_b16 v[96:97], v9 offset:0
  ds_read_b64_tr_b16 v[98:99], v9 offset:1024
  buffer_load_dwordx4 v3, s[36:39], s26 offen offset:1024 lds
  ds_read_b64_tr_b16 v[100:101], v13 offset:0
  ds_read_b64_tr_b16 v[102:103], v13 offset:1024
  buffer_load_dwordx4 v3, s[36:39], s26 offen offset:2048 lds
  ds_read_b64_tr_b16 v[104:105], v9 offset:8192
  ds_read_b64_tr_b16 v[106:107], v9 offset:9216
  buffer_load_dwordx4 v3, s[36:39], s26 offen offset:3072 lds
  ds_read_b64_tr_b16 v[108:109], v13 offset:8192
  ds_read_b64_tr_b16 v[110:111], v13 offset:9216
  s_add_u32 m0, s25, 4096
  s_add_u32 s26, s24, 4096
  buffer_load_dwordx4 v3, s[36:39], s26 offen offset:0 lds
  ds_read_b128 v[64:67], v8 offset:0
  ds_read_b128 v[68:71], v8 offset:1024
  buffer_load_dwordx4 v3, s[36:39], s26 offen offset:1024 lds
  ds_read_b128 v[72:75], v8 offset:2048
  ds_read_b128 v[76:79], v8 offset:3072
  buffer_load_dwordx4 v3, s[36:39], s26 offen offset:2048 lds
  ds_read_b128 v[80:83], v8 offset:4096
  ds_read_b128 v[84:87], v8 offset:5120
  buffer_load_dwordx4 v3, s[36:39], s26 offen offset:3072 lds
  s_add_u32 s24, s24, 32768
  s_xor_b32 s25, s25, 32768
  ds_read_b128 v[88:91], v8 offset:6144
  ds_read_b128 v[92:95], v8 offset:7168
  s_add_u32 s50, s50, 32768
  s_cmp_eq_u32 s50, 163840
  s_cselect_b32 s50, 0, s50
  s_waitcnt vmcnt(14) lgkmcnt(0)
  s_barrier
  v_mfma_f32_16x16x32_bf16 v[128:131], v[96:99], v[64:67], v[128:131]
  v_mfma_f32_16x16x32_bf16 v[144:147], v[96:99], v[68:71], v[144:147]
  v_mfma_f32_16x16x32_bf16 v[160:163], v[96:99], v[72:75], v[160:163]
  v_mfma_f32_16x16x32_bf16 v[176:179], v[96:99], v[76:79], v[176:179]
  v_mfma_f32_16x16x32_bf16 v[192:195], v[96:99], v[80:83], v[192:195]
  v_mfma_f32_16x16x32_bf16 v[208:211], v[96:99], v[84:87], v[208:211]
  v_mfma_f32_16x16x32_bf16 v[224:227], v[96:99], v[88:91], v[224:227]
  v_mfma_f32_16x16x32_bf16 v[240:243], v[96:99], v[92:95], v[240:243]
  v_mfma_f32_16x16x32_bf16 v[244:247], v[100:103], v[92:95], v[244:247]
  v_mfma_f32_16x16x32_bf16 v[228:231], v[100:103], v[88:91], v[228:231]
  v_mfma_f32_16x16x32_bf16 v[212:215], v[100:103], v[84:87], v[212:215]
  v_mfma_f32_16x16x32_bf16 v[196:199], v[100:103], v[80:83], v[196:199]
  v_mfma_f32_16x16x32_bf16 v[180:183], v[100:103], v[76:79], v[180:183]
  v_mfma_f32_16x16x32_bf16 v[164:167], v[100:103], v[72:75], v[164:167]
  v_mfma_f32_16x16x32_bf16 v[148:151], v[100:103], v[68:71], v[148:151]
  v_mfma_f32_16x16x32_bf16 v[132:135], v[100:103], v[64:67], v[132:135]
  v_mfma_f32_16x16x32_bf16 v[136:139], v[104:107], v[64:67], v[136:139]
  v_mfma_f32_16x16x32_bf16 v[152:155], v[104:107], v[68:71], v[152:155]
  v_mfma_f32_16x16x32_bf16 v[168:171], v[104:107], v[72:75], v[168:171]
  v_mfma_f32_16x16x32_bf16 v[184:187], v[104:107], v[76:79], v[184:187]
  v_mfma_f32_16x16x32_bf16 v[200:203], v[104:107], v[80:83], v[200:203]
  v_mfma_f32_16x16x32_bf16 v[216:219], v[104:107], v[84:87], v[216:219]
  v_mfma_f32_16x16x32_bf16 v[232:235], v[104:107], v[88:91], v[232:235]
  v_mfma_f32_16x16x32_bf16 v[248:251], v[104:107], v[92:95], v[248:251]
  v_mfma_f32_16x16x32_bf16 v[252:255], v[108:111], v[92:95], v[252:255]
  v_mfma_f32_16x16x32_bf16 v[236:239], v[108:111], v[88:91], v[236:239]
  v_mfma_f32_16x16x32_bf16 v[220:223], v[108:111], v[84:87], v[220:223]
  v_mfma_f32_16x16x32_bf16 v[204:207], v[108:111], v[80:83], v[204:207]
  v_mfma_f32_16x16x32_bf16 v[188:191], v[108:111], v[76:79], v[188:191]
  v_mfma_f32_16x16x32_bf16 v[172:175], v[108:111], v[72:75], v[172:175]
  v_mfma_f32_16x16x32_bf16 v[156:159], v[108:111], v[68:71], v[156:159]
  v_mfma_f32_16x16x32_bf16 v[140:143], v[108:111], v[64:67], v[140:143]
  v_add_u32 v8, s50, v6
  v_add_u32 v9, s50, v7
  v_add_u32 v13, s50, v11
  s_add_u32 m0, s25, 0
  s_add_u32 s26, s24, 0
  buffer_load_dwordx4 v3, s[36:39], s26 offen offset:0 lds
  ds_read_b64_tr_b16 v[96:97], v9 offset:0
  ds_read_b64_tr_b16 v[98:99], v9 offset:1024
  buffer_load_dwordx4 v3, s[36:39], s26 offen offset:1024 lds
  ds_read_b64_tr_b16 v[100:101], v13 offset:0
  ds_read_b64_tr_b16 v[102:103], v13 offset:1024
  buffer_load_dwordx4 v3, s[36:39], s26 offen offset:2048 lds
  ds_read_b64_tr_b16 v[104:105], v9 offset:8192
  ds_read_b64_tr_b16 v[106:107], v9 offset:9216
  buffer_load_dwordx4 v3, s[36:39], s26 offen offset:3072 lds
  ds_read_b64_tr_b16 v[108:109], v13 offset:8192
  ds_read_b64_tr_b16 v[110:111], v13 offset:9216
  s_add_u32 m0, s25, 4096
  s_add_u32 s26, s24, 4096
  buffer_load_dwordx4 v3, s[36:39], s26 offen offset:0 lds
  ds_read_b128 v[64:67], v8 offset:0
  ds_read_b128 v[68:71], v8 offset:1024
  buffer_load_dwordx4 v3, s[36:39], s26 offen offset:1024 lds
  ds_read_b128 v[72:75], v8 offset:2048
  ds_read_b128 v[76:79], v8 offset:3072
  buffer_load_dwordx4 v3, s[36:39], s26 offen offset:2048 lds
  ds_read_b128 v[80:83], v8 offset:4096
  ds_read_b128 v[84:87], v8 offset:5120
  buffer_load_dwordx4 v3, s[36:39], s26 offen offset:3072 lds
  s_add_u32 s24, s24, 32768
  s_xor_b32 s25, s25, 32768
  ds_read_b128 v[88:91], v8 offset:6144
  ds_read_b128 v[92:95], v8 offset:7168
  s_add_u32 s50, s50, 32768
  s_cmp_eq_u32 s50, 163840
  s_cselect_b32 s50, 0, s50
  s_waitcnt vmcnt(16) lgkmcnt(0)
  s_barrier
  v_mfma_f32_16x16x32_bf16 v[128:131], v[96:99], v[64:67], v[128:131]
  v_mfma_f32_16x16x32_bf16 v[144:147], v[96:99], v[68:71], v[144:147]
  v_mfma_f32_16x16x32_bf16 v[160:163], v[96:99], v[72:75], v[160:163]
  v_mfma_f32_16x16x32_bf16 v[176:179], v[96:99], v[76:79], v[176:179]
  v_mfma_f32_16x16x32_bf16 v[192:195], v[96:99], v[80:83], v[192:195]
  v_mfma_f32_16x16x32_bf16 v[208:211], v[96:99], v[84:87], v[208:211]
  v_mfma_f32_16x16x32_bf16 v[224:227], v[96:99], v[88:91], v[224:227]
  v_mfma_f32_16x16x32_bf16 v[240:243], v[96:99], v[92:95], v[240:243]
  v_mfma_f32_16x16x32_bf16 v[244:247], v[100:103], v[92:95], v[244:247]
  v_mfma_f32_16x16x32_bf16 v[228:231], v[100:103], v[88:91], v[228:231]
  v_mfma_f32_16x16x32_bf16 v[212:215], v[100:103], v[84:87], v[212:215]
  v_mfma_f32_16x16x32_bf16 v[196:199], v[100:103], v[80:83], v[196:199]
  v_mfma_f32_16x16x32_bf16 v[180:183], v[100:103], v[76:79], v[180:183]
  v_mfma_f32_16x16x32_bf16 v[164:167], v[100:103], v[72:75], v[164:167]
  v_mfma_f32_16x16x32_bf16 v[148:151], v[100:103], v[68:71], v[148:151]
  v_mfma_f32_16x16x32_bf16 v[132:135], v[100:103], v[64:67], v[132:135]
  v_mfma_f32_16x16x32_bf16 v[136:139], v[104:107], v[64:67], v[136:139]
  v_mfma_f32_16x16x32_bf16 v[152:155], v[104:107], v[68:71], v[152:155]
  v_mfma_f32_16x16x32_bf16 v[168:171], v[104:107], v[72:75], v[168:171]
  v_mfma_f32_16x16x32_bf16 v[184:187], v[104:107], v[76:79], v[184:187]
  v_mfma_f32_16x16x32_bf16 v[200:203], v[104:107], v[80:83], v[200:203]
  v_mfma_f32_16x16x32_bf16 v[216:219], v[104:107], v[84:87], v[216:219]
  v_mfma_f32_16x16x32_bf16 v[232:235], v[104:107], v[88:91], v[232:235]
  v_mfma_f32_16x16x32_bf16 v[248:251], v[104:107], v[92:95], v[248:251]
  v_mfma_f32_16x16x32_bf16 v[252:255], v[108:111], v[92:95], v[252:255]
  v_mfma_f32_16x16x32_bf16 v[236:239], v[108:111], v[88:91], v[236:239]
  v_mfma_f32_16x16x32_bf16 v[220:223], v[108:111], v[84:87], v[220:223]
  v_mfma_f32_16x16x32_bf16 v[204:207], v[108:111], v[80:83], v[204:207]
  v_mfma_f32_16x16x32_bf16 v[188:191], v[108:111], v[76:79], v[188:191]
  v_mfma_f32_16x16x32_bf16 v[172:175], v[108:111], v[72:75], v[172:175]
  v_mfma_f32_16x16x32_bf16 v[156:159], v[108:111], v[68:71], v[156:159]
  v_mfma_f32_16x16x32_bf16 v[140:143], v[108:111], v[64:67], v[140:143]
  v_add_u32 v8, s50, v6
  v_add_u32 v9, s50, v7
  v_add_u32 v13, s50, v11
  ds_read_b64_tr_b16 v[96:97], v9 offset:0
  ds_read_b64_tr_b16 v[98:99], v9 offset:1024
  ds_read_b64_tr_b16 v[100:101], v13 offset:0
  ds_read_b64_tr_b16 v[102:103], v13 offset:1024
  ds_read_b64_tr_b16 v[104:105], v9 offset:8192
  ds_read_b64_tr_b16 v[106:107], v9 offset:9216
  ds_read_b64_tr_b16 v[108:109], v13 offset:8192
  ds_read_b64_tr_b16 v[110:111], v13 offset:9216
  ds_read_b128 v[64:67], v8 offset:0
  ds_read_b128 v[68:71], v8 offset:1024
  ds_read_b128 v[72:75], v8 offset:2048
  ds_read_b128 v[76:79], v8 offset:3072
  ds_read_b128 v[80:83], v8 offset:4096
  ds_read_b128 v[84:87], v8 offset:5120
  ds_read_b128 v[88:91], v8 offset:6144
  ds_read_b128 v[92:95], v8 offset:7168
  s_add_u32 s50, s50, 32768
  s_cmp_eq_u32 s50, 163840
  s_cselect_b32 s50, 0, s50
  s_waitcnt vmcnt(16) lgkmcnt(0)
  s_barrier
  v_mfma_f32_16x16x32_bf16 v[128:131], v[96:99], v[64:67], v[128:131]
  v_mfma_f32_16x16x32_bf16 v[144:147], v[96:99], v[68:71], v[144:147]
  v_mfma_f32_16x16x32_bf16 v[160:163], v[96:99], v[72:75], v[160:163]
  v_mfma_f32_16x16x32_bf16 v[176:179], v[96:99], v[76:79], v[176:179]
  v_mfma_f32_16x16x32_bf16 v[192:195], v[96:99], v[80:83], v[192:195]
  v_mfma_f32_16x16x32_bf16 v[208:211], v[96:99], v[84:87], v[208:211]
  v_mfma_f32_16x16x32_bf16 v[224:227], v[96:99], v[88:91], v[224:227]
  v_mfma_f32_16x16x32_bf16 v[240:243], v[96:99], v[92:95], v[240:243]
  v_mfma_f32_16x16x32_bf16 v[244:247], v[100:103], v[92:95], v[244:247]
  v_mfma_f32_16x16x32_bf16 v[228:231], v[100:103], v[88:91], v[228:231]
  v_mfma_f32_16x16x32_bf16 v[212:215], v[100:103], v[84:87], v[212:215]
  v_mfma_f32_16x16x32_bf16 v[196:199], v[100:103], v[80:83], v[196:199]
  v_mfma_f32_16x16x32_bf16 v[180:183], v[100:103], v[76:79], v[180:183]
  v_mfma_f32_16x16x32_bf16 v[164:167], v[100:103], v[72:75], v[164:167]
  v_mfma_f32_16x16x32_bf16 v[148:151], v[100:103], v[68:71], v[148:151]
  v_mfma_f32_16x16x32_bf16 v[132:135], v[100:103], v[64:67], v[132:135]
  v_mfma_f32_16x16x32_bf16 v[136:139], v[104:107], v[64:67], v[136:139]
  v_mfma_f32_16x16x32_bf16 v[152:155], v[104:107], v[68:71], v[152:155]
  v_mfma_f32_16x16x32_bf16 v[168:171], v[104:107], v[72:75], v[168:171]
  v_mfma_f32_16x16x32_bf16 v[184:187], v[104:107], v[76:79], v[184:187]
  v_mfma_f32_16x16x32_bf16 v[200:203], v[104:107], v[80:83], v[200:203]
  v_mfma_f32_16x16x32_bf16 v[216:219], v[104:107], v[84:87], v[216:219]
  v_mfma_f32_16x16x32_bf16 v[232:235], v[104:107], v[88:91], v[232:235]
  v_mfma_f32_16x16x32_bf16 v[248:251], v[104:107], v[92:95], v[248:251]
  v_mfma_f32_16x16x32_bf16 v[252:255], v[108:111], v[92:95], v[252:255]
  v_mfma_f32_16x16x32_bf16 v[236:239], v[108:111], v[88:91], v[236:239]
  v_mfma_f32_16x16x32_bf16 v[220:223], v[108:111], v[84:87], v[220:223]
  v_mfma_f32_16x16x32_bf16 v[204:207], v[108:111], v[80:83], v[204:207]
  v_mfma_f32_16x16x32_bf16 v[188:191], v[108:111], v[76:79], v[188:191]
  v_mfma_f32_16x16x32_bf16 v[172:175], v[108:111], v[72:75], v[172:175]
  v_mfma_f32_16x16x32_bf16 v[156:159], v[108:111], v[68:71], v[156:159]
  v_mfma_f32_16x16x32_bf16 v[140:143], v[108:111], v[64:67], v[140:143]
  s_branch G1_EPI
G1_B:
  s_add_u32 m0, s47, s45
  s_nop 0
  buffer_load_dwordx4 v3, s[32:35], s44 offen lds
  buffer_load_dwordx4 v10, s[32:35], s44 offen offset:1024 lds
  s_add_u32 s44, s44, 1024
  s_add_u32 s47, s47, 32768
  s_cmp_eq_u32 s47, 163840
  s_cselect_b32 s47, 0, s47
  s_add_u32 m0, s52, s46
  s_nop 0
  global_load_lds_dwordx4 v[116:117], off
  global_load_lds_dwordx4 v[118:119], off offset:1024
  v_lshl_add_u64 v[116:117], v[120:121], 0, v[116:117]
  v_lshl_add_u64 v[118:119], v[120:121], 0, v[118:119]
  s_add_u32 s52, s52, 32768
  s_cmp_eq_u32 s52, 163840
  s_cselect_b32 s52, 0, s52
  s_add_u32 m0, s47, s45
  s_nop 0
  buffer_load_dwordx4 v3, s[32:35], s44 offen lds
  buffer_load_dwordx4 v10, s[32:35], s44 offen offset:1024 lds
  s_add_u32 s44, s44, 1024
  s_add_u32 s47, s47, 32768
  s_cmp_eq_u32 s47, 163840
  s_cselect_b32 s47, 0, s47
  s_lshr_b32 s17, s20, 2
  s_lshl_b32 s16, s17, 13
  v_add_u32 v6, s16, v3
  s_and_b32 s19, s21, 1
  s_lshl_b32 s16, s23, 1
  s_add_u32 s40, s16, s19
  s_add_u32 s41, s40, 1
  s_mul_i32 s16, s19, 6
  s_sub_u32 s16, 6, s16
  s_cmp_eq_u32 s23, 3
  s_cselect_b32 s40, s16, s40
  s_cselect_b32 s41, 7, s41
  v_lshrrev_b32 v2, 4, v1
  v_lshlrev_b32 v7, 11, v2
  v_and_b32 v2, 1, v2
  v_lshlrev_b32 v12, 2, v2
  v_bfe_u32 v2, v1, 2, 2
  v_lshl_add_u32 v7, v2, 8, v7
  v_add_u32 v12, v12, v2
  v_and_b32 v2, 3, v1
  v_lshl_add_u32 v7, v2, 3, v7
  v_add_u32 v7, 16384, v7
  v_xor_b32 v2, s41, v12
  v_lshl_add_u32 v11, v2, 5, v7
  v_xor_b32 v2, s40, v12
  v_lshl_add_u32 v7, v2, 5, v7
  s_waitcnt vmcnt(4)
  s_barrier
  s_add_u32 m0, s52, s46
  s_nop 0
  global_load_lds_dwordx4 v[116:117], off
  global_load_lds_dwordx4 v[118:119], off offset:1024
  v_lshl_add_u64 v[116:117], v[120:121], 0, v[116:117]
  v_lshl_add_u64 v[118:119], v[120:121], 0, v[118:119]
  s_add_u32 s52, s52, 32768
  s_cmp_eq_u32 s52, 163840
  s_cselect_b32 s52, 0, s52
  s_add_u32 m0, s47, s45
  s_nop 0
  buffer_load_dwordx4 v3, s[32:35], s44 offen lds
  buffer_load_dwordx4 v10, s[32:35], s44 offen offset:1024 lds
  s_add_u32 s44, s44, 1024
  s_add_u32 s47, s47, 32768
  s_cmp_eq_u32 s47, 163840
  s_cselect_b32 s47, 0, s47
  s_add_u32 m0, s52, s46
  s_nop 0
  global_load_lds_dwordx4 v[116:117], off
  global_load_lds_dwordx4 v[118:119], off offset:1024
  v_lshl_add_u64 v[116:117], v[120:121], 0, v[116:117]
  v_lshl_add_u64 v[118:119], v[120:121], 0, v[118:119]
  s_add_u32 s52, s52, 32768
  s_cmp_eq_u32 s52, 163840
  s_cselect_b32 s52, 0, s52
  s_add_u32 m0, s47, s45
  s_nop 0
  buffer_load_dwordx4 v3, s[32:35], s44 offen lds
  buffer_load_dwordx4 v10, s[32:35], s44 offen offset:1024 lds
  s_add_u32 s44, s44, 1024
  s_add_u32 s47, s47, 32768
  s_cmp_eq_u32 s47, 163840
  s_cselect_b32 s47, 0, s47
  s_barrier
  v_add_u32 v8, s50, v6
  v_add_u32 v9, s50, v7
  v_add_u32 v13, s50, v11
  s_add_u32 m0, s52, s46
  s_nop 0
  global_load_lds_dwordx4 v[116:117], off
  ds_read_b64_tr_b16 v[96:97], v9 offset:0
  ds_read_b64_tr_b16 v[98:99], v9 offset:1024
  ds_read_b64_tr_b16 v[100:101], v13 offset:0
  global_load_lds_dwordx4 v[118:119], off offset:1024
  ds_read_b64_tr_b16 v[102:103], v13 offset:1024
  ds_read_b64_tr_b16 v[104:105], v9 offset:8192
  ds_read_b64_tr_b16 v[106:107], v9 offset:9216
  v_lshl_add_u64 v[116:117], v[120:121], 0, v[116:117]
  v_lshl_add_u64 v[118:119], v[120:121], 0, v[118:119]
  s_add_u32 s52, s52, 32768
  s_cmp_eq_u32 s52, 163840
  s_cselect_b32 s52, 0, s52
  s_add_u32 m0, s47, s45
  s_nop 0
  buffer_load_dwordx4 v3, s[32:35], s44 offen lds
  ds_read_b64_tr_b16 v[108:109], v13 offset:8192
  ds_read_b64_tr_b16 v[110:111], v13 offset:9216
  ds_read_b128 v[64:67], v8 offset:0
  buffer_load_dwordx4 v10, s[32:35], s44 offen offset:1024 lds
  ds_read_b128 v[68:71], v8 offset:1024
  ds_read_b128 v[72:75], v8 offset:2048
  ds_read_b128 v[76:79], v8 offset:3072
  s_add_u32 s44, s44, 1024
  s_add_u32 s47, s47, 32768
  s_cmp_eq_u32 s47, 163840
  s_cselect_b32 s47, 0, s47
  buffer_load_dword v16, v14, s[24:27], s30 offen
  s_add_u32 s30, s30, s31
  ds_read_b128 v[80:83], v8 offset:4096
  ds_read_b128 v[84:87], v8 offset:5120
  ds_read_b128 v[88:91], v8 offset:6144
  ds_read_b128 v[92:95], v8 offset:7168
  s_add_u32 s50, s50, 32768
  s_cmp_eq_u32 s50, 163840
  s_cselect_b32 s50, 0, s50
  s_waitcnt vmcnt(13)
  s_barrier
  s_waitcnt lgkmcnt(0)
  v_mfma_f32_16x16x32_bf16 v[128:131], v[96:99], v[64:67], 0
  v_mfma_f32_16x16x32_bf16 v[144:147], v[96:99], v[68:71], 0
  v_mfma_f32_16x16x32_bf16 v[160:163], v[96:99], v[72:75], 0
  v_mfma_f32_16x16x32_bf16 v[176:179], v[96:99], v[76:79], 0
  v_mfma_f32_16x16x32_bf16 v[192:195], v[96:99], v[80:83], 0
  v_mfma_f32_16x16x32_bf16 v[208:211], v[96:99], v[84:87], 0
  v_mfma_f32_16x16x32_bf16 v[224:227], v[96:99], v[88:91], 0
  v_mfma_f32_16x16x32_bf16 v[240:243], v[96:99], v[92:95], 0
  v_mfma_f32_16x16x32_bf16 v[244:247], v[100:103], v[92:95], 0
  v_mfma_f32_16x16x32_bf16 v[228:231], v[100:103], v[88:91], 0
  v_mfma_f32_16x16x32_bf16 v[212:215], v[100:103], v[84:87], 0
  v_mfma_f32_16x16x32_bf16 v[196:199], v[100:103], v[80:83], 0
  v_mfma_f32_16x16x32_bf16 v[180:183], v[100:103], v[76:79], 0
  v_mfma_f32_16x16x32_bf16 v[164:167], v[100:103], v[72:75], 0
  v_mfma_f32_16x16x32_bf16 v[148:151], v[100:103], v[68:71], 0
  v_mfma_f32_16x16x32_bf16 v[132:135], v[100:103], v[64:67], 0
  v_mfma_f32_16x16x32_bf16 v[136:139], v[104:107], v[64:67], 0
  v_mfma_f32_16x16x32_bf16 v[152:155], v[104:107], v[68:71], 0
  v_mfma_f32_16x16x32_bf16 v[168:171], v[104:107], v[72:75], 0
  v_mfma_f32_16x16x32_bf16 v[184:187], v[104:107], v[76:79], 0
  v_mfma_f32_16x16x32_bf16 v[200:203], v[104:107], v[80:83], 0
  v_mfma_f32_16x16x32_bf16 v[216:219], v[104:107], v[84:87], 0
  v_mfma_f32_16x16x32_bf16 v[232:235], v[104:107], v[88:91], 0
  v_mfma_f32_16x16x32_bf16 v[248:251], v[104:107], v[92:95], 0
  v_mfma_f32_16x16x32_bf16 v[252:255], v[108:111], v[92:95], 0
  v_mfma_f32_16x16x32_bf16 v[236:239], v[108:111], v[88:91], 0
  v_mfma_f32_16x16x32_bf16 v[220:223], v[108:111], v[84:87], 0
  v_mfma_f32_16x16x32_bf16 v[204:207], v[108:111], v[80:83], 0
  v_mfma_f32_16x16x32_bf16 v[188:191], v[108:111], v[76:79], 0
  v_mfma_f32_16x16x32_bf16 v[172:175], v[108:111], v[72:75], 0
  v_mfma_f32_16x16x32_bf16 v[156:159], v[108:111], v[68:71], 0
  v_mfma_f32_16x16x32_bf16 v[140:143], v[108:111], v[64:67], 0
  s_waitcnt vmcnt(9)
  s_barrier
  v_add_u32 v8, s50, v6
  v_add_u32 v9, s50, v7
  v_add_u32 v13, s50, v11
  s_add_u32 m0, s52, s46
  s_nop 0
  global_load_lds_dwordx4 v[116:117], off
  ds_read_b64_tr_b16 v[96:97], v9 offset:0
  ds_read_b64_tr_b16 v[98:99], v9 offset:1024
  ds_read_b64_tr_b16 v[100:101], v13 offset:0
  global_load_lds_dwordx4 v[118:119], off offset:1024
  ds_read_b64_tr_b16 v[102:103], v13 offset:1024
  ds_read_b64_tr_b16 v[104:105], v9 offset:8192
  ds_read_b64_tr_b16 v[106:107], v9 offset:9216
  v_lshl_add_u64 v[116:117], v[120:121], 0, v[116:117]
  v_lshl_add_u64 v[118:119], v[120:121], 0, v[118:119]
  s_add_u32 s52, s52, 32768
  s_cmp_eq_u32 s52, 163840
  s_cselect_b32 s52, 0, s52
  s_add_u32 m0, s47, s45
  s_nop 0
  buffer_load_dwordx4 v3, s[32:35], s44 offen lds
  ds_read_b64_tr_b16 v[108:109], v13 offset:8192
  ds_read_b64_tr_b16 v[110:111], v13 offset:9216
  ds_read_b128 v[64:67], v8 offset:0
  buffer_load_dwordx4 v10, s[32:35], s44 offen offset:1024 lds
  ds_read_b128 v[68:71], v8 offset:1024
  ds_read_b128 v[72:75], v8 offset:2048
  ds_read_b128 v[76:79], v8 offset:3072
  s_add_u32 s44, s44, 1024
  s_add_u32 s47, s47, 32768
  s_cmp_eq_u32 s47, 163840
  s_cselect_b32 s47, 0, s47
  buffer_load_dword v16, v14, s[24:27], s30 offen
  s_add_u32 s30, s30, s31
  ds_read_b128 v[80:83], v8 offset:4096
  ds_read_b128 v[84:87], v8 offset:5120
  ds_read_b128 v[88:91], v8 offset:6144
  ds_read_b128 v[92:95], v8 offset:7168
  s_add_u32 s50, s50, 32768
  s_cmp_eq_u32 s50, 163840
  s_cselect_b32 s50, 0, s50
  s_waitcnt lgkmcnt(0)
  v_mfma_f32_16x16x32_bf16 v[128:131], v[96:99], v[64:67], v[128:131]
  v_mfma_f32_16x16x32_bf16 v[144:147], v[96:99], v[68:71], v[144:147]
  v_mfma_f32_16x16x32_bf16 v[160:163], v[96:99], v[72:75], v[160:163]
  v_mfma_f32_16x16x32_bf16 v[176:179], v[96:99], v[76:79], v[176:179]
  v_mfma_f32_16x16x32_bf16 v[192:195], v[96:99], v[80:83], v[192:195]
  v_mfma_f32_16x16x32_bf16 v[208:211], v[96:99], v[84:87], v[208:211]
  v_mfma_f32_16x16x32_bf16 v[224:227], v[96:99], v[88:91], v[224:227]
  v_mfma_f32_16x16x32_bf16 v[240:243], v[96:99], v[92:95], v[240:243]
  v_mfma_f32_16x16x32_bf16 v[244:247], v[100:103], v[92:95], v[244:247]
  v_mfma_f32_16x16x32_bf16 v[228:231], v[100:103], v[88:91], v[228:231]
  v_mfma_f32_16x16x32_bf16 v[212:215], v[100:103], v[84:87], v[212:215]
  v_mfma_f32_16x16x32_bf16 v[196:199], v[100:103], v[80:83], v[196:199]
  v_mfma_f32_16x16x32_bf16 v[180:183], v[100:103], v[76:79], v[180:183]
  v_mfma_f32_16x16x32_bf16 v[164:167], v[100:103], v[72:75], v[164:167]
  v_mfma_f32_16x16x32_bf16 v[148:151], v[100:103], v[68:71], v[148:151]
  v_mfma_f32_16x16x32_bf16 v[132:135], v[100:103], v[64:67], v[132:135]
  v_mfma_f32_16x16x32_bf16 v[136:139], v[104:107], v[64:67], v[136:139]
  v_mfma_f32_16x16x32_bf16 v[152:155], v[104:107], v[68:71], v[152:155]
  v_mfma_f32_16x16x32_bf16 v[168:171], v[104:107], v[72:75], v[168:171]
  v_mfma_f32_16x16x32_bf16 v[184:187], v[104:107], v[76:79], v[184:187]
  v_mfma_f32_16x16x32_bf16 v[200:203], v[104:107], v[80:83], v[200:203]
  v_mfma_f32_16x16x32_bf16 v[216:219], v[104:107], v[84:87], v[216:219]
  v_mfma_f32_16x16x32_bf16 v[232:235], v[104:107], v[88:91], v[232:235]
  v_mfma_f32_16x16x32_bf16 v[248:251], v[104:107], v[92:95], v[248:251]
  v_mfma_f32_16x16x32_bf16 v[252:255], v[108:111], v[92:95], v[252:255]
  v_mfma_f32_16x16x32_bf16 v[236:239], v[108:111], v[88:91], v[236:239]
  v_mfma_f32_16x16x32_bf16 v[220:223], v[108:111], v[84:87], v[220:223]
  v_mfma_f32_16x16x32_bf16 v[204:207], v[108:111], v[80:83], v[204:207]
  v_mfma_f32_16x16x32_bf16 v[188:191], v[108:111], v[76:79], v[188:191]
  v_mfma_f32_16x16x32_bf16 v[172:175], v[108:111], v[72:75], v[172:175]
  v_mfma_f32_16x16x32_bf16 v[156:159], v[108:111], v[68:71], v[156:159]
  v_mfma_f32_16x16x32_bf16 v[140:143], v[108:111], v[64:67], v[140:143]
  s_waitcnt vmcnt(10)
  s_barrier
  s_mov_b32 s51, 26
G1_B_LOOP:
  v_add_u32 v8, s50, v6
  v_add_u32 v9, s50, v7
  v_add_u32 v13, s50, v11
  s_add_u32 m0, s52, s46
  s_nop 0
  global_load_lds_dwordx4 v[116:117], off
  ds_read_b64_tr_b16 v[96:97], v9 offset:0
  ds_read_b64_tr_b16 v[98:99], v9 offset:1024
  ds_read_b64_tr_b16 v[100:101], v13 offset:0
  global_load_lds_dwordx4 v[118:119], off offset:1024
  ds_read_b64_tr_b16 v[102:103], v13 offset:1024
  ds_read_b64_tr_b16 v[104:105], v9 offset:8192
  ds_read_b64_tr_b16 v[106:107], v9 offset:9216
  v_lshl_add_u64 v[116:117], v[120:121], 0, v[116:117]
  v_lshl_add_u64 v[118:119], v[120:121], 0, v[118:119]
  s_add_u32 s52, s52, 32768
  s_cmp_eq_u32 s52, 163840
  s_cselect_b32 s52, 0, s52
  s_add_u32 m0, s47, s45
  s_nop 0
  buffer_load_dwordx4 v3, s[32:35], s44 offen lds
  ds_read_b64_tr_b16 v[108:109], v13 offset:8192
  ds_read_b64_tr_b16 v[110:111], v13 offset:9216
  ds_read_b128 v[64:67], v8 offset:0
  buffer_load_dwordx4 v10, s[32:35], s44 offen offset:1024 lds
  ds_read_b128 v[68:71], v8 offset:1024
  ds_read_b128 v[72:75], v8 offset:2048
  ds_read_b128 v[76:79], v8 offset:3072
  s_add_u32 s44, s44, 1024
  s_add_u32 s47, s47, 32768
  s_cmp_eq_u32 s47, 163840
  s_cselect_b32 s47, 0, s47
  buffer_load_dword v16, v14, s[24:27], s30 offen
  s_add_u32 s30, s30, s31
  ds_read_b128 v[80:83], v8 offset:4096
  ds_read_b128 v[84:87], v8 offset:5120
  ds_read_b128 v[88:91], v8 offset:6144
  ds_read_b128 v[92:95], v8 offset:7168
  s_add_u32 s50, s50, 32768
  s_cmp_eq_u32 s50, 163840
  s_cselect_b32 s50, 0, s50
  s_waitcnt lgkmcnt(0)
  v_mfma_f32_16x16x32_bf16 v[128:131], v[96:99], v[64:67], v[128:131]
  v_mfma_f32_16x16x32_bf16 v[144:147], v[96:99], v[68:71], v[144:147]
  v_mfma_f32_16x16x32_bf16 v[160:163], v[96:99], v[72:75], v[160:163]
  v_mfma_f32_16x16x32_bf16 v[176:179], v[96:99], v[76:79], v[176:179]
  v_mfma_f32_16x16x32_bf16 v[192:195], v[96:99], v[80:83], v[192:195]
  v_mfma_f32_16x16x32_bf16 v[208:211], v[96:99], v[84:87], v[208:211]
  v_mfma_f32_16x16x32_bf16 v[224:227], v[96:99], v[88:91], v[224:227]
  v_mfma_f32_16x16x32_bf16 v[240:243], v[96:99], v[92:95], v[240:243]
  v_mfma_f32_16x16x32_bf16 v[244:247], v[100:103], v[92:95], v[244:247]
  v_mfma_f32_16x16x32_bf16 v[228:231], v[100:103], v[88:91], v[228:231]
  v_mfma_f32_16x16x32_bf16 v[212:215], v[100:103], v[84:87], v[212:215]
  v_mfma_f32_16x16x32_bf16 v[196:199], v[100:103], v[80:83], v[196:199]
  v_mfma_f32_16x16x32_bf16 v[180:183], v[100:103], v[76:79], v[180:183]
  v_mfma_f32_16x16x32_bf16 v[164:167], v[100:103], v[72:75], v[164:167]
  v_mfma_f32_16x16x32_bf16 v[148:151], v[100:103], v[68:71], v[148:151]
  v_mfma_f32_16x16x32_bf16 v[132:135], v[100:103], v[64:67], v[132:135]
  v_mfma_f32_16x16x32_bf16 v[136:139], v[104:107], v[64:67], v[136:139]
  v_mfma_f32_16x16x32_bf16 v[152:155], v[104:107], v[68:71], v[152:155]
  v_mfma_f32_16x16x32_bf16 v[168:171], v[104:107], v[72:75], v[168:171]
  v_mfma_f32_16x16x32_bf16 v[184:187], v[104:107], v[76:79], v[184:187]
  v_mfma_f32_16x16x32_bf16 v[200:203], v[104:107], v[80:83], v[200:203]
  v_mfma_f32_16x16x32_bf16 v[216:219], v[104:107], v[84:87], v[216:219]
  v_mfma_f32_16x16x32_bf16 v[232:235], v[104:107], v[88:91], v[232:235]
  v_mfma_f32_16x16x32_bf16 v[248:251], v[104:107], v[92:95], v[248:251]
  v_mfma_f32_16x16x32_bf16 v[252:255], v[108:111], v[92:95], v[252:255]
  v_mfma_f32_16x16x32_bf16 v[236:239], v[108:111], v[88:91], v[236:239]
  v_mfma_f32_16x16x32_bf16 v[220:223], v[108:111], v[84:87], v[220:223]
  v_mfma_f32_16x16x32_bf16 v[204:207], v[108:111], v[80:83], v[204:207]
  v_mfma_f32_16x16x32_bf16 v[188:191], v[108:111], v[76:79], v[188:191]
  v_mfma_f32_16x16x32_bf16 v[172:175], v[108:111], v[72:75], v[172:175]
  v_mfma_f32_16x16x32_bf16 v[156:159], v[108:111], v[68:71], v[156:159]
  v_mfma_f32_16x16x32_bf16 v[140:143], v[108:111], v[64:67], v[140:143]
  s_waitcnt vmcnt(11)
  s_barrier
  s_sub_u32 s51, s51, 1
  s_cmp_lg_u32 s51, 0
  s_cbranch_scc1 G1_B_LOOP
  v_add_u32 v8, s50, v6
  v_add_u32 v9, s50, v7
  v_add_u32 v13, s50, v11
  ds_read_b64_tr_b16 v[96:97], v9 offset:0
  ds_read_b64_tr_b16 v[98:99], v9 offset:1024
  ds_read_b64_tr_b16 v[100:101], v13 offset:0
  ds_read_b64_tr_b16 v[102:103], v13 offset:1024
  ds_read_b64_tr_b16 v[104:105], v9 offset:8192
  ds_read_b64_tr_b16 v[106:107], v9 offset:9216
  ds_read_b64_tr_b16 v[108:109], v13 offset:8192
  ds_read_b64_tr_b16 v[110:111], v13 offset:9216
  ds_read_b128 v[64:67], v8 offset:0
  ds_read_b128 v[68:71], v8 offset:1024
  ds_read_b128 v[72:75], v8 offset:2048
  ds_read_b128 v[76:79], v8 offset:3072
  ds_read_b128 v[80:83], v8 offset:4096
  ds_read_b128 v[84:87], v8 offset:5120
  ds_read_b128 v[88:91], v8 offset:6144
  ds_read_b128 v[92:95], v8 offset:7168
  s_add_u32 s50, s50, 32768
  s_cmp_eq_u32 s50, 163840
  s_cselect_b32 s50, 0, s50
  s_waitcnt lgkmcnt(0)
  v_mfma_f32_16x16x32_bf16 v[128:131], v[96:99], v[64:67], v[128:131]
  v_mfma_f32_16x16x32_bf16 v[144:147], v[96:99], v[68:71], v[144:147]
  v_mfma_f32_16x16x32_bf16 v[160:163], v[96:99], v[72:75], v[160:163]
  v_mfma_f32_16x16x32_bf16 v[176:179], v[96:99], v[76:79], v[176:179]
  v_mfma_f32_16x16x32_bf16 v[192:195], v[96:99], v[80:83], v[192:195]
  v_mfma_f32_16x16x32_bf16 v[208:211], v[96:99], v[84:87], v[208:211]
  v_mfma_f32_16x16x32_bf16 v[224:227], v[96:99], v[88:91], v[224:227]
  v_mfma_f32_16x16x32_bf16 v[240:243], v[96:99], v[92:95], v[240:243]
  v_mfma_f32_16x16x32_bf16 v[244:247], v[100:103], v[92:95], v[244:247]
  v_mfma_f32_16x16x32_bf16 v[228:231], v[100:103], v[88:91], v[228:231]
  v_mfma_f32_16x16x32_bf16 v[212:215], v[100:103], v[84:87], v[212:215]
  v_mfma_f32_16x16x32_bf16 v[196:199], v[100:103], v[80:83], v[196:199]
  v_mfma_f32_16x16x32_bf16 v[180:183], v[100:103], v[76:79], v[180:183]
  v_mfma_f32_16x16x32_bf16 v[164:167], v[100:103], v[72:75], v[164:167]
  v_mfma_f32_16x16x32_bf16 v[148:151], v[100:103], v[68:71], v[148:151]
  v_mfma_f32_16x16x32_bf16 v[132:135], v[100:103], v[64:67], v[132:135]
  v_mfma_f32_16x16x32_bf16 v[136:139], v[104:107], v[64:67], v[136:139]
  v_mfma_f32_16x16x32_bf16 v[152:155], v[104:107], v[68:71], v[152:155]
  v_mfma_f32_16x16x32_bf16 v[168:171], v[104:107], v[72:75], v[168:171]
  v_mfma_f32_16x16x32_bf16 v[184:187], v[104:107], v[76:79], v[184:187]
  v_mfma_f32_16x16x32_bf16 v[200:203], v[104:107], v[80:83], v[200:203]
  v_mfma_f32_16x16x32_bf16 v[216:219], v[104:107], v[84:87], v[216:219]
  v_mfma_f32_16x16x32_bf16 v[232:235], v[104:107], v[88:91], v[232:235]
  v_mfma_f32_16x16x32_bf16 v[248:251], v[104:107], v[92:95], v[248:251]
  v_mfma_f32_16x16x32_bf16 v[252:255], v[108:111], v[92:95], v[252:255]
  v_mfma_f32_16x16x32_bf16 v[236:239], v[108:111], v[88:91], v[236:239]
  v_mfma_f32_16x16x32_bf16 v[220:223], v[108:111], v[84:87], v[220:223]
  v_mfma_f32_16x16x32_bf16 v[204:207], v[108:111], v[80:83], v[204:207]
  v_mfma_f32_16x16x32_bf16 v[188:191], v[108:111], v[76:79], v[188:191]
  v_mfma_f32_16x16x32_bf16 v[172:175], v[108:111], v[72:75], v[172:175]
  v_mfma_f32_16x16x32_bf16 v[156:159], v[108:111], v[68:71], v[156:159]
  v_mfma_f32_16x16x32_bf16 v[140:143], v[108:111], v[64:67], v[140:143]
  s_waitcnt vmcnt(6)
  s_barrier
  v_add_u32 v8, s50, v6
  v_add_u32 v9, s50, v7
  v_add_u32 v13, s50, v11
  ds_read_b64_tr_b16 v[96:97], v9 offset:0
  ds_read_b64_tr_b16 v[98:99], v9 offset:1024
  ds_read_b64_tr_b16 v[100:101], v13 offset:0
  ds_read_b64_tr_b16 v[102:103], v13 offset:1024
  ds_read_b64_tr_b16 v[104:105], v9 offset:8192
  ds_read_b64_tr_b16 v[106:107], v9 offset:9216
  ds_read_b64_tr_b16 v[108:109], v13 offset:8192
  ds_read_b64_tr_b16 v[110:111], v13 offset:9216
  ds_read_b128 v[64:67], v8 offset:0
  ds_read_b128 v[68:71], v8 offset:1024
  ds_read_b128 v[72:75], v8 offset:2048
  ds_read_b128 v[76:79], v8 offset:3072
  ds_read_b128 v[80:83], v8 offset:4096
  ds_read_b128 v[84:87], v8 offset:5120
  ds_read_b128 v[88:91], v8 offset:6144
  ds_read_b128 v[92:95], v8 offset:7168
  s_add_u32 s50, s50, 32768
  s_cmp_eq_u32 s50, 163840
  s_cselect_b32 s50, 0, s50
  s_waitcnt lgkmcnt(0)
  v_mfma_f32_16x16x32_bf16 v[128:131], v[96:99], v[64:67], v[128:131]
  v_mfma_f32_16x16x32_bf16 v[144:147], v[96:99], v[68:71], v[144:147]
  v_mfma_f32_16x16x32_bf16 v[160:163], v[96:99], v[72:75], v[160:163]
  v_mfma_f32_16x16x32_bf16 v[176:179], v[96:99], v[76:79], v[176:179]
  v_mfma_f32_16x16x32_bf16 v[192:195], v[96:99], v[80:83], v[192:195]
  v_mfma_f32_16x16x32_bf16 v[208:211], v[96:99], v[84:87], v[208:211]
  v_mfma_f32_16x16x32_bf16 v[224:227], v[96:99], v[88:91], v[224:227]
  v_mfma_f32_16x16x32_bf16 v[240:243], v[96:99], v[92:95], v[240:243]
  v_mfma_f32_16x16x32_bf16 v[244:247], v[100:103], v[92:95], v[244:247]
  v_mfma_f32_16x16x32_bf16 v[228:231], v[100:103], v[88:91], v[228:231]
  v_mfma_f32_16x16x32_bf16 v[212:215], v[100:103], v[84:87], v[212:215]
  v_mfma_f32_16x16x32_bf16 v[196:199], v[100:103], v[80:83], v[196:199]
  v_mfma_f32_16x16x32_bf16 v[180:183], v[100:103], v[76:79], v[180:183]
  v_mfma_f32_16x16x32_bf16 v[164:167], v[100:103], v[72:75], v[164:167]
  v_mfma_f32_16x16x32_bf16 v[148:151], v[100:103], v[68:71], v[148:151]
  v_mfma_f32_16x16x32_bf16 v[132:135], v[100:103], v[64:67], v[132:135]
  v_mfma_f32_16x16x32_bf16 v[136:139], v[104:107], v[64:67], v[136:139]
  v_mfma_f32_16x16x32_bf16 v[152:155], v[104:107], v[68:71], v[152:155]
  v_mfma_f32_16x16x32_bf16 v[168:171], v[104:107], v[72:75], v[168:171]
  v_mfma_f32_16x16x32_bf16 v[184:187], v[104:107], v[76:79], v[184:187]
  v_mfma_f32_16x16x32_bf16 v[200:203], v[104:107], v[80:83], v[200:203]
  v_mfma_f32_16x16x32_bf16 v[216:219], v[104:107], v[84:87], v[216:219]
  v_mfma_f32_16x16x32_bf16 v[232:235], v[104:107], v[88:91], v[232:235]
  v_mfma_f32_16x16x32_bf16 v[248:251], v[104:107], v[92:95], v[248:251]
  v_mfma_f32_16x16x32_bf16 v[252:255], v[108:111], v[92:95], v[252:255]
  v_mfma_f32_16x16x32_bf16 v[236:239], v[108:111], v[88:91], v[236:239]
  v_mfma_f32_16x16x32_bf16 v[220:223], v[108:111], v[84:87], v[220:223]
  v_mfma_f32_16x16x32_bf16 v[204:207], v[108:111], v[80:83], v[204:207]
  v_mfma_f32_16x16x32_bf16 v[188:191], v[108:111], v[76:79], v[188:191]
  v_mfma_f32_16x16x32_bf16 v[172:175], v[108:111], v[72:75], v[172:175]
  v_mfma_f32_16x16x32_bf16 v[156:159], v[108:111], v[68:71], v[156:159]
  v_mfma_f32_16x16x32_bf16 v[140:143], v[108:111], v[64:67], v[140:143]
  s_waitcnt vmcnt(1)
  s_barrier
  v_add_u32 v8, s50, v6
  v_add_u32 v9, s50, v7
  v_add_u32 v13, s50, v11
  ds_read_b64_tr_b16 v[96:97], v9 offset:0
  ds_read_b64_tr_b16 v[98:99], v9 offset:1024
  ds_read_b64_tr_b16 v[100:101], v13 offset:0
  ds_read_b64_tr_b16 v[102:103], v13 offset:1024
  ds_read_b64_tr_b16 v[104:105], v9 offset:8192
  ds_read_b64_tr_b16 v[106:107], v9 offset:9216
  ds_read_b64_tr_b16 v[108:109], v13 offset:8192
  ds_read_b64_tr_b16 v[110:111], v13 offset:9216
  ds_read_b128 v[64:67], v8 offset:0
  ds_read_b128 v[68:71], v8 offset:1024
  ds_read_b128 v[72:75], v8 offset:2048
  ds_read_b128 v[76:79], v8 offset:3072
  ds_read_b128 v[80:83], v8 offset:4096
  ds_read_b128 v[84:87], v8 offset:5120
  ds_read_b128 v[88:91], v8 offset:6144
  ds_read_b128 v[92:95], v8 offset:7168
  s_add_u32 s50, s50, 32768
  s_cmp_eq_u32 s50, 163840
  s_cselect_b32 s50, 0, s50
  s_waitcnt lgkmcnt(0)
  v_mfma_f32_16x16x32_bf16 v[128:131], v[96:99], v[64:67], v[128:131]
  v_mfma_f32_16x16x32_bf16 v[144:147], v[96:99], v[68:71], v[144:147]
  v_mfma_f32_16x16x32_bf16 v[160:163], v[96:99], v[72:75], v[160:163]
  v_mfma_f32_16x16x32_bf16 v[176:179], v[96:99], v[76:79], v[176:179]
  v_mfma_f32_16x16x32_bf16 v[192:195], v[96:99], v[80:83], v[192:195]
  v_mfma_f32_16x16x32_bf16 v[208:211], v[96:99], v[84:87], v[208:211]
  v_mfma_f32_16x16x32_bf16 v[224:227], v[96:99], v[88:91], v[224:227]
  v_mfma_f32_16x16x32_bf16 v[240:243], v[96:99], v[92:95], v[240:243]
  v_mfma_f32_16x16x32_bf16 v[244:247], v[100:103], v[92:95], v[244:247]
  v_mfma_f32_16x16x32_bf16 v[228:231], v[100:103], v[88:91], v[228:231]
  v_mfma_f32_16x16x32_bf16 v[212:215], v[100:103], v[84:87], v[212:215]
  v_mfma_f32_16x16x32_bf16 v[196:199], v[100:103], v[80:83], v[196:199]
  v_mfma_f32_16x16x32_bf16 v[180:183], v[100:103], v[76:79], v[180:183]
  v_mfma_f32_16x16x32_bf16 v[164:167], v[100:103], v[72:75], v[164:167]
  v_mfma_f32_16x16x32_bf16 v[148:151], v[100:103], v[68:71], v[148:151]
  v_mfma_f32_16x16x32_bf16 v[132:135], v[100:103], v[64:67], v[132:135]
  v_mfma_f32_16x16x32_bf16 v[136:139], v[104:107], v[64:67], v[136:139]
  v_mfma_f32_16x16x32_bf16 v[152:155], v[104:107], v[68:71], v[152:155]
  v_mfma_f32_16x16x32_bf16 v[168:171], v[104:107], v[72:75], v[168:171]
  v_mfma_f32_16x16x32_bf16 v[184:187], v[104:107], v[76:79], v[184:187]
  v_mfma_f32_16x16x32_bf16 v[200:203], v[104:107], v[80:83], v[200:203]
  v_mfma_f32_16x16x32_bf16 v[216:219], v[104:107], v[84:87], v[216:219]
  v_mfma_f32_16x16x32_bf16 v[232:235], v[104:107], v[88:91], v[232:235]
  v_mfma_f32_16x16x32_bf16 v[248:251], v[104:107], v[92:95], v[248:251]
  v_mfma_f32_16x16x32_bf16 v[252:255], v[108:111], v[92:95], v[252:255]
  v_mfma_f32_16x16x32_bf16 v[236:239], v[108:111], v[88:91], v[236:239]
  v_mfma_f32_16x16x32_bf16 v[220:223], v[108:111], v[84:87], v[220:223]
  v_mfma_f32_16x16x32_bf16 v[204:207], v[108:111], v[80:83], v[204:207]
  v_mfma_f32_16x16x32_bf16 v[188:191], v[108:111], v[76:79], v[188:191]
  v_mfma_f32_16x16x32_bf16 v[172:175], v[108:111], v[72:75], v[172:175]
  v_mfma_f32_16x16x32_bf16 v[156:159], v[108:111], v[68:71], v[156:159]
  v_mfma_f32_16x16x32_bf16 v[140:143], v[108:111], v[64:67], v[140:143]
  s_waitcnt vmcnt(1)
  s_barrier
  v_add_u32 v8, s50, v6
  v_add_u32 v9, s50, v7
  v_add_u32 v13, s50, v11
  ds_read_b64_tr_b16 v[96:97], v9 offset:0
  ds_read_b64_tr_b16 v[98:99], v9 offset:1024
  ds_read_b64_tr_b16 v[100:101], v13 offset:0
  ds_read_b64_tr_b16 v[102:103], v13 offset:1024
  ds_read_b64_tr_b16 v[104:105], v9 offset:8192
  ds_read_b64_tr_b16 v[106:107], v9 offset:9216
  ds_read_b64_tr_b16 v[108:109], v13 offset:8192
  ds_read_b64_tr_b16 v[110:111], v13 offset:9216
  ds_read_b128 v[64:67], v8 offset:0
  ds_read_b128 v[68:71], v8 offset:1024
  ds_read_b128 v[72:75], v8 offset:2048
  ds_read_b128 v[76:79], v8 offset:3072
  ds_read_b128 v[80:83], v8 offset:4096
  ds_read_b128 v[84:87], v8 offset:5120
  ds_read_b128 v[88:91], v8 offset:6144
  ds_read_b128 v[92:95], v8 offset:7168
  s_add_u32 s50, s50, 32768
  s_cmp_eq_u32 s50, 163840
  s_cselect_b32 s50, 0, s50
  s_waitcnt lgkmcnt(0)
  v_mfma_f32_16x16x32_bf16 v[128:131], v[96:99], v[64:67], v[128:131]
  v_mfma_f32_16x16x32_bf16 v[144:147], v[96:99], v[68:71], v[144:147]
  v_mfma_f32_16x16x32_bf16 v[160:163], v[96:99], v[72:75], v[160:163]
  v_mfma_f32_16x16x32_bf16 v[176:179], v[96:99], v[76:79], v[176:179]
  v_mfma_f32_16x16x32_bf16 v[192:195], v[96:99], v[80:83], v[192:195]
  v_mfma_f32_16x16x32_bf16 v[208:211], v[96:99], v[84:87], v[208:211]
  v_mfma_f32_16x16x32_bf16 v[224:227], v[96:99], v[88:91], v[224:227]
  v_mfma_f32_16x16x32_bf16 v[240:243], v[96:99], v[92:95], v[240:243]
  v_mfma_f32_16x16x32_bf16 v[244:247], v[100:103], v[92:95], v[244:247]
  v_mfma_f32_16x16x32_bf16 v[228:231], v[100:103], v[88:91], v[228:231]
  v_mfma_f32_16x16x32_bf16 v[212:215], v[100:103], v[84:87], v[212:215]
  v_mfma_f32_16x16x32_bf16 v[196:199], v[100:103], v[80:83], v[196:199]
  v_mfma_f32_16x16x32_bf16 v[180:183], v[100:103], v[76:79], v[180:183]
  v_mfma_f32_16x16x32_bf16 v[164:167], v[100:103], v[72:75], v[164:167]
  v_mfma_f32_16x16x32_bf16 v[148:151], v[100:103], v[68:71], v[148:151]
  v_mfma_f32_16x16x32_bf16 v[132:135], v[100:103], v[64:67], v[132:135]
  v_mfma_f32_16x16x32_bf16 v[136:139], v[104:107], v[64:67], v[136:139]
  v_mfma_f32_16x16x32_bf16 v[152:155], v[104:107], v[68:71], v[152:155]
  v_mfma_f32_16x16x32_bf16 v[168:171], v[104:107], v[72:75], v[168:171]
  v_mfma_f32_16x16x32_bf16 v[184:187], v[104:107], v[76:79], v[184:187]
  v_mfma_f32_16x16x32_bf16 v[200:203], v[104:107], v[80:83], v[200:203]
  v_mfma_f32_16x16x32_bf16 v[216:219], v[104:107], v[84:87], v[216:219]
  v_mfma_f32_16x16x32_bf16 v[232:235], v[104:107], v[88:91], v[232:235]
  v_mfma_f32_16x16x32_bf16 v[248:251], v[104:107], v[92:95], v[248:251]
  v_mfma_f32_16x16x32_bf16 v[252:255], v[108:111], v[92:95], v[252:255]
  v_mfma_f32_16x16x32_bf16 v[236:239], v[108:111], v[88:91], v[236:239]
  v_mfma_f32_16x16x32_bf16 v[220:223], v[108:111], v[84:87], v[220:223]
  v_mfma_f32_16x16x32_bf16 v[204:207], v[108:111], v[80:83], v[204:207]
  v_mfma_f32_16x16x32_bf16 v[188:191], v[108:111], v[76:79], v[188:191]
  v_mfma_f32_16x16x32_bf16 v[172:175], v[108:111], v[72:75], v[172:175]
  v_mfma_f32_16x16x32_bf16 v[156:159], v[108:111], v[68:71], v[156:159]
  v_mfma_f32_16x16x32_bf16 v[140:143], v[108:111], v[64:67], v[140:143]
G1_EPI:
  s_lshl_b32 s16, s20, 8
  s_add_u32 s16, s16, 147456
  v_lshl_add_u32 v13, v1, 2, s16
  v_mov_b32 v12, 0
  ds_write_b32 v13, v12
  s_lshl_b32 s60, s2, 3
  s_add_u32 s60, s60, s54
  s_lshl_b32 s60, s60, 2
  s_add_u32 s60, s60, 4730880
  s_lshl_b32 s16, s22, 4
  s_lshr_b32 s17, s20, 2
  s_lshl_b32 s17, s17, 3
  s_add_u32 s16, s16, s17
  s_mul_i32 s16, s16, 112
  s_mul_i32 s17, s21, 7
  s_add_u32 s17, s17, s40
  s_lshr_b32 s17, s17, 1
  s_add_u32 s16, s16, s17
  s_lshl_b32 s16, s16, 10
  s_add_u32 s61, s16, 16777216
  s_cmp_lg_u32 s23, 3
  s_cbranch_scc1 G1_NQ
  s_mov_b32 s18, 0x3e8293ee
  s_lshr_b32 s16, s20, 2
  s_lshl_b32 s16, s16, 13
  s_add_u32 s16, s16, 131072
  v_add_u32 v9, s16, v3
  s_lshl_b32 s16, s19, 3
  s_add_u32 s61, s61, s16
  v_mul_f32 v132, s18, v132
  v_mul_f32 v140, s18, v140
  v_mul_f32 v133, s18, v133
  v_mul_f32 v141, s18, v141
  v_mul_f32 v134, s18, v134
  v_mul_f32 v142, s18, v142
  v_mul_f32 v135, s18, v135
  v_mul_f32 v143, s18, v143
  v_cvt_pk_bf16_f32 v64, v132, v133
  v_cvt_pk_bf16_f32 v65, v134, v135
  v_cvt_pk_bf16_f32 v66, v140, v141
  v_cvt_pk_bf16_f32 v67, v142, v143
  ds_write_b128 v9, v[64:67] offset:0
  v_mul_f32 v148, s18, v148
  v_mul_f32 v156, s18, v156
  v_mul_f32 v149, s18, v149
  v_mul_f32 v157, s18, v157
  v_mul_f32 v150, s18, v150
  v_mul_f32 v158, s18, v158
  v_mul_f32 v151, s18, v151
  v_mul_f32 v159, s18, v159
  v_cvt_pk_bf16_f32 v68, v148, v149
  v_cvt_pk_bf16_f32 v69, v150, v151
  v_cvt_pk_bf16_f32 v70, v156, v157
  v_cvt_pk_bf16_f32 v71, v158, v159
  ds_write_b128 v9, v[68:71] offset:1024
  v_mul_f32 v164, s18, v164
  v_mul_f32 v172, s18, v172
  v_mul_f32 v165, s18, v165
  v_mul_f32 v173, s18, v173
  v_mul_f32 v166, s18, v166
  v_mul_f32 v174, s18, v174
  v_mul_f32 v167, s18, v167
  v_mul_f32 v175, s18, v175
  v_cvt_pk_bf16_f32 v72, v164, v165
  v_cvt_pk_bf16_f32 v73, v166, v167
  v_cvt_pk_bf16_f32 v74, v172, v173
  v_cvt_pk_bf16_f32 v75, v174, v175
  ds_write_b128 v9, v[72:75] offset:2048
  v_mul_f32 v180, s18, v180
  v_mul_f32 v188, s18, v188
  v_mul_f32 v181, s18, v181
  v_mul_f32 v189, s18, v189
  v_mul_f32 v182, s18, v182
  v_mul_f32 v190, s18, v190
  v_mul_f32 v183, s18, v183
  v_mul_f32 v191, s18, v191
  v_cvt_pk_bf16_f32 v76, v180, v181
  v_cvt_pk_bf16_f32 v77, v182, v183
  v_cvt_pk_bf16_f32 v78, v188, v189
  v_cvt_pk_bf16_f32 v79, v190, v191
  ds_write_b128 v9, v[76:79] offset:3072
  v_mul_f32 v196, s18, v196
  v_mul_f32 v204, s18, v204
  v_mul_f32 v197, s18, v197
  v_mul_f32 v205, s18, v205
  v_mul_f32 v198, s18, v198
  v_mul_f32 v206, s18, v206
  v_mul_f32 v199, s18, v199
  v_mul_f32 v207, s18, v207
  v_cvt_pk_bf16_f32 v80, v196, v197
  v_cvt_pk_bf16_f32 v81, v198, v199
  v_cvt_pk_bf16_f32 v82, v204, v205
  v_cvt_pk_bf16_f32 v83, v206, v207
  ds_write_b128 v9, v[80:83] offset:4096
  v_mul_f32 v212, s18, v212
  v_mul_f32 v220, s18, v220
  v_mul_f32 v213, s18, v213
  v_mul_f32 v221, s18, v221
  v_mul_f32 v214, s18, v214
  v_mul_f32 v222, s18, v222
  v_mul_f32 v215, s18, v215
  v_mul_f32 v223, s18, v223
  v_cvt_pk_bf16_f32 v84, v212, v213
  v_cvt_pk_bf16_f32 v85, v214, v215
  v_cvt_pk_bf16_f32 v86, v220, v221
  v_cvt_pk_bf16_f32 v87, v222, v223
  ds_write_b128 v9, v[84:87] offset:5120
  v_mul_f32 v228, s18, v228
  v_mul_f32 v236, s18, v236
  v_mul_f32 v229, s18, v229
  v_mul_f32 v237, s18, v237
  v_mul_f32 v230, s18, v230
  v_mul_f32 v238, s18, v238
  v_mul_f32 v231, s18, v231
  v_mul_f32 v239, s18, v239
  v_cvt_pk_bf16_f32 v88, v228, v229
  v_cvt_pk_bf16_f32 v89, v230, v231
  v_cvt_pk_bf16_f32 v90, v236, v237
  v_cvt_pk_bf16_f32 v91, v238, v239
  ds_write_b128 v9, v[88:91] offset:6144
  v_mul_f32 v244, s18, v244
  v_mul_f32 v252, s18, v252
  v_mul_f32 v245, s18, v245
  v_mul_f32 v253, s18, v253
  v_mul_f32 v246, s18, v246
  v_mul_f32 v254, s18, v254
  v_mul_f32 v247, s18, v247
  v_mul_f32 v255, s18, v255
  v_cvt_pk_bf16_f32 v92, v244, v245
  v_cvt_pk_bf16_f32 v93, v246, v247
  v_cvt_pk_bf16_f32 v94, v252, v253
  v_cvt_pk_bf16_f32 v95, v254, v255
  ds_write_b128 v9, v[92:95] offset:7168
G1_NQ:
  s_cmp_lt_u32 s20, 4
  s_cbranch_scc1 G1_PK
  s_waitcnt lgkmcnt(0)
  s_barrier
  s_setprio 3
G1_PK:
  s_cmp_eq_u32 s23, 3
  s_cbranch_scc1 G1_EPQ
  v_max_f32 v240, 0, v240
  v_max_f32 v241, 0, v241
  v_max_f32 v242, 0, v242
  v_max_f32 v243, 0, v243
  v_max_f32 v244, 0, v244
  v_max_f32 v245, 0, v245
  v_max_f32 v246, 0, v246
  v_max_f32 v247, 0, v247
  v_mul_f32 v240, v240, v248
  v_mul_f32 v241, v241, v249
  v_mul_f32 v242, v242, v250
  v_mul_f32 v243, v243, v251
  v_mul_f32 v244, v244, v252
  v_mul_f32 v245, v245, v253
  v_mul_f32 v246, v246, v254
  v_mul_f32 v247, v247, v255
  v_cvt_pk_bf16_f32 v252, v240, v241
  v_cvt_pk_bf16_f32 v253, v242, v243
  v_cvt_pk_bf16_f32 v254, v244, v245
  v_cvt_pk_bf16_f32 v255, v246, v247
  v_max_f32 v224, 0, v224
  v_max_f32 v225, 0, v225
  v_max_f32 v226, 0, v226
  v_max_f32 v227, 0, v227
  v_max_f32 v228, 0, v228
  v_max_f32 v229, 0, v229
  v_max_f32 v230, 0, v230
  v_max_f32 v231, 0, v231
  v_mul_f32 v224, v224, v232
  v_mul_f32 v225, v225, v233
  v_mul_f32 v226, v226, v234
  v_mul_f32 v227, v227, v235
  v_mul_f32 v228, v228, v236
  v_mul_f32 v229, v229, v237
  v_mul_f32 v230, v230, v238
  v_mul_f32 v231, v231, v239
  v_cvt_pk_bf16_f32 v248, v224, v225
  v_cvt_pk_bf16_f32 v249, v226, v227
  v_cvt_pk_bf16_f32 v250, v228, v229
  v_cvt_pk_bf16_f32 v251, v230, v231
  v_max_f32 v208, 0, v208
  v_max_f32 v209, 0, v209
  v_max_f32 v210, 0, v210
  v_max_f32 v211, 0, v211
  v_max_f32 v212, 0, v212
  v_max_f32 v213, 0, v213
  v_max_f32 v214, 0, v214
  v_max_f32 v215, 0, v215
  v_mul_f32 v208, v208, v216
  v_mul_f32 v209, v209, v217
  v_mul_f32 v210, v210, v218
  v_mul_f32 v211, v211, v219
  v_mul_f32 v212, v212, v220
  v_mul_f32 v213, v213, v221
  v_mul_f32 v214, v214, v222
  v_mul_f32 v215, v215, v223
  v_cvt_pk_bf16_f32 v244, v208, v209
  v_cvt_pk_bf16_f32 v245, v210, v211
  v_cvt_pk_bf16_f32 v246, v212, v213
  v_cvt_pk_bf16_f32 v247, v214, v215
  v_max_f32 v192, 0, v192
  v_max_f32 v193, 0, v193
  v_max_f32 v194, 0, v194
  v_max_f32 v195, 0, v195
  v_max_f32 v196, 0, v196
  v_max_f32 v197, 0, v197
  v_max_f32 v198, 0, v198
  v_max_f32 v199, 0, v199
  v_mul_f32 v192, v192, v200
  v_mul_f32 v193, v193, v201
  v_mul_f32 v194, v194, v202
  v_mul_f32 v195, v195, v203
  v_mul_f32 v196, v196, v204
  v_mul_f32 v197, v197, v205
  v_mul_f32 v198, v198, v206
  v_mul_f32 v199, v199, v207
  v_cvt_pk_bf16_f32 v240, v192, v193
  v_cvt_pk_bf16_f32 v241, v194, v195
  v_cvt_pk_bf16_f32 v242, v196, v197
  v_cvt_pk_bf16_f32 v243, v198, v199
  v_max_f32 v176, 0, v176
  v_max_f32 v177, 0, v177
  v_max_f32 v178, 0, v178
  v_max_f32 v179, 0, v179
  v_max_f32 v180, 0, v180
  v_max_f32 v181, 0, v181
  v_max_f32 v182, 0, v182
  v_max_f32 v183, 0, v183
  v_mul_f32 v176, v176, v184
  v_mul_f32 v177, v177, v185
  v_mul_f32 v178, v178, v186
  v_mul_f32 v179, v179, v187
  v_mul_f32 v180, v180, v188
  v_mul_f32 v181, v181, v189
  v_mul_f32 v182, v182, v190
  v_mul_f32 v183, v183, v191
  v_cvt_pk_bf16_f32 v236, v176, v177
  v_cvt_pk_bf16_f32 v237, v178, v179
  v_cvt_pk_bf16_f32 v238, v180, v181
  v_cvt_pk_bf16_f32 v239, v182, v183
  v_max_f32 v160, 0, v160
  v_max_f32 v161, 0, v161
  v_max_f32 v162, 0, v162
  v_max_f32 v163, 0, v163
  v_max_f32 v164, 0, v164
  v_max_f32 v165, 0, v165
  v_max_f32 v166, 0, v166
  v_max_f32 v167, 0, v167
  v_mul_f32 v160, v160, v168
  v_mul_f32 v161, v161, v169
  v_mul_f32 v162, v162, v170
  v_mul_f32 v163, v163, v171
  v_mul_f32 v164, v164, v172
  v_mul_f32 v165, v165, v173
  v_mul_f32 v166, v166, v174
  v_mul_f32 v167, v167, v175
  v_cvt_pk_bf16_f32 v232, v160, v161
  v_cvt_pk_bf16_f32 v233, v162, v163
  v_cvt_pk_bf16_f32 v234, v164, v165
  v_cvt_pk_bf16_f32 v235, v166, v167
  v_max_f32 v144, 0, v144
  v_max_f32 v145, 0, v145
  v_max_f32 v146, 0, v146
  v_max_f32 v147, 0, v147
  v_max_f32 v148, 0, v148
  v_max_f32 v149, 0, v149
  v_max_f32 v150, 0, v150
  v_max_f32 v151, 0, v151
  v_mul_f32 v144, v144, v152
  v_mul_f32 v145, v145, v153
  v_mul_f32 v146, v146, v154
  v_mul_f32 v147, v147, v155
  v_mul_f32 v148, v148, v156
  v_mul_f32 v149, v149, v157
  v_mul_f32 v150, v150, v158
  v_mul_f32 v151, v151, v159
  v_cvt_pk_bf16_f32 v228, v144, v145
  v_cvt_pk_bf16_f32 v229, v146, v147
  v_cvt_pk_bf16_f32 v230, v148, v149
  v_cvt_pk_bf16_f32 v231, v150, v151
  v_max_f32 v128, 0, v128
  v_max_f32 v129, 0, v129
  v_max_f32 v130, 0, v130
  v_max_f32 v131, 0, v131
  v_max_f32 v132, 0, v132
  v_max_f32 v133, 0, v133
  v_max_f32 v134, 0, v134
  v_max_f32 v135, 0, v135
  v_mul_f32 v128, v128, v136
  v_mul_f32 v129, v129, v137
  v_mul_f32 v130, v130, v138
  v_mul_f32 v131, v131, v139
  v_mul_f32 v132, v132, v140
  v_mul_f32 v133, v133, v141
  v_mul_f32 v134, v134, v142
  v_mul_f32 v135, v135, v143
  v_cvt_pk_bf16_f32 v224, v128, v129
  v_cvt_pk_bf16_f32 v225, v130, v131
  v_cvt_pk_bf16_f32 v226, v132, v133
  v_cvt_pk_bf16_f32 v227, v134, v135
  s_branch G1_X
G1_EPQ:
  v_max_f32 v240, 0, v240
  v_max_f32 v241, 0, v241
  v_max_f32 v242, 0, v242
  v_max_f32 v243, 0, v243
  v_mul_f32 v240, v240, v248
  v_mul_f32 v241, v241, v249
  v_mul_f32 v242, v242, v250
  v_mul_f32 v243, v243, v251
  v_cvt_pk_bf16_f32 v252, v240, v241
  v_cvt_pk_bf16_f32 v253, v242, v243
  v_max_f32 v224, 0, v224
  v_max_f32 v225, 0, v225
  v_max_f32 v226, 0, v226
  v_max_f32 v227, 0, v227
  v_mul_f32 v224, v224, v232
  v_mul_f32 v225, v225, v233
  v_mul_f32 v226, v226, v234
  v_mul_f32 v227, v227, v235
  v_cvt_pk_bf16_f32 v248, v224, v225
  v_cvt_pk_bf16_f32 v249, v226, v227
  v_max_f32 v208, 0, v208
  v_max_f32 v209, 0, v209
  v_max_f32 v210, 0, v210
  v_max_f32 v211, 0, v211
  v_mul_f32 v208, v208, v216
  v_mul_f32 v209, v209, v217
  v_mul_f32 v210, v210, v218
  v_mul_f32 v211, v211, v219
  v_cvt_pk_bf16_f32 v244, v208, v209
  v_cvt_pk_bf16_f32 v245, v210, v211
  v_max_f32 v192, 0, v192
  v_max_f32 v193, 0, v193
  v_max_f32 v194, 0, v194
  v_max_f32 v195, 0, v195
  v_mul_f32 v192, v192, v200
  v_mul_f32 v193, v193, v201
  v_mul_f32 v194, v194, v202
  v_mul_f32 v195, v195, v203
  v_cvt_pk_bf16_f32 v240, v192, v193
  v_cvt_pk_bf16_f32 v241, v194, v195
  v_max_f32 v176, 0, v176
  v_max_f32 v177, 0, v177
  v_max_f32 v178, 0, v178
  v_max_f32 v179, 0, v179
  v_mul_f32 v176, v176, v184
  v_mul_f32 v177, v177, v185
  v_mul_f32 v178, v178, v186
  v_mul_f32 v179, v179, v187
  v_cvt_pk_bf16_f32 v236, v176, v177
  v_cvt_pk_bf16_f32 v237, v178, v179
  v_max_f32 v160, 0, v160
  v_max_f32 v161, 0, v161
  v_max_f32 v162, 0, v162
  v_max_f32 v163, 0, v163
  v_mul_f32 v160, v160, v168
  v_mul_f32 v161, v161, v169
  v_mul_f32 v162, v162, v170
  v_mul_f32 v163, v163, v171
  v_cvt_pk_bf16_f32 v232, v160, v161
  v_cvt_pk_bf16_f32 v233, v162, v163
  v_max_f32 v144, 0, v144
  v_max_f32 v145, 0, v145
  v_max_f32 v146, 0, v146
  v_max_f32 v147, 0, v147
  v_mul_f32 v144, v144, v152
  v_mul_f32 v145, v145, v153
  v_mul_f32 v146, v146, v154
  v_mul_f32 v147, v147, v155
  v_cvt_pk_bf16_f32 v228, v144, v145
  v_cvt_pk_bf16_f32 v229, v146, v147
  v_max_f32 v128, 0, v128
  v_max_f32 v129, 0, v129
  v_max_f32 v130, 0, v130
  v_max_f32 v131, 0, v131
  v_mul_f32 v128, v128, v136
  v_mul_f32 v129, v129, v137
  v_mul_f32 v130, v130, v138
  v_mul_f32 v131, v131, v139
  v_cvt_pk_bf16_f32 v224, v128, v129
  v_cvt_pk_bf16_f32 v225, v130, v131
G1_X:
  s_cmp_ge_u32 s20, 4
  s_cbranch_scc1 G1_X2
  s_lshl_b32 s16, s20, 11
  v_add_u32 v9, s16, v3
  ds_write_b128 v9, v[224:227] offset:0
  ds_write_b128 v9, v[228:231] offset:1024
  ds_write_b128 v9, v[232:235] offset:8192
  ds_write_b128 v9, v[236:239] offset:9216
  ds_write_b128 v9, v[240:243] offset:16384
  ds_write_b128 v9, v[244:247] offset:17408
  ds_write_b128 v9, v[248:251] offset:24576
  ds_write_b128 v9, v[252:255] offset:25600
  s_waitcnt lgkmcnt(0)
  s_barrier
G1_X2:
  s_and_b32 s20, s54, 3
  s_cmp_ge_u32 s54, 4
  s_cbranch_scc1 F_B
  s_add_u32 s36, s32, 4194304
  s_addc_u32 s37, s33, 0
  s_mov_b32 s38, 0x40000
  s_mov_b32 s39, 0x20000
  v_bfe_u32 v2, v1, 4, 1
  v_lshlrev_b32 v4, 10, v2
  v_lshrrev_b32 v2, 5, v1
  v_lshl_add_u32 v4, v2, 8, v4
  v_and_b32 v2, 15, v1
  v_lshl_add_u32 v4, v2, 4, v4
  s_lshl_b32 s16, s20, 12
  s_add_u32 s16, s16, 131072
  v_add_u32 v5, s16, v4
  ds_read_b128 v[16:19], v5 offset:0
  ds_read_b128 v[20:23], v5 offset:512
  ds_read_b128 v[24:27], v5 offset:2048
  ds_read_b128 v[28:31], v5 offset:2560
  v_add_u32 v6, 65536, v4
  v_add_u32 v7, 67584, v3
  s_lshl_b32 s16, s20, 8
  s_add_u32 s16, s16, 147456
  v_lshl_add_u32 v13, v1, 2, s16
  v_and_b32 v2, 3, v1
  v_lshlrev_b32 v14, 8, v2
  v_lshl_add_u32 v14, v1, 2, v14
  v_add_u32 v14, 147456, v14
  v_mov_b32 v12, 1
  s_mov_b32 s53, 0
  s_waitcnt vmcnt(8)
  ds_add_u32 v13, v12
  s_add_u32 s53, s53, 1
SY2:
  ds_read_b32 v15, v14
  s_waitcnt lgkmcnt(0)
  v_cmp_gt_u32 vcc, s53, v15
  s_nop 0
  s_cbranch_vccnz SY2
  ds_read_b128 v[32:35], v6 offset:0
  ds_read_b128 v[36:39], v6 offset:512
  ds_read_b128 v[40:43], v7 offset:0
  ds_read_b128 v[44:47], v7 offset:1024
  v_and_b32 v2, 4, v1
  v_cmp_eq_u32 vcc, 0, v2
  v_mov_b32 v5, 0x3f803f80
  s_mov_b32 s28, 0
  v_and_b32 v2, 1, v1
  v_cndmask_b32 v72, 0, v5, vcc
  v_xor_b32 v74, v5, v72
  v_mov_b32 v73, v72
  v_mov_b32 v75, v74
  s_mov_b32 s16, 0xaaaaaaaa
  v_mul_lo_u32 v84, v2, s16
  v_or_b32 v84, 0x44444444, v84
  s_waitcnt lgkmcnt(0)
  v_mfma_f32_32x32x16_bf16 v[96:111], v[32:35], v[16:19], 0
  v_mfma_f32_32x32x16_bf16 v[96:111], v[36:39], v[20:23], v[96:111]
  v_mfma_f32_32x32x16_bf16 v[112:127], v[32:35], v[24:27], 0
  v_mfma_f32_32x32x16_bf16 v[112:127], v[36:39], v[28:31], v[112:127]
  v_mov_b32 v128, 0
  v_mov_b32 v129, 0
  v_mov_b32 v130, 0
  v_mov_b32 v131, 0
  v_mov_b32 v132, 0
  v_mov_b32 v133, 0
  v_mov_b32 v134, 0
  v_mov_b32 v135, 0
  v_mov_b32 v136, 0
  v_mov_b32 v137, 0
  v_mov_b32 v138, 0
  v_mov_b32 v139, 0
  v_mov_b32 v140, 0
  v_mov_b32 v141, 0
  v_mov_b32 v142, 0
  v_mov_b32 v143, 0
  v_mov_b32 v76, 0
  v_mov_b32 v77, 0
  v_mov_b32 v78, 0
  v_mov_b32 v79, 0
  v_mov_b32 v144, 0
  v_mov_b32 v145, 0
  v_mov_b32 v146, 0
  v_mov_b32 v147, 0
  v_mov_b32 v148, 0
  v_mov_b32 v149, 0
  v_mov_b32 v150, 0
  v_mov_b32 v151, 0
  v_mov_b32 v152, 0
  v_mov_b32 v153, 0
  v_mov_b32 v154, 0
  v_mov_b32 v155, 0
  v_mov_b32 v156, 0
  v_mov_b32 v157, 0
  v_mov_b32 v158, 0
  v_mov_b32 v159, 0
  v_mov_b32 v80, 0
  v_mov_b32 v81, 0
  v_mov_b32 v82, 0
  v_mov_b32 v83, 0
  v_mov_b32 v64, 0
  v_mov_b32 v68, 0
  v_mov_b32 v60, 0
  v_mov_b32 v65, 0
  v_mov_b32 v69, 0
  v_mov_b32 v61, 0
  v_mov_b32 v66, 0
  v_mov_b32 v70, 0
  v_mov_b32 v62, 0
  v_mov_b32 v67, 0
  v_mov_b32 v71, 0
  v_mov_b32 v63, 0
  v_max3_f32 v8, v96, v97, v98
  v_max3_f32 v8, v8, v99, v100
  v_max3_f32 v8, v8, v101, v102
  v_max3_f32 v8, v8, v103, v104
  v_max3_f32 v8, v8, v105, v106
  v_max3_f32 v8, v8, v107, v108
  v_max3_f32 v8, v8, v109, v110
  v_max_f32 v8, v8, v111
  v_mov_b32 v9, v8
  v_max3_f32 v10, v112, v113, v114
  v_max3_f32 v10, v10, v115, v116
  v_max3_f32 v10, v10, v117, v118
  v_max3_f32 v10, v10, v119, v120
  v_max3_f32 v10, v10, v121, v122
  v_max3_f32 v10, v10, v123, v124
  v_max3_f32 v10, v10, v125, v126
  v_max_f32 v10, v10, v127
  v_mov_b32 v11, v10
  v_permlane32_swap_b32 v8, v9
  v_max_f32 v8, v8, v9
  v_sub_f32 v160, 0, v8
  v_mov_b32 v161, v160
  v_mov_b32 v162, v160
  v_mov_b32 v163, v160
  v_mov_b32 v164, v160
  v_mov_b32 v165, v160
  v_mov_b32 v166, v160
  v_mov_b32 v167, v160
  v_mov_b32 v168, v160
  v_mov_b32 v169, v160
  v_mov_b32 v170, v160
  v_mov_b32 v171, v160
  v_mov_b32 v172, v160
  v_mov_b32 v173, v160
  v_mov_b32 v174, v160
  v_mov_b32 v175, v160
  v_permlane32_swap_b32 v10, v11
  v_max_f32 v10, v10, v11
  v_sub_f32 v176, 0, v10
  v_mov_b32 v177, v176
  v_mov_b32 v178, v176
  v_mov_b32 v179, v176
  v_mov_b32 v180, v176
  v_mov_b32 v181, v176
  v_mov_b32 v182, v176
  v_mov_b32 v183, v176
  v_mov_b32 v184, v176
  v_mov_b32 v185, v176
  v_mov_b32 v186, v176
  v_mov_b32 v187, v176
  v_mov_b32 v188, v176
  v_mov_b32 v189, v176
  v_mov_b32 v190, v176
  v_mov_b32 v191, v176
  v_mfma_f32_32x32x16_bf16 v[96:111], v[32:35], v[16:19], v[160:175]
  v_mfma_f32_32x32x16_bf16 v[96:111], v[36:39], v[20:23], v[96:111]
  s_setprio 2
  s_nop 11
  v_mfma_f32_32x32x16_bf16 v[112:127], v[32:35], v[24:27], v[176:191]
  ds_read_b128 v[48:51], v6 offset:4096
  v_exp_f32 v96, v96
  v_exp_f32 v97, v97
  ds_read_b128 v[52:55], v6 offset:4608
  v_exp_f32 v98, v98
  v_mfma_f32_32x32x16_bf16 v[144:159], v[60:63], v[68:71], v[144:159]
  ds_read_b128 v[56:59], v7 offset:4096
  v_exp_f32 v99, v99
  v_exp_f32 v100, v100
  v_exp_f32 v101, v101
  v_smfmac_f32_16x16x64_bf16 v[80:83], v[72:75], v[64:71], v84
  ds_read_b128 v[60:63], v7 offset:5120
  v_exp_f32 v102, v102
  v_exp_f32 v103, v103
  v_mfma_f32_32x32x16_bf16 v[112:127], v[36:39], v[28:31], v[112:127]
  v_cvt_pk_bf16_f32 v64, v96, v97
  v_cvt_pk_bf16_f32 v65, v98, v99
  v_exp_f32 v104, v104
  v_cvt_pk_bf16_f32 v66, v100, v101
  v_cvt_pk_bf16_f32 v67, v102, v103
  v_exp_f32 v105, v105
  v_exp_f32 v106, v106
  v_mfma_f32_32x32x16_bf16 v[128:143], v[40:43], v[64:67], v[128:143]
  v_exp_f32 v107, v107
  v_exp_f32 v108, v108
  v_exp_f32 v109, v109
  v_exp_f32 v110, v110
  v_exp_f32 v111, v111
  v_cvt_pk_bf16_f32 v68, v104, v105
  v_cvt_pk_bf16_f32 v69, v106, v107
  v_cvt_pk_bf16_f32 v70, v108, v109
  v_cvt_pk_bf16_f32 v71, v110, v111
  s_waitcnt lgkmcnt(0)
  v_mfma_f32_32x32x16_bf16 v[96:111], v[48:51], v[16:19], v[160:175]
  v_exp_f32 v112, v112
  v_exp_f32 v113, v113
  v_exp_f32 v114, v114
  v_mfma_f32_32x32x16_bf16 v[128:143], v[44:47], v[68:71], v[128:143]
  v_exp_f32 v115, v115
  v_exp_f32 v116, v116
  v_exp_f32 v117, v117
  v_smfmac_f32_16x16x64_bf16 v[76:79], v[72:75], v[64:71], v84
  v_exp_f32 v118, v118
  v_exp_f32 v119, v119
  v_mfma_f32_32x32x16_bf16 v[96:111], v[52:55], v[20:23], v[96:111]
  v_cvt_pk_bf16_f32 v64, v112, v113
  v_cvt_pk_bf16_f32 v65, v114, v115
  v_exp_f32 v120, v120
  v_cvt_pk_bf16_f32 v66, v116, v117
  v_cvt_pk_bf16_f32 v67, v118, v119
  v_exp_f32 v121, v121
  v_exp_f32 v122, v122
  v_mfma_f32_32x32x16_bf16 v[144:159], v[40:43], v[64:67], v[144:159]
  v_exp_f32 v123, v123
  v_exp_f32 v124, v124
  v_exp_f32 v125, v125
  v_exp_f32 v126, v126
  v_exp_f32 v127, v127
  v_cvt_pk_bf16_f32 v68, v120, v121
  v_cvt_pk_bf16_f32 v69, v122, v123
  v_cvt_pk_bf16_f32 v70, v124, v125
  v_cvt_pk_bf16_f32 v71, v126, v127
  v_mfma_f32_32x32x16_bf16 v[112:127], v[48:51], v[24:27], v[176:191]
  ds_read_b128 v[32:35], v6 offset:8192
  v_exp_f32 v96, v96
  v_exp_f32 v97, v97
  ds_read_b128 v[36:39], v6 offset:8704
  v_exp_f32 v98, v98
  v_mfma_f32_32x32x16_bf16 v[144:159], v[44:47], v[68:71], v[144:159]
  ds_read_b128 v[40:43], v7 offset:8192
  v_exp_f32 v99, v99
  v_exp_f32 v100, v100
  v_exp_f32 v101, v101
  v_smfmac_f32_16x16x64_bf16 v[80:83], v[72:75], v[64:71], v84
  ds_read_b128 v[44:47], v7 offset:9216
  v_exp_f32 v102, v102
  v_exp_f32 v103, v103
  v_mfma_f32_32x32x16_bf16 v[112:127], v[52:55], v[28:31], v[112:127]
  v_cvt_pk_bf16_f32 v64, v96, v97
  v_cvt_pk_bf16_f32 v65, v98, v99
  v_exp_f32 v104, v104
  v_cvt_pk_bf16_f32 v66, v100, v101
  v_cvt_pk_bf16_f32 v67, v102, v103
  v_exp_f32 v105, v105
  v_exp_f32 v106, v106
  v_mfma_f32_32x32x16_bf16 v[128:143], v[56:59], v[64:67], v[128:143]
  v_exp_f32 v107, v107
  v_exp_f32 v108, v108
  v_exp_f32 v109, v109
  v_exp_f32 v110, v110
  v_exp_f32 v111, v111
  v_cvt_pk_bf16_f32 v68, v104, v105
  v_cvt_pk_bf16_f32 v69, v106, v107
  v_cvt_pk_bf16_f32 v70, v108, v109
  v_cvt_pk_bf16_f32 v71, v110, v111
  s_waitcnt lgkmcnt(0)
  v_mfma_f32_32x32x16_bf16 v[96:111], v[32:35], v[16:19], v[160:175]
  v_exp_f32 v112, v112
  v_exp_f32 v113, v113
  v_exp_f32 v114, v114
  v_mfma_f32_32x32x16_bf16 v[128:143], v[60:63], v[68:71], v[128:143]
  v_exp_f32 v115, v115
  v_exp_f32 v116, v116
  v_exp_f32 v117, v117
  v_smfmac_f32_16x16x64_bf16 v[76:79], v[72:75], v[64:71], v84
  v_exp_f32 v118, v118
  v_exp_f32 v119, v119
  v_mfma_f32_32x32x16_bf16 v[96:111], v[36:39], v[20:23], v[96:111]
  v_cvt_pk_bf16_f32 v64, v112, v113
  v_cvt_pk_bf16_f32 v65, v114, v115
  v_exp_f32 v120, v120
  v_cvt_pk_bf16_f32 v66, v116, v117
  v_cvt_pk_bf16_f32 v67, v118, v119
  v_exp_f32 v121, v121
  v_exp_f32 v122, v122
  v_mfma_f32_32x32x16_bf16 v[144:159], v[56:59], v[64:67], v[144:159]
  v_exp_f32 v123, v123
  v_exp_f32 v124, v124
  v_exp_f32 v125, v125
  v_exp_f32 v126, v126
  v_exp_f32 v127, v127
  v_cvt_pk_bf16_f32 v68, v120, v121
  v_cvt_pk_bf16_f32 v69, v122, v123
  v_cvt_pk_bf16_f32 v70, v124, v125
  v_cvt_pk_bf16_f32 v71, v126, v127
  v_mfma_f32_32x32x16_bf16 v[112:127], v[32:35], v[24:27], v[176:191]
  ds_read_b128 v[48:51], v6 offset:12288
  v_exp_f32 v96, v96
  v_exp_f32 v97, v97
  ds_read_b128 v[52:55], v6 offset:12800
  v_exp_f32 v98, v98
  v_mfma_f32_32x32x16_bf16 v[144:159], v[60:63], v[68:71], v[144:159]
  ds_read_b128 v[56:59], v7 offset:12288
  v_exp_f32 v99, v99
  v_exp_f32 v100, v100
  v_exp_f32 v101, v101
  v_smfmac_f32_16x16x64_bf16 v[80:83], v[72:75], v[64:71], v84
  ds_read_b128 v[60:63], v7 offset:13312
  v_exp_f32 v102, v102
  v_exp_f32 v103, v103
  v_mfma_f32_32x32x16_bf16 v[112:127], v[36:39], v[28:31], v[112:127]
  v_cvt_pk_bf16_f32 v64, v96, v97
  v_cvt_pk_bf16_f32 v65, v98, v99
  v_exp_f32 v104, v104
  v_cvt_pk_bf16_f32 v66, v100, v101
  v_cvt_pk_bf16_f32 v67, v102, v103
  v_exp_f32 v105, v105
  v_exp_f32 v106, v106
  v_mfma_f32_32x32x16_bf16 v[128:143], v[40:43], v[64:67], v[128:143]
  v_exp_f32 v107, v107
  v_exp_f32 v108, v108
  v_exp_f32 v109, v109
  v_exp_f32 v110, v110
  v_exp_f32 v111, v111
  v_cvt_pk_bf16_f32 v68, v104, v105
  v_cvt_pk_bf16_f32 v69, v106, v107
  v_cvt_pk_bf16_f32 v70, v108, v109
  v_cvt_pk_bf16_f32 v71, v110, v111
  s_waitcnt lgkmcnt(0)
  v_mfma_f32_32x32x16_bf16 v[96:111], v[48:51], v[16:19], v[160:175]
  v_exp_f32 v112, v112
  v_exp_f32 v113, v113
  v_exp_f32 v114, v114
  v_mfma_f32_32x32x16_bf16 v[128:143], v[44:47], v[68:71], v[128:143]
  v_exp_f32 v115, v115
  v_exp_f32 v116, v116
  v_exp_f32 v117, v117
  v_smfmac_f32_16x16x64_bf16 v[76:79], v[72:75], v[64:71], v84
  v_exp_f32 v118, v118
  v_exp_f32 v119, v119
  v_mfma_f32_32x32x16_bf16 v[96:111], v[52:55], v[20:23], v[96:111]
  v_cvt_pk_bf16_f32 v64, v112, v113
  v_cvt_pk_bf16_f32 v65, v114, v115
  v_exp_f32 v120, v120
  v_cvt_pk_bf16_f32 v66, v116, v117
  v_cvt_pk_bf16_f32 v67, v118, v119
  v_exp_f32 v121, v121
  v_exp_f32 v122, v122
  v_mfma_f32_32x32x16_bf16 v[144:159], v[40:43], v[64:67], v[144:159]
  v_exp_f32 v123, v123
  v_exp_f32 v124, v124
  v_exp_f32 v125, v125
  v_exp_f32 v126, v126
  v_exp_f32 v127, v127
  v_cvt_pk_bf16_f32 v68, v120, v121
  v_cvt_pk_bf16_f32 v69, v122, v123
  v_cvt_pk_bf16_f32 v70, v124, v125
  v_cvt_pk_bf16_f32 v71, v126, v127
  v_mfma_f32_32x32x16_bf16 v[112:127], v[48:51], v[24:27], v[176:191]
  ds_read_b128 v[32:35], v6 offset:16384
  v_exp_f32 v96, v96
  v_exp_f32 v97, v97
  ds_read_b128 v[36:39], v6 offset:16896
  v_exp_f32 v98, v98
  v_mfma_f32_32x32x16_bf16 v[144:159], v[44:47], v[68:71], v[144:159]
  ds_read_b128 v[40:43], v7 offset:16384
  v_exp_f32 v99, v99
  v_exp_f32 v100, v100
  v_exp_f32 v101, v101
  v_smfmac_f32_16x16x64_bf16 v[80:83], v[72:75], v[64:71], v84
  ds_read_b128 v[44:47], v7 offset:17408
  v_exp_f32 v102, v102
  v_exp_f32 v103, v103
  v_mfma_f32_32x32x16_bf16 v[112:127], v[52:55], v[28:31], v[112:127]
  v_cvt_pk_bf16_f32 v64, v96, v97
  v_cvt_pk_bf16_f32 v65, v98, v99
  v_exp_f32 v104, v104
  v_cvt_pk_bf16_f32 v66, v100, v101
  v_cvt_pk_bf16_f32 v67, v102, v103
  v_exp_f32 v105, v105
  v_exp_f32 v106, v106
  v_mfma_f32_32x32x16_bf16 v[128:143], v[56:59], v[64:67], v[128:143]
  v_exp_f32 v107, v107
  v_exp_f32 v108, v108
  v_exp_f32 v109, v109
  v_exp_f32 v110, v110
  v_exp_f32 v111, v111
  v_cvt_pk_bf16_f32 v68, v104, v105
  v_cvt_pk_bf16_f32 v69, v106, v107
  v_cvt_pk_bf16_f32 v70, v108, v109
  v_cvt_pk_bf16_f32 v71, v110, v111
  s_waitcnt lgkmcnt(0)
  v_mfma_f32_32x32x16_bf16 v[96:111], v[32:35], v[16:19], v[160:175]
  v_exp_f32 v112, v112
  v_exp_f32 v113, v113
  v_exp_f32 v114, v114
  v_mfma_f32_32x32x16_bf16 v[128:143], v[60:63], v[68:71], v[128:143]
  v_exp_f32 v115, v115
  v_exp_f32 v116, v116
  v_exp_f32 v117, v117
  v_smfmac_f32_16x16x64_bf16 v[76:79], v[72:75], v[64:71], v84
  v_exp_f32 v118, v118
  v_exp_f32 v119, v119
  v_mfma_f32_32x32x16_bf16 v[96:111], v[36:39], v[20:23], v[96:111]
  v_cvt_pk_bf16_f32 v64, v112, v113
  v_cvt_pk_bf16_f32 v65, v114, v115
  v_exp_f32 v120, v120
  v_cvt_pk_bf16_f32 v66, v116, v117
  v_cvt_pk_bf16_f32 v67, v118, v119
  v_exp_f32 v121, v121
  v_exp_f32 v122, v122
  v_mfma_f32_32x32x16_bf16 v[144:159], v[56:59], v[64:67], v[144:159]
  v_exp_f32 v123, v123
  v_exp_f32 v124, v124
  v_exp_f32 v125, v125
  v_exp_f32 v126, v126
  v_exp_f32 v127, v127
  v_cvt_pk_bf16_f32 v68, v120, v121
  v_cvt_pk_bf16_f32 v69, v122, v123
  v_cvt_pk_bf16_f32 v70, v124, v125
  v_cvt_pk_bf16_f32 v71, v126, v127
  v_mfma_f32_32x32x16_bf16 v[112:127], v[32:35], v[24:27], v[176:191]
  ds_read_b128 v[48:51], v6 offset:20480
  v_exp_f32 v96, v96
  v_exp_f32 v97, v97
  ds_read_b128 v[52:55], v6 offset:20992
  v_exp_f32 v98, v98
  v_mfma_f32_32x32x16_bf16 v[144:159], v[60:63], v[68:71], v[144:159]
  ds_read_b128 v[56:59], v7 offset:20480
  v_exp_f32 v99, v99
  v_exp_f32 v100, v100
  v_exp_f32 v101, v101
  v_smfmac_f32_16x16x64_bf16 v[80:83], v[72:75], v[64:71], v84
  ds_read_b128 v[60:63], v7 offset:21504
  v_exp_f32 v102, v102
  v_exp_f32 v103, v103
  v_mfma_f32_32x32x16_bf16 v[112:127], v[36:39], v[28:31], v[112:127]
  v_cvt_pk_bf16_f32 v64, v96, v97
  v_cvt_pk_bf16_f32 v65, v98, v99
  v_exp_f32 v104, v104
  v_cvt_pk_bf16_f32 v66, v100, v101
  v_cvt_pk_bf16_f32 v67, v102, v103
  v_exp_f32 v105, v105
  v_exp_f32 v106, v106
  v_mfma_f32_32x32x16_bf16 v[128:143], v[40:43], v[64:67], v[128:143]
  v_exp_f32 v107, v107
  v_exp_f32 v108, v108
  v_exp_f32 v109, v109
  v_exp_f32 v110, v110
  v_exp_f32 v111, v111
  v_cvt_pk_bf16_f32 v68, v104, v105
  v_cvt_pk_bf16_f32 v69, v106, v107
  v_cvt_pk_bf16_f32 v70, v108, v109
  v_cvt_pk_bf16_f32 v71, v110, v111
  s_waitcnt lgkmcnt(0)
  v_mfma_f32_32x32x16_bf16 v[96:111], v[48:51], v[16:19], v[160:175]
  v_exp_f32 v112, v112
  v_exp_f32 v113, v113
  v_exp_f32 v114, v114
  v_mfma_f32_32x32x16_bf16 v[128:143], v[44:47], v[68:71], v[128:143]
  v_exp_f32 v115, v115
  v_exp_f32 v116, v116
  v_exp_f32 v117, v117
  v_smfmac_f32_16x16x64_bf16 v[76:79], v[72:75], v[64:71], v84
  v_exp_f32 v118, v118
  v_exp_f32 v119, v119
  v_mfma_f32_32x32x16_bf16 v[96:111], v[52:55], v[20:23], v[96:111]
  v_cvt_pk_bf16_f32 v64, v112, v113
  v_cvt_pk_bf16_f32 v65, v114, v115
  v_exp_f32 v120, v120
  v_cvt_pk_bf16_f32 v66, v116, v117
  v_cvt_pk_bf16_f32 v67, v118, v119
  v_exp_f32 v121, v121
  v_exp_f32 v122, v122
  v_mfma_f32_32x32x16_bf16 v[144:159], v[40:43], v[64:67], v[144:159]
  v_exp_f32 v123, v123
  v_exp_f32 v124, v124
  v_exp_f32 v125, v125
  v_exp_f32 v126, v126
  v_exp_f32 v127, v127
  v_cvt_pk_bf16_f32 v68, v120, v121
  v_cvt_pk_bf16_f32 v69, v122, v123
  v_cvt_pk_bf16_f32 v70, v124, v125
  v_cvt_pk_bf16_f32 v71, v126, v127
  v_mfma_f32_32x32x16_bf16 v[112:127], v[48:51], v[24:27], v[176:191]
  ds_read_b128 v[32:35], v6 offset:24576
  v_exp_f32 v96, v96
  v_exp_f32 v97, v97
  ds_read_b128 v[36:39], v6 offset:25088
  v_exp_f32 v98, v98
  v_mfma_f32_32x32x16_bf16 v[144:159], v[44:47], v[68:71], v[144:159]
  ds_read_b128 v[40:43], v7 offset:24576
  v_exp_f32 v99, v99
  v_exp_f32 v100, v100
  v_exp_f32 v101, v101
  v_smfmac_f32_16x16x64_bf16 v[80:83], v[72:75], v[64:71], v84
  ds_read_b128 v[44:47], v7 offset:25600
  v_exp_f32 v102, v102
  v_exp_f32 v103, v103
  v_mfma_f32_32x32x16_bf16 v[112:127], v[52:55], v[28:31], v[112:127]
  v_cvt_pk_bf16_f32 v64, v96, v97
  v_cvt_pk_bf16_f32 v65, v98, v99
  v_exp_f32 v104, v104
  v_cvt_pk_bf16_f32 v66, v100, v101
  v_cvt_pk_bf16_f32 v67, v102, v103
  v_exp_f32 v105, v105
  v_exp_f32 v106, v106
  v_mfma_f32_32x32x16_bf16 v[128:143], v[56:59], v[64:67], v[128:143]
  v_exp_f32 v107, v107
  v_exp_f32 v108, v108
  v_exp_f32 v109, v109
  v_exp_f32 v110, v110
  v_exp_f32 v111, v111
  v_cvt_pk_bf16_f32 v68, v104, v105
  v_cvt_pk_bf16_f32 v69, v106, v107
  v_cvt_pk_bf16_f32 v70, v108, v109
  v_cvt_pk_bf16_f32 v71, v110, v111
  s_waitcnt lgkmcnt(0)
  v_mfma_f32_32x32x16_bf16 v[96:111], v[32:35], v[16:19], v[160:175]
  v_exp_f32 v112, v112
  v_exp_f32 v113, v113
  v_exp_f32 v114, v114
  v_mfma_f32_32x32x16_bf16 v[128:143], v[60:63], v[68:71], v[128:143]
  v_exp_f32 v115, v115
  v_exp_f32 v116, v116
  v_exp_f32 v117, v117
  v_smfmac_f32_16x16x64_bf16 v[76:79], v[72:75], v[64:71], v84
  v_exp_f32 v118, v118
  v_exp_f32 v119, v119
  v_mfma_f32_32x32x16_bf16 v[96:111], v[36:39], v[20:23], v[96:111]
  v_cvt_pk_bf16_f32 v64, v112, v113
  v_cvt_pk_bf16_f32 v65, v114, v115
  v_exp_f32 v120, v120
  v_cvt_pk_bf16_f32 v66, v116, v117
  v_cvt_pk_bf16_f32 v67, v118, v119
  v_exp_f32 v121, v121
  v_exp_f32 v122, v122
  v_mfma_f32_32x32x16_bf16 v[144:159], v[56:59], v[64:67], v[144:159]
  v_exp_f32 v123, v123
  v_exp_f32 v124, v124
  v_exp_f32 v125, v125
  v_exp_f32 v126, v126
  v_exp_f32 v127, v127
  v_cvt_pk_bf16_f32 v68, v120, v121
  v_cvt_pk_bf16_f32 v69, v122, v123
  v_cvt_pk_bf16_f32 v70, v124, v125
  v_cvt_pk_bf16_f32 v71, v126, v127
  s_waitcnt vmcnt(0)
  ds_add_u32 v13, v12
  s_add_u32 s53, s53, 1
  v_mfma_f32_32x32x16_bf16 v[112:127], v[32:35], v[24:27], v[176:191]
  ds_read_b128 v[48:51], v6 offset:28672
  v_exp_f32 v96, v96
  v_exp_f32 v97, v97
  ds_read_b128 v[52:55], v6 offset:29184
  v_exp_f32 v98, v98
  v_mfma_f32_32x32x16_bf16 v[144:159], v[60:63], v[68:71], v[144:159]
  ds_read_b128 v[56:59], v7 offset:28672
  v_exp_f32 v99, v99
  v_exp_f32 v100, v100
  v_exp_f32 v101, v101
  v_smfmac_f32_16x16x64_bf16 v[80:83], v[72:75], v[64:71], v84
  ds_read_b128 v[60:63], v7 offset:29696
  v_exp_f32 v102, v102
  v_exp_f32 v103, v103
  v_mfma_f32_32x32x16_bf16 v[112:127], v[36:39], v[28:31], v[112:127]
  v_cvt_pk_bf16_f32 v64, v96, v97
  v_cvt_pk_bf16_f32 v65, v98, v99
  v_exp_f32 v104, v104
  v_cvt_pk_bf16_f32 v66, v100, v101
  v_cvt_pk_bf16_f32 v67, v102, v103
  v_exp_f32 v105, v105
  v_exp_f32 v106, v106
  v_mfma_f32_32x32x16_bf16 v[128:143], v[40:43], v[64:67], v[128:143]
  v_exp_f32 v107, v107
  v_exp_f32 v108, v108
  v_exp_f32 v109, v109
  v_exp_f32 v110, v110
  v_exp_f32 v111, v111
  v_cvt_pk_bf16_f32 v68, v104, v105
  v_cvt_pk_bf16_f32 v69, v106, v107
  v_cvt_pk_bf16_f32 v70, v108, v109
  v_cvt_pk_bf16_f32 v71, v110, v111
  s_waitcnt lgkmcnt(0)
  v_mfma_f32_32x32x16_bf16 v[96:111], v[48:51], v[16:19], v[160:175]
  v_exp_f32 v112, v112
  v_exp_f32 v113, v113
  v_exp_f32 v114, v114
  v_mfma_f32_32x32x16_bf16 v[128:143], v[44:47], v[68:71], v[128:143]
  v_exp_f32 v115, v115
  v_exp_f32 v116, v116
  v_exp_f32 v117, v117
  v_smfmac_f32_16x16x64_bf16 v[76:79], v[72:75], v[64:71], v84
  v_exp_f32 v118, v118
  v_exp_f32 v119, v119
  v_mfma_f32_32x32x16_bf16 v[96:111], v[52:55], v[20:23], v[96:111]
  v_cvt_pk_bf16_f32 v64, v112, v113
  v_cvt_pk_bf16_f32 v65, v114, v115
  v_exp_f32 v120, v120
  v_cvt_pk_bf16_f32 v66, v116, v117
  v_cvt_pk_bf16_f32 v67, v118, v119
  v_exp_f32 v121, v121
  v_exp_f32 v122, v122
  v_mfma_f32_32x32x16_bf16 v[144:159], v[40:43], v[64:67], v[144:159]
  v_exp_f32 v123, v123
  v_exp_f32 v124, v124
  v_exp_f32 v125, v125
  ds_read_b32 v15, v14
  v_exp_f32 v126, v126
  v_exp_f32 v127, v127
  v_cvt_pk_bf16_f32 v68, v120, v121
  v_cvt_pk_bf16_f32 v69, v122, v123
  v_cvt_pk_bf16_f32 v70, v124, v125
  v_cvt_pk_bf16_f32 v71, v126, v127
  s_waitcnt lgkmcnt(0)
  v_cmp_gt_u32 vcc, s53, v15
  s_nop 0
  s_cbranch_vccnz ATT_SP7F
ATT_CT7F:
  ds_add_u32 v13, v12
  s_add_u32 s53, s53, 1
  v_xor_b32 v6, 0x8000, v6
  v_xor_b32 v7, 0x8000, v7
  v_mfma_f32_32x32x16_bf16 v[112:127], v[48:51], v[24:27], v[176:191]
  ds_read_b128 v[32:35], v6 offset:0
  v_exp_f32 v96, v96
  v_exp_f32 v97, v97
  ds_read_b128 v[36:39], v6 offset:512
  v_exp_f32 v98, v98
  v_mfma_f32_32x32x16_bf16 v[144:159], v[44:47], v[68:71], v[144:159]
  ds_read_b128 v[40:43], v7 offset:0
  v_exp_f32 v99, v99
  v_exp_f32 v100, v100
  v_exp_f32 v101, v101
  v_smfmac_f32_16x16x64_bf16 v[80:83], v[72:75], v[64:71], v84
  ds_read_b128 v[44:47], v7 offset:1024
  v_exp_f32 v102, v102
  v_exp_f32 v103, v103
  v_mfma_f32_32x32x16_bf16 v[112:127], v[52:55], v[28:31], v[112:127]
  v_cvt_pk_bf16_f32 v64, v96, v97
  v_cvt_pk_bf16_f32 v65, v98, v99
  v_exp_f32 v104, v104
  v_cvt_pk_bf16_f32 v66, v100, v101
  v_cvt_pk_bf16_f32 v67, v102, v103
  v_exp_f32 v105, v105
  v_exp_f32 v106, v106
  v_mfma_f32_32x32x16_bf16 v[128:143], v[56:59], v[64:67], v[128:143]
  v_exp_f32 v107, v107
  v_exp_f32 v108, v108
  v_exp_f32 v109, v109
  v_exp_f32 v110, v110
  v_exp_f32 v111, v111
  v_cvt_pk_bf16_f32 v68, v104, v105
  v_cvt_pk_bf16_f32 v69, v106, v107
  v_cvt_pk_bf16_f32 v70, v108, v109
  v_cvt_pk_bf16_f32 v71, v110, v111
  s_waitcnt lgkmcnt(0)
  v_mfma_f32_32x32x16_bf16 v[96:111], v[32:35], v[16:19], v[160:175]
  v_exp_f32 v112, v112
  v_exp_f32 v113, v113
  v_exp_f32 v114, v114
  v_mfma_f32_32x32x16_bf16 v[128:143], v[60:63], v[68:71], v[128:143]
  v_exp_f32 v115, v115
  v_exp_f32 v116, v116
  v_exp_f32 v117, v117
  v_smfmac_f32_16x16x64_bf16 v[76:79], v[72:75], v[64:71], v84
  v_exp_f32 v118, v118
  v_exp_f32 v119, v119
  v_mfma_f32_32x32x16_bf16 v[96:111], v[36:39], v[20:23], v[96:111]
  v_cvt_pk_bf16_f32 v64, v112, v113
  v_cvt_pk_bf16_f32 v65, v114, v115
  v_exp_f32 v120, v120
  v_cvt_pk_bf16_f32 v66, v116, v117
  v_cvt_pk_bf16_f32 v67, v118, v119
  v_exp_f32 v121, v121
  v_exp_f32 v122, v122
  v_mfma_f32_32x32x16_bf16 v[144:159], v[56:59], v[64:67], v[144:159]
  v_exp_f32 v123, v123
  v_exp_f32 v124, v124
  v_exp_f32 v125, v125
  ds_read_b32 v15, v14
  v_exp_f32 v126, v126
  v_exp_f32 v127, v127
  v_cvt_pk_bf16_f32 v68, v120, v121
  v_cvt_pk_bf16_f32 v69, v122, v123
  v_cvt_pk_bf16_f32 v70, v124, v125
  v_cvt_pk_bf16_f32 v71, v126, v127
  s_waitcnt lgkmcnt(0)
ATT_LOOP:
  v_cmp_gt_u32 vcc, s53, v15
  s_nop 0
  s_cbranch_vccnz ATT_SP0
ATT_CT0:
  v_mfma_f32_32x32x16_bf16 v[112:127], v[32:35], v[24:27], v[176:191]
  ds_read_b128 v[48:51], v6 offset:4096
  v_exp_f32 v96, v96
  v_exp_f32 v97, v97
  ds_read_b128 v[52:55], v6 offset:4608
  v_exp_f32 v98, v98
  v_mfma_f32_32x32x16_bf16 v[144:159], v[60:63], v[68:71], v[144:159]
  ds_read_b128 v[56:59], v7 offset:4096
  v_exp_f32 v99, v99
  v_exp_f32 v100, v100
  v_exp_f32 v101, v101
  v_smfmac_f32_16x16x64_bf16 v[80:83], v[72:75], v[64:71], v84
  ds_read_b128 v[60:63], v7 offset:5120
  v_exp_f32 v102, v102
  v_exp_f32 v103, v103
  v_mfma_f32_32x32x16_bf16 v[112:127], v[36:39], v[28:31], v[112:127]
  v_cvt_pk_bf16_f32 v64, v96, v97
  v_cvt_pk_bf16_f32 v65, v98, v99
  v_exp_f32 v104, v104
  v_cvt_pk_bf16_f32 v66, v100, v101
  v_cvt_pk_bf16_f32 v67, v102, v103
  v_exp_f32 v105, v105
  v_exp_f32 v106, v106
  v_mfma_f32_32x32x16_bf16 v[128:143], v[40:43], v[64:67], v[128:143]
  v_exp_f32 v107, v107
  v_exp_f32 v108, v108
  v_exp_f32 v109, v109
  s_add_u32 m0, s25, 0
  s_add_u32 s26, s24, 0
  buffer_load_dwordx4 v3, s[36:39], s26 offen offset:0 lds
  v_exp_f32 v110, v110
  v_exp_f32 v111, v111
  v_cvt_pk_bf16_f32 v68, v104, v105
  v_cvt_pk_bf16_f32 v69, v106, v107
  v_cvt_pk_bf16_f32 v70, v108, v109
  v_cvt_pk_bf16_f32 v71, v110, v111
  s_waitcnt lgkmcnt(0)
  v_mfma_f32_32x32x16_bf16 v[96:111], v[48:51], v[16:19], v[160:175]
  v_exp_f32 v112, v112
  v_exp_f32 v113, v113
  v_exp_f32 v114, v114
  v_mfma_f32_32x32x16_bf16 v[128:143], v[44:47], v[68:71], v[128:143]
  v_exp_f32 v115, v115
  v_exp_f32 v116, v116
  v_exp_f32 v117, v117
  v_smfmac_f32_16x16x64_bf16 v[76:79], v[72:75], v[64:71], v84
  v_exp_f32 v118, v118
  v_exp_f32 v119, v119
  v_mfma_f32_32x32x16_bf16 v[96:111], v[52:55], v[20:23], v[96:111]
  v_cvt_pk_bf16_f32 v64, v112, v113
  v_cvt_pk_bf16_f32 v65, v114, v115
  v_exp_f32 v120, v120
  v_cvt_pk_bf16_f32 v66, v116, v117
  v_cvt_pk_bf16_f32 v67, v118, v119
  v_exp_f32 v121, v121
  v_exp_f32 v122, v122
  v_mfma_f32_32x32x16_bf16 v[144:159], v[40:43], v[64:67], v[144:159]
  v_exp_f32 v123, v123
  v_exp_f32 v124, v124
  v_exp_f32 v125, v125
  buffer_load_dwordx4 v3, s[36:39], s26 offen offset:1024 lds
  v_exp_f32 v126, v126
  v_exp_f32 v127, v127
  v_cvt_pk_bf16_f32 v68, v120, v121
  v_cvt_pk_bf16_f32 v69, v122, v123
  v_cvt_pk_bf16_f32 v70, v124, v125
  v_cvt_pk_bf16_f32 v71, v126, v127
  v_mfma_f32_32x32x16_bf16 v[112:127], v[48:51], v[24:27], v[176:191]
  ds_read_b128 v[32:35], v6 offset:8192
  v_exp_f32 v96, v96
  v_exp_f32 v97, v97
  ds_read_b128 v[36:39], v6 offset:8704
  v_exp_f32 v98, v98
  v_mfma_f32_32x32x16_bf16 v[144:159], v[44:47], v[68:71], v[144:159]
  ds_read_b128 v[40:43], v7 offset:8192
  v_exp_f32 v99, v99
  v_exp_f32 v100, v100
  v_exp_f32 v101, v101
  v_smfmac_f32_16x16x64_bf16 v[80:83], v[72:75], v[64:71], v84
  ds_read_b128 v[44:47], v7 offset:9216
  v_exp_f32 v102, v102
  v_exp_f32 v103, v103
  v_mfma_f32_32x32x16_bf16 v[112:127], v[52:55], v[28:31], v[112:127]
  v_cvt_pk_bf16_f32 v64, v96, v97
  v_cvt_pk_bf16_f32 v65, v98, v99
  v_exp_f32 v104, v104
  v_cvt_pk_bf16_f32 v66, v100, v101
  v_cvt_pk_bf16_f32 v67, v102, v103
  v_exp_f32 v105, v105
  v_exp_f32 v106, v106
  v_mfma_f32_32x32x16_bf16 v[128:143], v[56:59], v[64:67], v[128:143]
  v_exp_f32 v107, v107
  v_exp_f32 v108, v108
  v_exp_f32 v109, v109
  buffer_load_dwordx4 v3, s[36:39], s26 offen offset:2048 lds
  v_exp_f32 v110, v110
  v_exp_f32 v111, v111
  v_cvt_pk_bf16_f32 v68, v104, v105
  v_cvt_pk_bf16_f32 v69, v106, v107
  v_cvt_pk_bf16_f32 v70, v108, v109
  v_cvt_pk_bf16_f32 v71, v110, v111
  s_waitcnt lgkmcnt(0)
  v_mfma_f32_32x32x16_bf16 v[96:111], v[32:35], v[16:19], v[160:175]
  v_exp_f32 v112, v112
  v_exp_f32 v113, v113
  v_exp_f32 v114, v114
  v_mfma_f32_32x32x16_bf16 v[128:143], v[60:63], v[68:71], v[128:143]
  v_exp_f32 v115, v115
  v_exp_f32 v116, v116
  v_exp_f32 v117, v117
  v_smfmac_f32_16x16x64_bf16 v[76:79], v[72:75], v[64:71], v84
  v_exp_f32 v118, v118
  v_exp_f32 v119, v119
  v_mfma_f32_32x32x16_bf16 v[96:111], v[36:39], v[20:23], v[96:111]
  v_cvt_pk_bf16_f32 v64, v112, v113
  v_cvt_pk_bf16_f32 v65, v114, v115
  v_exp_f32 v120, v120
  v_cvt_pk_bf16_f32 v66, v116, v117
  v_cvt_pk_bf16_f32 v67, v118, v119
  v_exp_f32 v121, v121
  v_exp_f32 v122, v122
  v_mfma_f32_32x32x16_bf16 v[144:159], v[56:59], v[64:67], v[144:159]
  v_exp_f32 v123, v123
  v_exp_f32 v124, v124
  v_exp_f32 v125, v125
  buffer_load_dwordx4 v3, s[36:39], s26 offen offset:3072 lds
  v_exp_f32 v126, v126
  v_exp_f32 v127, v127
  v_cvt_pk_bf16_f32 v68, v120, v121
  v_cvt_pk_bf16_f32 v69, v122, v123
  v_cvt_pk_bf16_f32 v70, v124, v125
  v_cvt_pk_bf16_f32 v71, v126, v127
  v_mfma_f32_32x32x16_bf16 v[112:127], v[32:35], v[24:27], v[176:191]
  ds_read_b128 v[48:51], v6 offset:12288
  v_exp_f32 v96, v96
  v_exp_f32 v97, v97
  ds_read_b128 v[52:55], v6 offset:12800
  v_exp_f32 v98, v98
  v_mfma_f32_32x32x16_bf16 v[144:159], v[60:63], v[68:71], v[144:159]
  ds_read_b128 v[56:59], v7 offset:12288
  v_exp_f32 v99, v99
  v_exp_f32 v100, v100
  v_exp_f32 v101, v101
  v_smfmac_f32_16x16x64_bf16 v[80:83], v[72:75], v[64:71], v84
  ds_read_b128 v[60:63], v7 offset:13312
  v_exp_f32 v102, v102
  v_exp_f32 v103, v103
  v_mfma_f32_32x32x16_bf16 v[112:127], v[36:39], v[28:31], v[112:127]
  v_cvt_pk_bf16_f32 v64, v96, v97
  v_cvt_pk_bf16_f32 v65, v98, v99
  v_exp_f32 v104, v104
  v_cvt_pk_bf16_f32 v66, v100, v101
  v_cvt_pk_bf16_f32 v67, v102, v103
  v_exp_f32 v105, v105
  v_exp_f32 v106, v106
  v_mfma_f32_32x32x16_bf16 v[128:143], v[40:43], v[64:67], v[128:143]
  v_exp_f32 v107, v107
  v_exp_f32 v108, v108
  v_exp_f32 v109, v109
  s_add_u32 m0, s25, 4096
  s_add_u32 s26, s24, 4096
  buffer_load_dwordx4 v3, s[36:39], s26 offen offset:0 lds
  v_exp_f32 v110, v110
  v_exp_f32 v111, v111
  v_cvt_pk_bf16_f32 v68, v104, v105
  v_cvt_pk_bf16_f32 v69, v106, v107
  v_cvt_pk_bf16_f32 v70, v108, v109
  v_cvt_pk_bf16_f32 v71, v110, v111
  s_waitcnt lgkmcnt(0)
  v_mfma_f32_32x32x16_bf16 v[96:111], v[48:51], v[16:19], v[160:175]
  v_exp_f32 v112, v112
  v_exp_f32 v113, v113
  v_exp_f32 v114, v114
  v_mfma_f32_32x32x16_bf16 v[128:143], v[44:47], v[68:71], v[128:143]
  v_exp_f32 v115, v115
  v_exp_f32 v116, v116
  v_exp_f32 v117, v117
  v_smfmac_f32_16x16x64_bf16 v[76:79], v[72:75], v[64:71], v84
  v_exp_f32 v118, v118
  v_exp_f32 v119, v119
  v_mfma_f32_32x32x16_bf16 v[96:111], v[52:55], v[20:23], v[96:111]
  v_cvt_pk_bf16_f32 v64, v112, v113
  v_cvt_pk_bf16_f32 v65, v114, v115
  v_exp_f32 v120, v120
  v_cvt_pk_bf16_f32 v66, v116, v117
  v_cvt_pk_bf16_f32 v67, v118, v119
  v_exp_f32 v121, v121
  v_exp_f32 v122, v122
  v_mfma_f32_32x32x16_bf16 v[144:159], v[40:43], v[64:67], v[144:159]
  v_exp_f32 v123, v123
  v_exp_f32 v124, v124
  v_exp_f32 v125, v125
  buffer_load_dwordx4 v3, s[36:39], s26 offen offset:1024 lds
  v_exp_f32 v126, v126
  v_exp_f32 v127, v127
  v_cvt_pk_bf16_f32 v68, v120, v121
  v_cvt_pk_bf16_f32 v69, v122, v123
  v_cvt_pk_bf16_f32 v70, v124, v125
  v_cvt_pk_bf16_f32 v71, v126, v127
  v_mfma_f32_32x32x16_bf16 v[112:127], v[48:51], v[24:27], v[176:191]
  ds_read_b128 v[32:35], v6 offset:16384
  v_exp_f32 v96, v96
  v_exp_f32 v97, v97
  ds_read_b128 v[36:39], v6 offset:16896
  v_exp_f32 v98, v98
  v_mfma_f32_32x32x16_bf16 v[144:159], v[44:47], v[68:71], v[144:159]
  ds_read_b128 v[40:43], v7 offset:16384
  v_exp_f32 v99, v99
  v_exp_f32 v100, v100
  v_exp_f32 v101, v101
  v_smfmac_f32_16x16x64_bf16 v[80:83], v[72:75], v[64:71], v84
  ds_read_b128 v[44:47], v7 offset:17408
  v_exp_f32 v102, v102
  v_exp_f32 v103, v103
  v_mfma_f32_32x32x16_bf16 v[112:127], v[52:55], v[28:31], v[112:127]
  v_cvt_pk_bf16_f32 v64, v96, v97
  v_cvt_pk_bf16_f32 v65, v98, v99
  v_exp_f32 v104, v104
  v_cvt_pk_bf16_f32 v66, v100, v101
  v_cvt_pk_bf16_f32 v67, v102, v103
  v_exp_f32 v105, v105
  v_exp_f32 v106, v106
  v_mfma_f32_32x32x16_bf16 v[128:143], v[56:59], v[64:67], v[128:143]
  v_exp_f32 v107, v107
  v_exp_f32 v108, v108
  v_exp_f32 v109, v109
  buffer_load_dwordx4 v3, s[36:39], s26 offen offset:2048 lds
  v_exp_f32 v110, v110
  v_exp_f32 v111, v111
  v_cvt_pk_bf16_f32 v68, v104, v105
  v_cvt_pk_bf16_f32 v69, v106, v107
  v_cvt_pk_bf16_f32 v70, v108, v109
  v_cvt_pk_bf16_f32 v71, v110, v111
  s_waitcnt lgkmcnt(0)
  v_mfma_f32_32x32x16_bf16 v[96:111], v[32:35], v[16:19], v[160:175]
  v_exp_f32 v112, v112
  v_exp_f32 v113, v113
  v_exp_f32 v114, v114
  v_mfma_f32_32x32x16_bf16 v[128:143], v[60:63], v[68:71], v[128:143]
  v_exp_f32 v115, v115
  v_exp_f32 v116, v116
  v_exp_f32 v117, v117
  v_smfmac_f32_16x16x64_bf16 v[76:79], v[72:75], v[64:71], v84
  v_exp_f32 v118, v118
  v_exp_f32 v119, v119
  v_mfma_f32_32x32x16_bf16 v[96:111], v[36:39], v[20:23], v[96:111]
  v_cvt_pk_bf16_f32 v64, v112, v113
  v_cvt_pk_bf16_f32 v65, v114, v115
  v_exp_f32 v120, v120
  v_cvt_pk_bf16_f32 v66, v116, v117
  v_cvt_pk_bf16_f32 v67, v118, v119
  v_exp_f32 v121, v121
  v_exp_f32 v122, v122
  v_mfma_f32_32x32x16_bf16 v[144:159], v[56:59], v[64:67], v[144:159]
  v_exp_f32 v123, v123
  v_exp_f32 v124, v124
  v_exp_f32 v125, v125
  buffer_load_dwordx4 v3, s[36:39], s26 offen offset:3072 lds
  s_add_u32 s24, s24, 32768
  s_xor_b32 s25, s25, 32768
  v_exp_f32 v126, v126
  v_exp_f32 v127, v127
  v_cvt_pk_bf16_f32 v68, v120, v121
  v_cvt_pk_bf16_f32 v69, v122, v123
  v_cvt_pk_bf16_f32 v70, v124, v125
  v_cvt_pk_bf16_f32 v71, v126, v127
  v_mfma_f32_32x32x16_bf16 v[112:127], v[32:35], v[24:27], v[176:191]
  ds_read_b128 v[48:51], v6 offset:20480
  v_exp_f32 v96, v96
  v_exp_f32 v97, v97
  ds_read_b128 v[52:55], v6 offset:20992
  v_exp_f32 v98, v98
  v_mfma_f32_32x32x16_bf16 v[144:159], v[60:63], v[68:71], v[144:159]
  ds_read_b128 v[56:59], v7 offset:20480
  v_exp_f32 v99, v99
  v_exp_f32 v100, v100
  v_exp_f32 v101, v101
  v_smfmac_f32_16x16x64_bf16 v[80:83], v[72:75], v[64:71], v84
  ds_read_b128 v[60:63], v7 offset:21504
  v_exp_f32 v102, v102
  v_exp_f32 v103, v103
  v_mfma_f32_32x32x16_bf16 v[112:127], v[36:39], v[28:31], v[112:127]
  v_cvt_pk_bf16_f32 v64, v96, v97
  v_cvt_pk_bf16_f32 v65, v98, v99
  v_exp_f32 v104, v104
  v_cvt_pk_bf16_f32 v66, v100, v101
  v_cvt_pk_bf16_f32 v67, v102, v103
  v_exp_f32 v105, v105
  v_exp_f32 v106, v106
  v_mfma_f32_32x32x16_bf16 v[128:143], v[40:43], v[64:67], v[128:143]
  v_exp_f32 v107, v107
  v_exp_f32 v108, v108
  v_exp_f32 v109, v109
  v_exp_f32 v110, v110
  v_exp_f32 v111, v111
  v_cvt_pk_bf16_f32 v68, v104, v105
  v_cvt_pk_bf16_f32 v69, v106, v107
  v_cvt_pk_bf16_f32 v70, v108, v109
  v_cvt_pk_bf16_f32 v71, v110, v111
  s_waitcnt lgkmcnt(0)
  v_mfma_f32_32x32x16_bf16 v[96:111], v[48:51], v[16:19], v[160:175]
  v_exp_f32 v112, v112
  v_exp_f32 v113, v113
  v_exp_f32 v114, v114
  v_mfma_f32_32x32x16_bf16 v[128:143], v[44:47], v[68:71], v[128:143]
  v_exp_f32 v115, v115
  v_exp_f32 v116, v116
  v_exp_f32 v117, v117
  v_smfmac_f32_16x16x64_bf16 v[76:79], v[72:75], v[64:71], v84
  v_exp_f32 v118, v118
  v_exp_f32 v119, v119
  v_mfma_f32_32x32x16_bf16 v[96:111], v[52:55], v[20:23], v[96:111]
  v_cvt_pk_bf16_f32 v64, v112, v113
  v_cvt_pk_bf16_f32 v65, v114, v115
  v_exp_f32 v120, v120
  v_cvt_pk_bf16_f32 v66, v116, v117
  v_cvt_pk_bf16_f32 v67, v118, v119
  v_exp_f32 v121, v121
  v_exp_f32 v122, v122
  v_mfma_f32_32x32x16_bf16 v[144:159], v[40:43], v[64:67], v[144:159]
  v_exp_f32 v123, v123
  v_exp_f32 v124, v124
  v_exp_f32 v125, v125
  v_exp_f32 v126, v126
  v_exp_f32 v127, v127
  v_cvt_pk_bf16_f32 v68, v120, v121
  v_cvt_pk_bf16_f32 v69, v122, v123
  v_cvt_pk_bf16_f32 v70, v124, v125
  v_cvt_pk_bf16_f32 v71, v126, v127
  v_mfma_f32_32x32x16_bf16 v[112:127], v[48:51], v[24:27], v[176:191]
  ds_read_b128 v[32:35], v6 offset:24576
  v_exp_f32 v96, v96
  v_exp_f32 v97, v97
  ds_read_b128 v[36:39], v6 offset:25088
  v_exp_f32 v98, v98
  v_mfma_f32_32x32x16_bf16 v[144:159], v[44:47], v[68:71], v[144:159]
  ds_read_b128 v[40:43], v7 offset:24576
  v_exp_f32 v99, v99
  v_exp_f32 v100, v100
  v_exp_f32 v101, v101
  v_smfmac_f32_16x16x64_bf16 v[80:83], v[72:75], v[64:71], v84
  ds_read_b128 v[44:47], v7 offset:25600
  v_exp_f32 v102, v102
  v_exp_f32 v103, v103
  v_mfma_f32_32x32x16_bf16 v[112:127], v[52:55], v[28:31], v[112:127]
  v_cvt_pk_bf16_f32 v64, v96, v97
  v_cvt_pk_bf16_f32 v65, v98, v99
  v_exp_f32 v104, v104
  v_cvt_pk_bf16_f32 v66, v100, v101
  v_cvt_pk_bf16_f32 v67, v102, v103
  v_exp_f32 v105, v105
  v_exp_f32 v106, v106
  v_mfma_f32_32x32x16_bf16 v[128:143], v[56:59], v[64:67], v[128:143]
  v_exp_f32 v107, v107
  v_exp_f32 v108, v108
  v_exp_f32 v109, v109
  v_exp_f32 v110, v110
  v_exp_f32 v111, v111
  v_cvt_pk_bf16_f32 v68, v104, v105
  v_cvt_pk_bf16_f32 v69, v106, v107
  v_cvt_pk_bf16_f32 v70, v108, v109
  v_cvt_pk_bf16_f32 v71, v110, v111
  s_waitcnt lgkmcnt(0)
  v_mfma_f32_32x32x16_bf16 v[96:111], v[32:35], v[16:19], v[160:175]
  v_exp_f32 v112, v112
  v_exp_f32 v113, v113
  v_exp_f32 v114, v114
  v_mfma_f32_32x32x16_bf16 v[128:143], v[60:63], v[68:71], v[128:143]
  v_exp_f32 v115, v115
  v_exp_f32 v116, v116
  v_exp_f32 v117, v117
  v_smfmac_f32_16x16x64_bf16 v[76:79], v[72:75], v[64:71], v84
  v_exp_f32 v118, v118
  v_exp_f32 v119, v119
  v_mfma_f32_32x32x16_bf16 v[96:111], v[36:39], v[20:23], v[96:111]
  v_cvt_pk_bf16_f32 v64, v112, v113
  v_cvt_pk_bf16_f32 v65, v114, v115
  v_exp_f32 v120, v120
  v_cvt_pk_bf16_f32 v66, v116, v117
  v_cvt_pk_bf16_f32 v67, v118, v119
  v_exp_f32 v121, v121
  v_exp_f32 v122, v122
  v_mfma_f32_32x32x16_bf16 v[144:159], v[56:59], v[64:67], v[144:159]
  v_exp_f32 v123, v123
  v_exp_f32 v124, v124
  v_exp_f32 v125, v125
  v_exp_f32 v126, v126
  v_exp_f32 v127, v127
  v_cvt_pk_bf16_f32 v68, v120, v121
  v_cvt_pk_bf16_f32 v69, v122, v123
  v_cvt_pk_bf16_f32 v70, v124, v125
  v_cvt_pk_bf16_f32 v71, v126, v127
  s_waitcnt vmcnt(0)
  ds_add_u32 v13, v12
  s_add_u32 s53, s53, 1
  v_mfma_f32_32x32x16_bf16 v[112:127], v[32:35], v[24:27], v[176:191]
  ds_read_b128 v[48:51], v6 offset:28672
  v_exp_f32 v96, v96
  v_exp_f32 v97, v97
  ds_read_b128 v[52:55], v6 offset:29184
  v_exp_f32 v98, v98
  v_mfma_f32_32x32x16_bf16 v[144:159], v[60:63], v[68:71], v[144:159]
  ds_read_b128 v[56:59], v7 offset:28672
  v_exp_f32 v99, v99
  v_exp_f32 v100, v100
  v_exp_f32 v101, v101
  v_smfmac_f32_16x16x64_bf16 v[80:83], v[72:75], v[64:71], v84
  ds_read_b128 v[60:63], v7 offset:29696
  v_exp_f32 v102, v102
  v_exp_f32 v103, v103
  v_mfma_f32_32x32x16_bf16 v[112:127], v[36:39], v[28:31], v[112:127]
  v_cvt_pk_bf16_f32 v64, v96, v97
  v_cvt_pk_bf16_f32 v65, v98, v99
  v_exp_f32 v104, v104
  v_cvt_pk_bf16_f32 v66, v100, v101
  v_cvt_pk_bf16_f32 v67, v102, v103
  v_exp_f32 v105, v105
  v_exp_f32 v106, v106
  v_mfma_f32_32x32x16_bf16 v[128:143], v[40:43], v[64:67], v[128:143]
  v_exp_f32 v107, v107
  v_exp_f32 v108, v108
  v_exp_f32 v109, v109
  v_exp_f32 v110, v110
  v_exp_f32 v111, v111
  v_cvt_pk_bf16_f32 v68, v104, v105
  v_cvt_pk_bf16_f32 v69, v106, v107
  v_cvt_pk_bf16_f32 v70, v108, v109
  v_cvt_pk_bf16_f32 v71, v110, v111
  s_waitcnt lgkmcnt(0)
  v_mfma_f32_32x32x16_bf16 v[96:111], v[48:51], v[16:19], v[160:175]
  v_exp_f32 v112, v112
  v_exp_f32 v113, v113
  v_exp_f32 v114, v114
  v_mfma_f32_32x32x16_bf16 v[128:143], v[44:47], v[68:71], v[128:143]
  v_exp_f32 v115, v115
  v_exp_f32 v116, v116
  v_exp_f32 v117, v117
  v_smfmac_f32_16x16x64_bf16 v[76:79], v[72:75], v[64:71], v84
  v_exp_f32 v118, v118
  v_exp_f32 v119, v119
  v_mfma_f32_32x32x16_bf16 v[96:111], v[52:55], v[20:23], v[96:111]
  v_cvt_pk_bf16_f32 v64, v112, v113
  v_cvt_pk_bf16_f32 v65, v114, v115
  v_exp_f32 v120, v120
  v_cvt_pk_bf16_f32 v66, v116, v117
  v_cvt_pk_bf16_f32 v67, v118, v119
  v_exp_f32 v121, v121
  v_exp_f32 v122, v122
  v_mfma_f32_32x32x16_bf16 v[144:159], v[40:43], v[64:67], v[144:159]
  v_exp_f32 v123, v123
  v_exp_f32 v124, v124
  v_exp_f32 v125, v125
  ds_read_b32 v15, v14
  v_exp_f32 v126, v126
  v_exp_f32 v127, v127
  v_cvt_pk_bf16_f32 v68, v120, v121
  v_cvt_pk_bf16_f32 v69, v122, v123
  v_cvt_pk_bf16_f32 v70, v124, v125
  v_cvt_pk_bf16_f32 v71, v126, v127
  s_waitcnt lgkmcnt(0)
  v_cmp_gt_u32 vcc, s53, v15
  s_nop 0
  s_cbranch_vccnz ATT_SP7
ATT_CT7:
  ds_add_u32 v13, v12
  s_add_u32 s53, s53, 1
  v_xor_b32 v6, 0x8000, v6
  v_xor_b32 v7, 0x8000, v7
  v_mfma_f32_32x32x16_bf16 v[112:127], v[48:51], v[24:27], v[176:191]
  ds_read_b128 v[32:35], v6 offset:0
  v_exp_f32 v96, v96
  v_exp_f32 v97, v97
  ds_read_b128 v[36:39], v6 offset:512
  v_exp_f32 v98, v98
  v_mfma_f32_32x32x16_bf16 v[144:159], v[44:47], v[68:71], v[144:159]
  ds_read_b128 v[40:43], v7 offset:0
  v_exp_f32 v99, v99
  v_exp_f32 v100, v100
  v_exp_f32 v101, v101
  v_smfmac_f32_16x16x64_bf16 v[80:83], v[72:75], v[64:71], v84
  ds_read_b128 v[44:47], v7 offset:1024
  v_exp_f32 v102, v102
  v_exp_f32 v103, v103
  v_mfma_f32_32x32x16_bf16 v[112:127], v[52:55], v[28:31], v[112:127]
  v_cvt_pk_bf16_f32 v64, v96, v97
  v_cvt_pk_bf16_f32 v65, v98, v99
  v_exp_f32 v104, v104
  v_cvt_pk_bf16_f32 v66, v100, v101
  v_cvt_pk_bf16_f32 v67, v102, v103
  v_exp_f32 v105, v105
  v_exp_f32 v106, v106
  v_mfma_f32_32x32x16_bf16 v[128:143], v[56:59], v[64:67], v[128:143]
  v_exp_f32 v107, v107
  v_exp_f32 v108, v108
  v_exp_f32 v109, v109
  v_exp_f32 v110, v110
  v_exp_f32 v111, v111
  v_cvt_pk_bf16_f32 v68, v104, v105
  v_cvt_pk_bf16_f32 v69, v106, v107
  v_cvt_pk_bf16_f32 v70, v108, v109
  v_cvt_pk_bf16_f32 v71, v110, v111
  s_waitcnt lgkmcnt(0)
  v_mfma_f32_32x32x16_bf16 v[96:111], v[32:35], v[16:19], v[160:175]
  v_exp_f32 v112, v112
  v_exp_f32 v113, v113
  v_exp_f32 v114, v114
  v_mfma_f32_32x32x16_bf16 v[128:143], v[60:63], v[68:71], v[128:143]
  v_exp_f32 v115, v115
  v_exp_f32 v116, v116
  v_exp_f32 v117, v117
  v_smfmac_f32_16x16x64_bf16 v[76:79], v[72:75], v[64:71], v84
  v_exp_f32 v118, v118
  v_exp_f32 v119, v119
  v_mfma_f32_32x32x16_bf16 v[96:111], v[36:39], v[20:23], v[96:111]
  v_cvt_pk_bf16_f32 v64, v112, v113
  v_cvt_pk_bf16_f32 v65, v114, v115
  v_exp_f32 v120, v120
  v_cvt_pk_bf16_f32 v66, v116, v117
  v_cvt_pk_bf16_f32 v67, v118, v119
  v_exp_f32 v121, v121
  v_exp_f32 v122, v122
  v_mfma_f32_32x32x16_bf16 v[144:159], v[56:59], v[64:67], v[144:159]
  v_exp_f32 v123, v123
  v_exp_f32 v124, v124
  v_exp_f32 v125, v125
  ds_read_b32 v15, v14
  v_exp_f32 v126, v126
  v_exp_f32 v127, v127
  v_cvt_pk_bf16_f32 v68, v120, v121
  v_cvt_pk_bf16_f32 v69, v122, v123
  v_cvt_pk_bf16_f32 v70, v124, v125
  v_cvt_pk_bf16_f32 v71, v126, v127
  s_add_u32 s28, s28, 1
  s_cmp_lg_u32 s28, 7
  s_waitcnt lgkmcnt(0)
  s_cbranch_scc1 ATT_LOOP
  v_mfma_f32_32x32x16_bf16 v[144:159], v[60:63], v[68:71], v[144:159]
  v_smfmac_f32_16x16x64_bf16 v[80:83], v[72:75], v[64:71], v84
  v_add_f32 v76, v76, v77
  s_nop 10
  v_add_f32 v80, v80, v81
  s_setprio 3
  s_mov_b32 s16, 0x71800000
  v_max3_f32 v8, abs(v128), abs(v129), v76
  v_add_f32 v10, v128, v129
  v_max3_f32 v9, abs(v144), abs(v145), v80
  v_add_f32 v11, v144, v145
  v_max3_f32 v8, v8, abs(v130), abs(v131)
  v_add_f32 v10, v10, v130
  v_add_f32 v86, v131, v76
  v_max3_f32 v9, v9, abs(v146), abs(v147)
  v_add_f32 v11, v11, v146
  v_add_f32 v87, v147, v80
  v_max3_f32 v8, v8, abs(v132), abs(v133)
  v_add_f32 v10, v10, v132
  v_add_f32 v86, v86, v133
  v_max3_f32 v9, v9, abs(v148), abs(v149)
  v_add_f32 v11, v11, v148
  v_add_f32 v87, v87, v149
  v_max3_f32 v8, v8, abs(v134), abs(v135)
  v_add_f32 v10, v10, v134
  v_add_f32 v86, v86, v135
  v_max3_f32 v9, v9, abs(v150), abs(v151)
  v_add_f32 v11, v11, v150
  v_add_f32 v87, v87, v151
  v_max3_f32 v8, v8, abs(v136), abs(v137)
  v_add_f32 v10, v10, v136
  v_add_f32 v86, v86, v137
  v_max3_f32 v9, v9, abs(v152), abs(v153)
  v_add_f32 v11, v11, v152
  v_add_f32 v87, v87, v153
  v_max3_f32 v8, v8, abs(v138), abs(v139)
  v_add_f32 v10, v10, v138
  v_add_f32 v86, v86, v139
  v_max3_f32 v9, v9, abs(v154), abs(v155)
  v_add_f32 v11, v11, v154
  v_add_f32 v87, v87, v155
  v_max3_f32 v8, v8, abs(v140), abs(v141)
  v_add_f32 v10, v10, v140
  v_add_f32 v86, v86, v141
  v_max3_f32 v9, v9, abs(v156), abs(v157)
  v_add_f32 v11, v11, v156
  v_add_f32 v87, v87, v157
  v_max3_f32 v8, v8, abs(v142), abs(v143)
  v_add_f32 v10, v10, v142
  v_add_f32 v86, v86, v143
  v_max3_f32 v9, v9, abs(v158), abs(v159)
  v_add_f32 v11, v11, v158
  v_add_f32 v87, v87, v159
  v_max_f32 v8, v8, v9
  v_add_f32 v10, v10, v11
  v_add_f32 v86, v86, v87
  v_add_f32 v9, v10, v86
  v_cmp_nlt_f32 vcc, v8, s16
  v_cmp_u_f32 s[18:19], v9, v9
  s_nop 0
  s_or_b64 vcc, vcc, s[18:19]
  s_cbranch_vccz ATT_FIN
  v_mov_b32 v128, 0
  v_mov_b32 v129, 0
  v_mov_b32 v130, 0
  v_mov_b32 v131, 0
  v_mov_b32 v132, 0
  v_mov_b32 v133, 0
  v_mov_b32 v134, 0
  v_mov_b32 v135, 0
  v_mov_b32 v136, 0
  v_mov_b32 v137, 0
  v_mov_b32 v138, 0
  v_mov_b32 v139, 0
  v_mov_b32 v140, 0
  v_mov_b32 v141, 0
  v_mov_b32 v142, 0
  v_mov_b32 v143, 0
  v_mov_b32 v76, 0
  v_mov_b32 v77, 0
  v_mov_b32 v78, 0
  v_mov_b32 v79, 0
  v_mov_b32 v10, 0xff61b1e6
  s_mov_b32 s29, 0
ATT_FB0:
  buffer_load_dwordx4 v[32:35], v4, s[36:39], s29 offen offset:0
  buffer_load_dwordx4 v[40:43], v3, s[36:39], s29 offen offset:2048
  buffer_load_dwordx4 v[36:39], v4, s[36:39], s29 offen offset:512
  buffer_load_dwordx4 v[44:47], v3, s[36:39], s29 offen offset:3072
  s_waitcnt vmcnt(0)
  v_mfma_f32_32x32x16_bf16 v[96:111], v[32:35], v[16:19], 0
  v_mfma_f32_32x32x16_bf16 v[96:111], v[36:39], v[20:23], v[96:111]
  s_nop 11
  v_max3_f32 v8, v96, v97, v10
  v_max3_f32 v8, v8, v98, v99
  v_max3_f32 v8, v8, v100, v101
  v_max3_f32 v8, v8, v102, v103
  v_max3_f32 v8, v8, v104, v105
  v_max3_f32 v8, v8, v106, v107
  v_max3_f32 v8, v8, v108, v109
  v_max3_f32 v8, v8, v110, v111
  v_mov_b32 v9, v8
  s_nop 1
  v_permlane32_swap_b32 v8, v9
  v_max_f32 v8, v8, v9
  v_sub_f32 v11, v10, v8
  v_exp_f32 v11, v11
  v_mov_b32 v10, v8
  v_sub_f32 v96, v96, v8
  v_sub_f32 v97, v97, v8
  v_sub_f32 v98, v98, v8
  v_sub_f32 v99, v99, v8
  v_sub_f32 v100, v100, v8
  v_sub_f32 v101, v101, v8
  v_sub_f32 v102, v102, v8
  v_sub_f32 v103, v103, v8
  v_sub_f32 v104, v104, v8
  v_sub_f32 v105, v105, v8
  v_sub_f32 v106, v106, v8
  v_sub_f32 v107, v107, v8
  v_sub_f32 v108, v108, v8
  v_sub_f32 v109, v109, v8
  v_sub_f32 v110, v110, v8
  v_sub_f32 v111, v111, v8
  v_exp_f32 v96, v96
  v_exp_f32 v97, v97
  v_exp_f32 v98, v98
  v_exp_f32 v99, v99
  v_exp_f32 v100, v100
  v_exp_f32 v101, v101
  v_exp_f32 v102, v102
  v_exp_f32 v103, v103
  v_exp_f32 v104, v104
  v_exp_f32 v105, v105
  v_exp_f32 v106, v106
  v_exp_f32 v107, v107
  v_exp_f32 v108, v108
  v_exp_f32 v109, v109
  v_exp_f32 v110, v110
  v_exp_f32 v111, v111
  v_mul_f32 v128, v128, v11
  v_mul_f32 v129, v129, v11
  v_mul_f32 v130, v130, v11
  v_mul_f32 v131, v131, v11
  v_mul_f32 v132, v132, v11
  v_mul_f32 v133, v133, v11
  v_mul_f32 v134, v134, v11
  v_mul_f32 v135, v135, v11
  v_mul_f32 v136, v136, v11
  v_mul_f32 v137, v137, v11
  v_mul_f32 v138, v138, v11
  v_mul_f32 v139, v139, v11
  v_mul_f32 v140, v140, v11
  v_mul_f32 v141, v141, v11
  v_mul_f32 v142, v142, v11
  v_mul_f32 v143, v143, v11
  v_mul_f32 v76, v76, v11
  v_mul_f32 v77, v77, v11
  v_mul_f32 v78, v78, v11
  v_mul_f32 v79, v79, v11
  v_cvt_pk_bf16_f32 v64, v96, v97
  v_cvt_pk_bf16_f32 v65, v98, v99
  v_cvt_pk_bf16_f32 v66, v100, v101
  v_cvt_pk_bf16_f32 v67, v102, v103
  v_cvt_pk_bf16_f32 v68, v104, v105
  v_cvt_pk_bf16_f32 v69, v106, v107
  v_cvt_pk_bf16_f32 v70, v108, v109
  v_cvt_pk_bf16_f32 v71, v110, v111
  v_mfma_f32_32x32x16_bf16 v[128:143], v[40:43], v[64:67], v[128:143]
  s_nop 0
  v_mfma_f32_32x32x16_bf16 v[128:143], v[44:47], v[68:71], v[128:143]
  v_smfmac_f32_16x16x64_bf16 v[76:79], v[72:75], v[64:71], v84
  s_add_u32 s29, s29, 4096
  s_cmp_lg_u32 s29, 262144
  s_cbranch_scc1 ATT_FB0
  s_nop 8
  v_add_f32 v76, v76, v77
  v_mov_b32 v144, 0
  v_mov_b32 v145, 0
  v_mov_b32 v146, 0
  v_mov_b32 v147, 0
  v_mov_b32 v148, 0
  v_mov_b32 v149, 0
  v_mov_b32 v150, 0
  v_mov_b32 v151, 0
  v_mov_b32 v152, 0
  v_mov_b32 v153, 0
  v_mov_b32 v154, 0
  v_mov_b32 v155, 0
  v_mov_b32 v156, 0
  v_mov_b32 v157, 0
  v_mov_b32 v158, 0
  v_mov_b32 v159, 0
  v_mov_b32 v80, 0
  v_mov_b32 v81, 0
  v_mov_b32 v82, 0
  v_mov_b32 v83, 0
  v_mov_b32 v10, 0xff61b1e6
  s_mov_b32 s29, 0
ATT_FB1:
  buffer_load_dwordx4 v[32:35], v4, s[36:39], s29 offen offset:0
  buffer_load_dwordx4 v[40:43], v3, s[36:39], s29 offen offset:2048
  buffer_load_dwordx4 v[36:39], v4, s[36:39], s29 offen offset:512
  buffer_load_dwordx4 v[44:47], v3, s[36:39], s29 offen offset:3072
  s_waitcnt vmcnt(0)
  v_mfma_f32_32x32x16_bf16 v[96:111], v[32:35], v[24:27], 0
  v_mfma_f32_32x32x16_bf16 v[96:111], v[36:39], v[28:31], v[96:111]
  s_nop 11
  v_max3_f32 v8, v96, v97, v10
  v_max3_f32 v8, v8, v98, v99
  v_max3_f32 v8, v8, v100, v101
  v_max3_f32 v8, v8, v102, v103
  v_max3_f32 v8, v8, v104, v105
  v_max3_f32 v8, v8, v106, v107
  v_max3_f32 v8, v8, v108, v109
  v_max3_f32 v8, v8, v110, v111
  v_mov_b32 v9, v8
  s_nop 1
  v_permlane32_swap_b32 v8, v9
  v_max_f32 v8, v8, v9
  v_sub_f32 v11, v10, v8
  v_exp_f32 v11, v11
  v_mov_b32 v10, v8
  v_sub_f32 v96, v96, v8
  v_sub_f32 v97, v97, v8
  v_sub_f32 v98, v98, v8
  v_sub_f32 v99, v99, v8
  v_sub_f32 v100, v100, v8
  v_sub_f32 v101, v101, v8
  v_sub_f32 v102, v102, v8
  v_sub_f32 v103, v103, v8
  v_sub_f32 v104, v104, v8
  v_sub_f32 v105, v105, v8
  v_sub_f32 v106, v106, v8
  v_sub_f32 v107, v107, v8
  v_sub_f32 v108, v108, v8
  v_sub_f32 v109, v109, v8
  v_sub_f32 v110, v110, v8
  v_sub_f32 v111, v111, v8
  v_exp_f32 v96, v96
  v_exp_f32 v97, v97
  v_exp_f32 v98, v98
  v_exp_f32 v99, v99
  v_exp_f32 v100, v100
  v_exp_f32 v101, v101
  v_exp_f32 v102, v102
  v_exp_f32 v103, v103
  v_exp_f32 v104, v104
  v_exp_f32 v105, v105
  v_exp_f32 v106, v106
  v_exp_f32 v107, v107
  v_exp_f32 v108, v108
  v_exp_f32 v109, v109
  v_exp_f32 v110, v110
  v_exp_f32 v111, v111
  v_mul_f32 v144, v144, v11
  v_mul_f32 v145, v145, v11
  v_mul_f32 v146, v146, v11
  v_mul_f32 v147, v147, v11
  v_mul_f32 v148, v148, v11
  v_mul_f32 v149, v149, v11
  v_mul_f32 v150, v150, v11
  v_mul_f32 v151, v151, v11
  v_mul_f32 v152, v152, v11
  v_mul_f32 v153, v153, v11
  v_mul_f32 v154, v154, v11
  v_mul_f32 v155, v155, v11
  v_mul_f32 v156, v156, v11
  v_mul_f32 v157, v157, v11
  v_mul_f32 v158, v158, v11
  v_mul_f32 v159, v159, v11
  v_mul_f32 v80, v80, v11
  v_mul_f32 v81, v81, v11
  v_mul_f32 v82, v82, v11
  v_mul_f32 v83, v83, v11
  v_cvt_pk_bf16_f32 v64, v96, v97
  v_cvt_pk_bf16_f32 v65, v98, v99
  v_cvt_pk_bf16_f32 v66, v100, v101
  v_cvt_pk_bf16_f32 v67, v102, v103
  v_cvt_pk_bf16_f32 v68, v104, v105
  v_cvt_pk_bf16_f32 v69, v106, v107
  v_cvt_pk_bf16_f32 v70, v108, v109
  v_cvt_pk_bf16_f32 v71, v110, v111
  v_mfma_f32_32x32x16_bf16 v[144:159], v[40:43], v[64:67], v[144:159]
  s_nop 0
  v_mfma_f32_32x32x16_bf16 v[144:159], v[44:47], v[68:71], v[144:159]
  v_smfmac_f32_16x16x64_bf16 v[80:83], v[72:75], v[64:71], v84
  s_add_u32 s29, s29, 4096
  s_cmp_lg_u32 s29, 262144
  s_cbranch_scc1 ATT_FB1
  s_nop 8
  v_add_f32 v80, v80, v81
ATT_FIN:
  v_mov_b32 v23, v13
  v_mov_b32 v24, v14
  v_mov_b32 v25, v12
  v_bfe_u32 v2, v1, 4, 1
  v_lshlrev_b32 v5, 15, v2
  v_lshrrev_b32 v2, 5, v1
  v_lshl_add_u32 v5, v2, 8, v5
  v_and_b32 v2, 15, v1
  v_lshl_add_u32 v5, v2, 4, v5
  s_lshl_b32 s16, s22, 2
  s_add_u32 s16, s16, s20
  s_lshl_b32 s16, s16, 7
  s_add_u32 s16, s16, s21
  s_lshl_b32 s16, s16, 10
  s_add_u32 s16, s16, 9437184
  s_add_u32 s17, s16, 65536
  v_rcp_f32 v8, v76
  v_rcp_f32 v9, v80
  v_mul_f32 v128, v128, v8
  v_mul_f32 v129, v129, v8
  v_mul_f32 v130, v130, v8
  v_mul_f32 v131, v131, v8
  v_mul_f32 v132, v132, v8
  v_mul_f32 v133, v133, v8
  v_mul_f32 v134, v134, v8
  v_mul_f32 v135, v135, v8
  v_mul_f32 v136, v136, v8
  v_mul_f32 v137, v137, v8
  v_mul_f32 v138, v138, v8
  v_mul_f32 v139, v139, v8
  v_mul_f32 v140, v140, v8
  v_mul_f32 v141, v141, v8
  v_mul_f32 v142, v142, v8
  v_mul_f32 v143, v143, v8
  v_cvt_pk_bf16_f32 v96, v128, v129
  v_cvt_pk_bf16_f32 v97, v130, v131
  v_cvt_pk_bf16_f32 v98, v132, v133
  v_cvt_pk_bf16_f32 v99, v134, v135
  v_cvt_pk_bf16_f32 v100, v136, v137
  v_cvt_pk_bf16_f32 v101, v138, v139
  v_cvt_pk_bf16_f32 v102, v140, v141
  v_cvt_pk_bf16_f32 v103, v142, v143
  buffer_store_dwordx4 v[96:99], v5, s[32:35], s16 offen offset:0 sc1
  buffer_store_dwordx4 v[100:103], v5, s[32:35], s16 offen offset:512 sc1
  v_mul_f32 v144, v144, v9
  v_mul_f32 v145, v145, v9
  v_mul_f32 v146, v146, v9
  v_mul_f32 v147, v147, v9
  v_mul_f32 v148, v148, v9
  v_mul_f32 v149, v149, v9
  v_mul_f32 v150, v150, v9
  v_mul_f32 v151, v151, v9
  v_mul_f32 v152, v152, v9
  v_mul_f32 v153, v153, v9
  v_mul_f32 v154, v154, v9
  v_mul_f32 v155, v155, v9
  v_mul_f32 v156, v156, v9
  v_mul_f32 v157, v157, v9
  v_mul_f32 v158, v158, v9
  v_mul_f32 v159, v159, v9
  v_cvt_pk_bf16_f32 v112, v144, v145
  v_cvt_pk_bf16_f32 v113, v146, v147
  v_cvt_pk_bf16_f32 v114, v148, v149
  v_cvt_pk_bf16_f32 v115, v150, v151
  v_cvt_pk_bf16_f32 v116, v152, v153
  v_cvt_pk_bf16_f32 v117, v154, v155
  v_cvt_pk_bf16_f32 v118, v156, v157
  v_cvt_pk_bf16_f32 v119, v158, v159
  buffer_store_dwordx4 v[112:115], v5, s[32:35], s17 offen offset:0 sc1
  buffer_store_dwordx4 v[116:119], v5, s[32:35], s17 offen offset:512 sc1
  s_load_dwordx2 s[8:9], s[0:1], 32
  s_and_b32 s21, s2, 1
  s_bfe_u32 s16, s2, 0x10001
  s_lshl_b32 s16, s16, 3
  s_bfe_u32 s17, s2, 0x30003
  s_add_u32 s22, s16, s17
  s_bfe_u32 s16, s2, 0x10002
  s_lshl_b32 s16, s16, 2
  s_bfe_u32 s17, s2, 0x20006
  s_add_u32 s23, s16, s17
  v_lshrrev_b32 v2, 4, v1
  s_lshl_b32 s16, s20, 3
  v_add_u32 v4, s16, v2
  v_lshlrev_b32 v4, 11, v4
  v_bfe_u32 v5, v1, 1, 3
  v_lshlrev_b32 v6, 1, v2
  v_xor_b32 v6, v6, v5
  v_mov_b32 v7, v6
  v_and_b32 v2, 1, v1
  v_lshl_add_u32 v4, v2, 4, v4
  s_lshl_b32 s16, s23, 8
  v_add_u32 v4, s16, v4
  v_add_u32 v5, 7168, v4
  v_lshl_add_u32 v4, v6, 5, v4
  v_lshl_add_u32 v5, v7, 5, v5
  s_lshl_b32 s48, s21, 20
  s_lshl_b32 s46, s20, 11
  s_add_u32 s46, s46, 65536
  s_lshl_b32 s16, s22, 2
  s_add_u32 s16, s16, s20
  s_lshl_b32 s44, s16, 16
  s_lshl_b32 s16, s21, 14
  s_add_u32 s44, s44, s16
  s_add_u32 s44, s44, 9437184
  v_bfe_u32 v2, v1, 4, 1
  v_lshlrev_b32 v10, 15, v2
  v_lshrrev_b32 v2, 5, v1
  v_lshl_add_u32 v10, v2, 8, v10
  v_and_b32 v2, 15, v1
  v_lshl_add_u32 v10, v2, 4, v10
  s_lshl_b32 s60, s2, 3
  s_add_u32 s60, s60, s54
  s_lshl_b32 s60, s60, 2
  s_add_u32 s60, s60, 4739072
  s_waitcnt vmcnt(0) lgkmcnt(0)
  v_mov_b32 v2, s55
  v_mov_b32 v8, 0
  s_mov_b64 exec, 1
  buffer_store_dword v2, v8, s[32:35], s60 offen sc1
  s_mov_b64 exec, -1
  s_mov_b32 s24, s8
  s_mov_b32 s25, s9
  s_mov_b32 s26, 0x200000
  s_mov_b32 s27, 0x20000
  s_and_b32 s16, s23, 3
  s_mul_i32 s50, s16, 0
  s_mov_b32 s51, s50
  ds_add_u32 v23, v25
  s_add_u32 s53, s53, 1
SY3:
  ds_read_b32 v26, v24
  s_waitcnt lgkmcnt(0)
  v_cmp_gt_u32 vcc, s53, v26
  s_nop 0
  s_cbranch_vccnz SY3
  s_add_u32 m0, s46, 0
  s_lshl_b32 s49, s50, 16
  s_add_u32 s49, s49, s48
  buffer_load_dwordx4 v4, s[24:27], s49 offen lds
  s_add_u32 s50, s50, 1
  s_cmp_eq_u32 s50, 8
  s_cselect_b32 s50, 0, s50
  buffer_load_dwordx4 v5, s[24:27], s49 offen offset:1024 lds
  s_add_u32 m0, s46, 8192
  s_lshl_b32 s49, s50, 16
  s_add_u32 s49, s49, s48
  buffer_load_dwordx4 v4, s[24:27], s49 offen lds
  s_add_u32 s50, s50, 1
  s_cmp_eq_u32 s50, 8
  s_cselect_b32 s50, 0, s50
  buffer_load_dwordx4 v5, s[24:27], s49 offen offset:1024 lds
  s_add_u32 m0, s46, 16384
  s_lshl_b32 s49, s50, 16
  s_add_u32 s49, s49, s48
  buffer_load_dwordx4 v4, s[24:27], s49 offen lds
  s_add_u32 s50, s50, 1
  s_cmp_eq_u32 s50, 8
  s_cselect_b32 s50, 0, s50
  buffer_load_dwordx4 v5, s[24:27], s49 offen offset:1024 lds
  s_add_u32 m0, s46, 24576
  s_lshl_b32 s49, s50, 16
  s_add_u32 s49, s49, s48
  buffer_load_dwordx4 v4, s[24:27], s49 offen lds
  s_add_u32 s50, s50, 1
  s_cmp_eq_u32 s50, 8
  s_cselect_b32 s50, 0, s50
  buffer_load_dwordx4 v5, s[24:27], s49 offen offset:1024 lds
  s_add_u32 m0, s46, 32768
  s_lshl_b32 s49, s50, 16
  s_add_u32 s49, s49, s48
  buffer_load_dwordx4 v4, s[24:27], s49 offen lds
  s_add_u32 s50, s50, 1
  s_cmp_eq_u32 s50, 8
  s_cselect_b32 s50, 0, s50
  buffer_load_dwordx4 v5, s[24:27], s49 offen offset:1024 lds
  s_add_u32 m0, s46, 40960
  s_lshl_b32 s49, s50, 16
  s_add_u32 s49, s49, s48
  buffer_load_dwordx4 v4, s[24:27], s49 offen lds
  s_add_u32 s50, s50, 1
  s_cmp_eq_u32 s50, 8
  s_cselect_b32 s50, 0, s50
  buffer_load_dwordx4 v5, s[24:27], s49 offen offset:1024 lds
  s_add_u32 m0, s46, 49152
  s_lshl_b32 s49, s50, 16
  s_add_u32 s49, s49, s48
  buffer_load_dwordx4 v4, s[24:27], s49 offen lds
  s_add_u32 s50, s50, 1
  s_cmp_eq_u32 s50, 8
  s_cselect_b32 s50, 0, s50
  buffer_load_dwordx4 v5, s[24:27], s49 offen offset:1024 lds
  s_add_u32 m0, s46, 57344
  s_lshl_b32 s49, s50, 16
  s_add_u32 s49, s49, s48
  buffer_load_dwordx4 v4, s[24:27], s49 offen lds
  s_add_u32 s50, s50, 1
  s_cmp_eq_u32 s50, 8
  s_cselect_b32 s50, 0, s50
  buffer_load_dwordx4 v5, s[24:27], s49 offen offset:1024 lds
  v_lshrrev_b32 v2, 5, v1
  v_lshlrev_b32 v12, 10, v2
  v_bfe_u32 v9, v1, 2, 2
  v_lshl_add_u32 v12, v9, 8, v12
  v_lshlrev_b32 v9, 1, v9
  v_bfe_u32 v2, v1, 4, 1
  v_xor_b32 v9, v9, v2
  v_lshl_add_u32 v12, v9, 5, v12
  v_and_b32 v9, 3, v1
  v_lshl_add_u32 v12, v9, 3, v12
  v_add_u32 v12, 65536, v12
  v_xor_b32 v13, 64, v12
  v_xor_b32 v14, 128, v12
  v_xor_b32 v15, 192, v12
  v_add_u32 v16, 0x10000, v12
  v_add_u32 v17, 0x10000, v13
  v_add_u32 v18, 0x10000, v14
  v_add_u32 v19, 0x10000, v15
  v_and_b32 v2, 3, v1
  v_lshlrev_b32 v9, 8, v2
  v_bfe_u32 v2, v1, 2, 2
  v_lshl_add_u32 v9, v2, 5, v9
  v_bfe_u32 v2, v1, 4, 1
  v_lshl_add_u32 v9, v2, 2, v9
  s_lshr_b32 s16, s22, 1
  s_lshl_b32 s18, s16, 10
  s_and_b32 s16, s22, 1
  s_lshl_b32 s16, s16, 3
  s_add_u32 s18, s18, s16
  s_lshl_b32 s16, s21, 7
  s_add_u32 s18, s18, s16
  s_add_u32 s18, s18, 4739072
  s_cmp_lg_u32 s20, 0
  s_cbranch_scc1 WO_NPL
  s_mov_b32 exec_lo, 0xff00ff
  s_mov_b32 exec_hi, 0
  s_mov_b32 s17, 0x40000
POLL4:
  buffer_load_dword v2, v9, s[32:35], s18 offen sc1
  s_waitcnt vmcnt(0)
  v_cmp_ne_u32 vcc, s55, v2
  s_nop 0
  s_cbranch_vccz POLL4_D
  s_sleep 4
  s_sub_u32 s17, s17, 1
  s_cmp_lg_u32 s17, 0
  s_cbranch_scc1 POLL4
POLL4_D:
  s_mov_b64 exec, -1
WO_NPL:
  s_waitcnt vmcnt(0)
  ds_add_u32 v23, v25
  s_add_u32 s53, s53, 1
SY5:
  s_sleep 1
  ds_read_b32 v26, v24
  s_waitcnt lgkmcnt(0)
  v_cmp_gt_u32 vcc, s53, v26
  s_nop 0
  s_cbranch_vccnz SY5
  s_lshl_b32 s45, s51, 10
  s_add_u32 s45, s45, s44
  buffer_load_dwordx4 v[160:163], v10, s[32:35], s45 offen
  s_add_u32 s51, s51, 1
  s_cmp_eq_u32 s51, 8
  s_cselect_b32 s51, 0, s51
  buffer_load_dwordx4 v[164:167], v10, s[32:35], s45 offen offset:512
  s_lshl_b32 s45, s51, 10
  s_add_u32 s45, s45, s44
  buffer_load_dwordx4 v[168:171], v10, s[32:35], s45 offen
  s_add_u32 s51, s51, 1
  s_cmp_eq_u32 s51, 8
  s_cselect_b32 s51, 0, s51
  buffer_load_dwordx4 v[172:175], v10, s[32:35], s45 offen offset:512
  s_lshl_b32 s45, s51, 10
  s_add_u32 s45, s45, s44
  buffer_load_dwordx4 v[176:179], v10, s[32:35], s45 offen
  s_add_u32 s51, s51, 1
  s_cmp_eq_u32 s51, 8
  s_cselect_b32 s51, 0, s51
  buffer_load_dwordx4 v[180:183], v10, s[32:35], s45 offen offset:512
  s_lshl_b32 s45, s51, 10
  s_add_u32 s45, s45, s44
  buffer_load_dwordx4 v[184:187], v10, s[32:35], s45 offen
  s_add_u32 s51, s51, 1
  s_cmp_eq_u32 s51, 8
  s_cselect_b32 s51, 0, s51
  buffer_load_dwordx4 v[188:191], v10, s[32:35], s45 offen offset:512
  s_setprio 0
  ds_read_b64_tr_b16 v[32:33], v12 offset:0
  ds_read_b64_tr_b16 v[34:35], v12 offset:2048
  ds_read_b64_tr_b16 v[36:37], v13 offset:0
  ds_read_b64_tr_b16 v[38:39], v13 offset:2048
  ds_read_b64_tr_b16 v[40:41], v14 offset:0
  ds_read_b64_tr_b16 v[42:43], v14 offset:2048
  ds_read_b64_tr_b16 v[44:45], v15 offset:0
  ds_read_b64_tr_b16 v[46:47], v15 offset:2048
  ds_read_b64_tr_b16 v[48:49], v12 offset:4096
  ds_read_b64_tr_b16 v[50:51], v12 offset:6144
  ds_read_b64_tr_b16 v[52:53], v13 offset:4096
  ds_read_b64_tr_b16 v[54:55], v13 offset:6144
  ds_read_b64_tr_b16 v[56:57], v14 offset:4096
  ds_read_b64_tr_b16 v[58:59], v14 offset:6144
  ds_read_b64_tr_b16 v[60:61], v15 offset:4096
  ds_read_b64_tr_b16 v[62:63], v15 offset:6144
  s_waitcnt vmcnt(6) lgkmcnt(0)
  v_mfma_f32_32x32x16_bf16 v[64:79], v[32:35], v[160:163], 0
  ds_read_b64_tr_b16 v[128:129], v12 offset:8192
  ds_read_b64_tr_b16 v[130:131], v12 offset:10240
  ds_read_b64_tr_b16 v[132:133], v13 offset:8192
  v_mfma_f32_32x32x16_bf16 v[80:95], v[36:39], v[160:163], 0
  ds_read_b64_tr_b16 v[134:135], v13 offset:10240
  ds_read_b64_tr_b16 v[136:137], v14 offset:8192
  ds_read_b64_tr_b16 v[138:139], v14 offset:10240
  s_lshl_b32 s45, s51, 10
  s_add_u32 s45, s45, s44
  buffer_load_dwordx4 v[192:195], v10, s[32:35], s45 offen
  v_mfma_f32_32x32x16_bf16 v[96:111], v[40:43], v[160:163], 0
  ds_read_b64_tr_b16 v[140:141], v15 offset:8192
  ds_read_b64_tr_b16 v[142:143], v15 offset:10240
  ds_read_b64_tr_b16 v[144:145], v12 offset:12288
  s_add_u32 s51, s51, 1
  s_cmp_eq_u32 s51, 8
  s_cselect_b32 s51, 0, s51
  buffer_load_dwordx4 v[196:199], v10, s[32:35], s45 offen offset:512
  v_mfma_f32_32x32x16_bf16 v[112:127], v[44:47], v[160:163], 0
  ds_read_b64_tr_b16 v[146:147], v12 offset:14336
  ds_read_b64_tr_b16 v[148:149], v13 offset:12288
  ds_read_b64_tr_b16 v[150:151], v13 offset:14336
  s_lshl_b32 s45, s51, 10
  s_add_u32 s45, s45, s44
  buffer_load_dwordx4 v[200:203], v10, s[32:35], s45 offen
  v_mfma_f32_32x32x16_bf16 v[64:79], v[48:51], v[164:167], v[64:79]
  ds_read_b64_tr_b16 v[152:153], v14 offset:12288
  ds_read_b64_tr_b16 v[154:155], v14 offset:14336
  ds_read_b64_tr_b16 v[156:157], v15 offset:12288
  v_mfma_f32_32x32x16_bf16 v[80:95], v[52:55], v[164:167], v[80:95]
  ds_read_b64_tr_b16 v[158:159], v15 offset:14336
  s_add_u32 s51, s51, 1
  s_cmp_eq_u32 s51, 8
  s_cselect_b32 s51, 0, s51
  buffer_load_dwordx4 v[204:207], v10, s[32:35], s45 offen offset:512
  v_mfma_f32_32x32x16_bf16 v[96:111], v[56:59], v[164:167], v[96:111]
  s_lshl_b32 s45, s51, 10
  s_add_u32 s45, s45, s44
  buffer_load_dwordx4 v[208:211], v10, s[32:35], s45 offen
  v_mfma_f32_32x32x16_bf16 v[112:127], v[60:63], v[164:167], v[112:127]
  s_add_u32 s51, s51, 1
  s_cmp_eq_u32 s51, 8
  s_cselect_b32 s51, 0, s51
  buffer_load_dwordx4 v[212:215], v10, s[32:35], s45 offen offset:512
  s_waitcnt vmcnt(10) lgkmcnt(0)
  v_mfma_f32_32x32x16_bf16 v[64:79], v[128:131], v[168:171], v[64:79]
  ds_read_b64_tr_b16 v[32:33], v12 offset:16384
  ds_read_b64_tr_b16 v[34:35], v12 offset:18432
  ds_read_b64_tr_b16 v[36:37], v13 offset:16384
  v_mfma_f32_32x32x16_bf16 v[80:95], v[132:135], v[168:171], v[80:95]
  ds_read_b64_tr_b16 v[38:39], v13 offset:18432
  ds_read_b64_tr_b16 v[40:41], v14 offset:16384
  ds_read_b64_tr_b16 v[42:43], v14 offset:18432
  v_mfma_f32_32x32x16_bf16 v[96:111], v[136:139], v[168:171], v[96:111]
  ds_read_b64_tr_b16 v[44:45], v15 offset:16384
  ds_read_b64_tr_b16 v[46:47], v15 offset:18432
  ds_read_b64_tr_b16 v[48:49], v12 offset:20480
  v_mfma_f32_32x32x16_bf16 v[112:127], v[140:143], v[168:171], v[112:127]
  ds_read_b64_tr_b16 v[50:51], v12 offset:22528
  ds_read_b64_tr_b16 v[52:53], v13 offset:20480
  ds_read_b64_tr_b16 v[54:55], v13 offset:22528
  s_lshl_b32 s45, s51, 10
  s_add_u32 s45, s45, s44
  buffer_load_dwordx4 v[216:219], v10, s[32:35], s45 offen
  v_mfma_f32_32x32x16_bf16 v[64:79], v[144:147], v[172:175], v[64:79]
  ds_read_b64_tr_b16 v[56:57], v14 offset:20480
  ds_read_b64_tr_b16 v[58:59], v14 offset:22528
  ds_read_b64_tr_b16 v[60:61], v15 offset:20480
  v_mfma_f32_32x32x16_bf16 v[80:95], v[148:151], v[172:175], v[80:95]
  ds_read_b64_tr_b16 v[62:63], v15 offset:22528
  v_mfma_f32_32x32x16_bf16 v[96:111], v[152:155], v[172:175], v[96:111]
  v_mfma_f32_32x32x16_bf16 v[112:127], v[156:159], v[172:175], v[112:127]
  s_add_u32 s51, s51, 1
  s_cmp_eq_u32 s51, 8
  s_cselect_b32 s51, 0, s51
  buffer_load_dwordx4 v[220:223], v10, s[32:35], s45 offen offset:512
  s_waitcnt vmcnt(10) lgkmcnt(0)
  v_mfma_f32_32x32x16_bf16 v[64:79], v[32:35], v[176:179], v[64:79]
  ds_read_b64_tr_b16 v[128:129], v12 offset:24576
  ds_read_b64_tr_b16 v[130:131], v12 offset:26624
  ds_read_b64_tr_b16 v[132:133], v13 offset:24576
  v_mfma_f32_32x32x16_bf16 v[80:95], v[36:39], v[176:179], v[80:95]
  ds_read_b64_tr_b16 v[134:135], v13 offset:26624
  ds_read_b64_tr_b16 v[136:137], v14 offset:24576
  ds_read_b64_tr_b16 v[138:139], v14 offset:26624
  v_mfma_f32_32x32x16_bf16 v[96:111], v[40:43], v[176:179], v[96:111]
  ds_read_b64_tr_b16 v[140:141], v15 offset:24576
  ds_read_b64_tr_b16 v[142:143], v15 offset:26624
  ds_read_b64_tr_b16 v[144:145], v12 offset:28672
  v_mfma_f32_32x32x16_bf16 v[112:127], v[44:47], v[176:179], v[112:127]
  ds_read_b64_tr_b16 v[146:147], v12 offset:30720
  ds_read_b64_tr_b16 v[148:149], v13 offset:28672
  ds_read_b64_tr_b16 v[150:151], v13 offset:30720
  v_mfma_f32_32x32x16_bf16 v[64:79], v[48:51], v[180:183], v[64:79]
  ds_read_b64_tr_b16 v[152:153], v14 offset:28672
  ds_read_b64_tr_b16 v[154:155], v14 offset:30720
  ds_read_b64_tr_b16 v[156:157], v15 offset:28672
  v_mfma_f32_32x32x16_bf16 v[80:95], v[52:55], v[180:183], v[80:95]
  ds_read_b64_tr_b16 v[158:159], v15 offset:30720
  v_mfma_f32_32x32x16_bf16 v[96:111], v[56:59], v[180:183], v[96:111]
  v_mfma_f32_32x32x16_bf16 v[112:127], v[60:63], v[180:183], v[112:127]
  s_waitcnt vmcnt(8) lgkmcnt(0)
  v_mfma_f32_32x32x16_bf16 v[64:79], v[128:131], v[184:187], v[64:79]
  ds_read_b64_tr_b16 v[32:33], v12 offset:32768
  ds_read_b64_tr_b16 v[34:35], v12 offset:34816
  ds_read_b64_tr_b16 v[36:37], v13 offset:32768
  v_mfma_f32_32x32x16_bf16 v[80:95], v[132:135], v[184:187], v[80:95]
  ds_read_b64_tr_b16 v[38:39], v13 offset:34816
  ds_read_b64_tr_b16 v[40:41], v14 offset:32768
  ds_read_b64_tr_b16 v[42:43], v14 offset:34816
  v_mfma_f32_32x32x16_bf16 v[96:111], v[136:139], v[184:187], v[96:111]
  ds_read_b64_tr_b16 v[44:45], v15 offset:32768
  ds_read_b64_tr_b16 v[46:47], v15 offset:34816
  ds_read_b64_tr_b16 v[48:49], v12 offset:36864
  v_mfma_f32_32x32x16_bf16 v[112:127], v[140:143], v[184:187], v[112:127]
  ds_read_b64_tr_b16 v[50:51], v12 offset:38912
  ds_read_b64_tr_b16 v[52:53], v13 offset:36864
  ds_read_b64_tr_b16 v[54:55], v13 offset:38912
  v_mfma_f32_32x32x16_bf16 v[64:79], v[144:147], v[188:191], v[64:79]
  ds_read_b64_tr_b16 v[56:57], v14 offset:36864
  ds_read_b64_tr_b16 v[58:59], v14 offset:38912
  ds_read_b64_tr_b16 v[60:61], v15 offset:36864
  v_mfma_f32_32x32x16_bf16 v[80:95], v[148:151], v[188:191], v[80:95]
  ds_read_b64_tr_b16 v[62:63], v15 offset:38912
  v_mfma_f32_32x32x16_bf16 v[96:111], v[152:155], v[188:191], v[96:111]
  v_mfma_f32_32x32x16_bf16 v[112:127], v[156:159], v[188:191], v[112:127]
  s_waitcnt vmcnt(6) lgkmcnt(0)
  v_mfma_f32_32x32x16_bf16 v[64:79], v[32:35], v[192:195], v[64:79]
  ds_read_b64_tr_b16 v[128:129], v12 offset:40960
  ds_read_b64_tr_b16 v[130:131], v12 offset:43008
  ds_read_b64_tr_b16 v[132:133], v13 offset:40960
  v_mfma_f32_32x32x16_bf16 v[80:95], v[36:39], v[192:195], v[80:95]
  ds_read_b64_tr_b16 v[134:135], v13 offset:43008
  ds_read_b64_tr_b16 v[136:137], v14 offset:40960
  ds_read_b64_tr_b16 v[138:139], v14 offset:43008
  v_mfma_f32_32x32x16_bf16 v[96:111], v[40:43], v[192:195], v[96:111]
  ds_read_b64_tr_b16 v[140:141], v15 offset:40960
  ds_read_b64_tr_b16 v[142:143], v15 offset:43008
  ds_read_b64_tr_b16 v[144:145], v12 offset:45056
  v_mfma_f32_32x32x16_bf16 v[112:127], v[44:47], v[192:195], v[112:127]
  ds_read_b64_tr_b16 v[146:147], v12 offset:47104
  ds_read_b64_tr_b16 v[148:149], v13 offset:45056
  ds_read_b64_tr_b16 v[150:151], v13 offset:47104
  v_mfma_f32_32x32x16_bf16 v[64:79], v[48:51], v[196:199], v[64:79]
  ds_read_b64_tr_b16 v[152:153], v14 offset:45056
  ds_read_b64_tr_b16 v[154:155], v14 offset:47104
  ds_read_b64_tr_b16 v[156:157], v15 offset:45056
  v_mfma_f32_32x32x16_bf16 v[80:95], v[52:55], v[196:199], v[80:95]
  ds_read_b64_tr_b16 v[158:159], v15 offset:47104
  v_mfma_f32_32x32x16_bf16 v[96:111], v[56:59], v[196:199], v[96:111]
  v_mfma_f32_32x32x16_bf16 v[112:127], v[60:63], v[196:199], v[112:127]
  s_waitcnt vmcnt(4) lgkmcnt(0)
  v_mfma_f32_32x32x16_bf16 v[64:79], v[128:131], v[200:203], v[64:79]
  ds_read_b64_tr_b16 v[32:33], v12 offset:49152
  ds_read_b64_tr_b16 v[34:35], v12 offset:51200
  ds_read_b64_tr_b16 v[36:37], v13 offset:49152
  v_mfma_f32_32x32x16_bf16 v[80:95], v[132:135], v[200:203], v[80:95]
  ds_read_b64_tr_b16 v[38:39], v13 offset:51200
  ds_read_b64_tr_b16 v[40:41], v14 offset:49152
  ds_read_b64_tr_b16 v[42:43], v14 offset:51200
  v_mfma_f32_32x32x16_bf16 v[96:111], v[136:139], v[200:203], v[96:111]
  ds_read_b64_tr_b16 v[44:45], v15 offset:49152
  ds_read_b64_tr_b16 v[46:47], v15 offset:51200
  ds_read_b64_tr_b16 v[48:49], v12 offset:53248
  v_mfma_f32_32x32x16_bf16 v[112:127], v[140:143], v[200:203], v[112:127]
  ds_read_b64_tr_b16 v[50:51], v12 offset:55296
  ds_read_b64_tr_b16 v[52:53], v13 offset:53248
  ds_read_b64_tr_b16 v[54:55], v13 offset:55296
  v_mfma_f32_32x32x16_bf16 v[64:79], v[144:147], v[204:207], v[64:79]
  ds_read_b64_tr_b16 v[56:57], v14 offset:53248
  ds_read_b64_tr_b16 v[58:59], v14 offset:55296
  ds_read_b64_tr_b16 v[60:61], v15 offset:53248
  v_mfma_f32_32x32x16_bf16 v[80:95], v[148:151], v[204:207], v[80:95]
  ds_read_b64_tr_b16 v[62:63], v15 offset:55296
  v_mfma_f32_32x32x16_bf16 v[96:111], v[152:155], v[204:207], v[96:111]
  v_mfma_f32_32x32x16_bf16 v[112:127], v[156:159], v[204:207], v[112:127]
  s_waitcnt vmcnt(2) lgkmcnt(0)
  v_mfma_f32_32x32x16_bf16 v[64:79], v[32:35], v[208:211], v[64:79]
  ds_read_b64_tr_b16 v[128:129], v12 offset:57344
  ds_read_b64_tr_b16 v[130:131], v12 offset:59392
  ds_read_b64_tr_b16 v[132:133], v13 offset:57344
  v_mfma_f32_32x32x16_bf16 v[80:95], v[36:39], v[208:211], v[80:95]
  ds_read_b64_tr_b16 v[134:135], v13 offset:59392
  ds_read_b64_tr_b16 v[136:137], v14 offset:57344
  ds_read_b64_tr_b16 v[138:139], v14 offset:59392
  v_mfma_f32_32x32x16_bf16 v[96:111], v[40:43], v[208:211], v[96:111]
  ds_read_b64_tr_b16 v[140:141], v15 offset:57344
  ds_read_b64_tr_b16 v[142:143], v15 offset:59392
  ds_read_b64_tr_b16 v[144:145], v12 offset:61440
  v_mfma_f32_32x32x16_bf16 v[112:127], v[44:47], v[208:211], v[112:127]
  ds_read_b64_tr_b16 v[146:147], v12 offset:63488
  ds_read_b64_tr_b16 v[148:149], v13 offset:61440
  ds_read_b64_tr_b16 v[150:151], v13 offset:63488
  v_mfma_f32_32x32x16_bf16 v[64:79], v[48:51], v[212:215], v[64:79]
  ds_read_b64_tr_b16 v[152:153], v14 offset:61440
  ds_read_b64_tr_b16 v[154:155], v14 offset:63488
  ds_read_b64_tr_b16 v[156:157], v15 offset:61440
  v_mfma_f32_32x32x16_bf16 v[80:95], v[52:55], v[212:215], v[80:95]
  ds_read_b64_tr_b16 v[158:159], v15 offset:63488
  v_mfma_f32_32x32x16_bf16 v[96:111], v[56:59], v[212:215], v[96:111]
  v_mfma_f32_32x32x16_bf16 v[112:127], v[60:63], v[212:215], v[112:127]
  s_waitcnt vmcnt(0) lgkmcnt(0)
  v_mfma_f32_32x32x16_bf16 v[64:79], v[128:131], v[216:219], v[64:79]
  v_mfma_f32_32x32x16_bf16 v[80:95], v[132:135], v[216:219], v[80:95]
  v_mfma_f32_32x32x16_bf16 v[96:111], v[136:139], v[216:219], v[96:111]
  v_mfma_f32_32x32x16_bf16 v[112:127], v[140:143], v[216:219], v[112:127]
  v_mfma_f32_32x32x16_bf16 v[64:79], v[144:147], v[220:223], v[64:79]
  v_mfma_f32_32x32x16_bf16 v[80:95], v[148:151], v[220:223], v[80:95]
  v_mfma_f32_32x32x16_bf16 v[96:111], v[152:155], v[220:223], v[96:111]
  v_mfma_f32_32x32x16_bf16 v[112:127], v[156:159], v[220:223], v[112:127]
  s_setprio 3
  ds_add_u32 v23, v25
  s_add_u32 s53, s53, 1
SY6:
  ds_read_b32 v26, v24
  s_waitcnt lgkmcnt(0)
  v_cmp_gt_u32 vcc, s53, v26
  s_nop 0
  s_cbranch_vccnz SY6
  s_lshl_b32 s16, s20, 14
  s_add_u32 s16, s16, 65536
  v_bfe_u32 v2, v1, 4, 1
  v_lshlrev_b32 v9, 13, v2
  v_lshrrev_b32 v2, 5, v1
  v_lshl_add_u32 v9, v2, 8, v9
  v_and_b32 v2, 15, v1
  v_lshl_add_u32 v9, v2, 4, v9
  v_add_u32 v9, s16, v9
  ds_write_b128 v9, v[64:67] offset:0
  ds_write_b128 v9, v[68:71] offset:512
  ds_write_b128 v9, v[72:75] offset:1024
  ds_write_b128 v9, v[76:79] offset:1536
  ds_write_b128 v9, v[80:83] offset:2048
  ds_write_b128 v9, v[84:87] offset:2560
  ds_write_b128 v9, v[88:91] offset:3072
  ds_write_b128 v9, v[92:95] offset:3584
  ds_write_b128 v9, v[96:99] offset:4096
  ds_write_b128 v9, v[100:103] offset:4608
  ds_write_b128 v9, v[104:107] offset:5120
  ds_write_b128 v9, v[108:111] offset:5632
  ds_write_b128 v9, v[112:115] offset:6144
  ds_write_b128 v9, v[116:119] offset:6656
  ds_write_b128 v9, v[120:123] offset:7168
  ds_write_b128 v9, v[124:127] offset:7680
  ds_add_u32 v23, v25
  s_waitcnt lgkmcnt(0)
  s_endpgm
ATT_SP0:
  ds_read_b32 v15, v14
  s_waitcnt lgkmcnt(0)
  v_cmp_gt_u32 vcc, s53, v15
  s_nop 0
  s_cbranch_vccnz ATT_SP0
  s_branch ATT_CT0
ATT_SP7:
  ds_read_b32 v15, v14
  s_waitcnt lgkmcnt(0)
  v_cmp_gt_u32 vcc, s53, v15
  s_nop 0
  s_cbranch_vccnz ATT_SP7
  s_branch ATT_CT7
ATT_SP7F:
  ds_read_b32 v15, v14
  s_waitcnt lgkmcnt(0)
  v_cmp_gt_u32 vcc, s53, v15
  s_nop 0
  s_cbranch_vccnz ATT_SP7F
  s_branch ATT_CT7F
F_B:
  s_setprio 0
  s_lshl_b32 s16, s20, 11
  v_add_u32 v9, s16, v3
  ds_read_b128 v[192:195], v9 offset:0
  ds_read_b128 v[196:199], v9 offset:1024
  ds_read_b128 v[200:203], v9 offset:8192
  ds_read_b128 v[204:207], v9 offset:9216
  ds_read_b128 v[208:211], v9 offset:16384
  ds_read_b128 v[212:215], v9 offset:17408
  ds_read_b128 v[216:219], v9 offset:24576
  ds_read_b128 v[220:223], v9 offset:25600
  s_sub_u32 s16, s61, 917504
  s_cmp_eq_u32 s20, 3
  s_cbranch_scc1 HS7
  buffer_store_dwordx4 v[224:227], v3, s[32:35], s61 offen sc1
  s_add_u32 s61, s61, 114688
  buffer_store_dwordx4 v[228:231], v3, s[32:35], s61 offen sc1
  s_add_u32 s61, s61, 114688
  buffer_store_dwordx4 v[232:235], v3, s[32:35], s61 offen sc1
  s_add_u32 s61, s61, 114688
  buffer_store_dwordx4 v[236:239], v3, s[32:35], s61 offen sc1
  s_add_u32 s61, s61, 114688
  buffer_store_dwordx4 v[240:243], v3, s[32:35], s61 offen sc1
  s_add_u32 s61, s61, 114688
  buffer_store_dwordx4 v[244:247], v3, s[32:35], s61 offen sc1
  s_add_u32 s61, s61, 114688
  buffer_store_dwordx4 v[248:251], v3, s[32:35], s61 offen sc1
  s_add_u32 s61, s61, 114688
  buffer_store_dwordx4 v[252:255], v3, s[32:35], s61 offen sc1
  s_add_u32 s61, s61, 114688
  s_waitcnt lgkmcnt(0)
  buffer_store_dwordx4 v[192:195], v3, s[32:35], s16 offen sc1
  s_add_u32 s16, s16, 114688
  buffer_store_dwordx4 v[196:199], v3, s[32:35], s16 offen sc1
  s_add_u32 s16, s16, 114688
  buffer_store_dwordx4 v[200:203], v3, s[32:35], s16 offen sc1
  s_add_u32 s16, s16, 114688
  buffer_store_dwordx4 v[204:207], v3, s[32:35], s16 offen sc1
  s_add_u32 s16, s16, 114688
  buffer_store_dwordx4 v[208:211], v3, s[32:35], s16 offen sc1
  s_add_u32 s16, s16, 114688
  buffer_store_dwordx4 v[212:215], v3, s[32:35], s16 offen sc1
  s_add_u32 s16, s16, 114688
  buffer_store_dwordx4 v[216:219], v3, s[32:35], s16 offen sc1
  s_add_u32 s16, s16, 114688
  buffer_store_dwordx4 v[220:223], v3, s[32:35], s16 offen sc1
  s_add_u32 s16, s16, 114688
  s_branch HS7_D
HS7:
  buffer_store_dwordx2 v[224:225], v3, s[32:35], s61 offen sc1
  s_add_u32 s61, s61, 114688
  buffer_store_dwordx2 v[228:229], v3, s[32:35], s61 offen sc1
  s_add_u32 s61, s61, 114688
  buffer_store_dwordx2 v[232:233], v3, s[32:35], s61 offen sc1
  s_add_u32 s61, s61, 114688
  buffer_store_dwordx2 v[236:237], v3, s[32:35], s61 offen sc1
  s_add_u32 s61, s61, 114688
  buffer_store_dwordx2 v[240:241], v3, s[32:35], s61 offen sc1
  s_add_u32 s61, s61, 114688
  buffer_store_dwordx2 v[244:245], v3, s[32:35], s61 offen sc1
  s_add_u32 s61, s61, 114688
  buffer_store_dwordx2 v[248:249], v3, s[32:35], s61 offen sc1
  s_add_u32 s61, s61, 114688
  buffer_store_dwordx2 v[252:253], v3, s[32:35], s61 offen sc1
  s_add_u32 s61, s61, 114688
  s_waitcnt lgkmcnt(0)
  buffer_store_dwordx2 v[192:193], v3, s[32:35], s16 offen sc1
  s_add_u32 s16, s16, 114688
  buffer_store_dwordx2 v[196:197], v3, s[32:35], s16 offen sc1
  s_add_u32 s16, s16, 114688
  buffer_store_dwordx2 v[200:201], v3, s[32:35], s16 offen sc1
  s_add_u32 s16, s16, 114688
  buffer_store_dwordx2 v[204:205], v3, s[32:35], s16 offen sc1
  s_add_u32 s16, s16, 114688
  buffer_store_dwordx2 v[208:209], v3, s[32:35], s16 offen sc1
  s_add_u32 s16, s16, 114688
  buffer_store_dwordx2 v[212:213], v3, s[32:35], s16 offen sc1
  s_add_u32 s16, s16, 114688
  buffer_store_dwordx2 v[216:217], v3, s[32:35], s16 offen sc1
  s_add_u32 s16, s16, 114688
  buffer_store_dwordx2 v[220:221], v3, s[32:35], s16 offen sc1
  s_add_u32 s16, s16, 114688
HS7_D:
  s_load_dwordx2 s[8:9], s[0:1], 64
  s_load_dwordx2 s[4:5], s[0:1], 32
  s_and_b32 s21, s2, 1
  s_bfe_u32 s16, s2, 0x10001
  s_lshl_b32 s16, s16, 3
  s_bfe_u32 s17, s2, 0x30003
  s_add_u32 s22, s16, s17
  s_bfe_u32 s16, s2, 0x10002
  s_lshl_b32 s16, s16, 2
  s_bfe_u32 s17, s2, 0x20006
  s_add_u32 s23, s16, s17
  s_lshl_b32 s46, s20, 11
  v_lshrrev_b32 v2, 4, v1
  s_lshl_b32 s16, s20, 3
  v_add_u32 v4, s16, v2
  v_lshlrev_b32 v4, 11, v4
  v_bfe_u32 v5, v1, 1, 3
  v_xor_b32 v6, v2, v5
  v_xor_b32 v7, 4, v6
  v_and_b32 v2, 1, v1
  v_lshl_add_u32 v4, v2, 4, v4
  s_lshl_b32 s16, s23, 8
  v_add_u32 v4, s16, v4
  v_add_u32 v5, 7168, v4
  v_lshl_add_u32 v4, v6, 5, v4
  v_lshl_add_u32 v5, v7, 5, v5
  s_mul_i32 s48, s21, 3670016
  s_waitcnt lgkmcnt(0)
  s_mov_b32 s24, s8
  s_mov_b32 s25, s9
  s_mov_b32 s26, 0x700000
  s_mov_b32 s27, 0x20000
  s_add_u32 m0, s46, 0
  s_add_u32 s49, s48, 0
  buffer_load_dwordx4 v4, s[24:27], s49 offen lds
  s_add_u32 s48, s48, 65536
  buffer_load_dwordx4 v5, s[24:27], s49 offen offset:1024 lds
  s_add_u32 m0, s46, 8192
  s_add_u32 s49, s48, 0
  buffer_load_dwordx4 v4, s[24:27], s49 offen lds
  s_add_u32 s48, s48, 65536
  buffer_load_dwordx4 v5, s[24:27], s49 offen offset:1024 lds
  s_waitcnt vmcnt(4)
  v_mov_b32 v2, s55
  v_mov_b32 v8, 0
  s_mov_b64 exec, 1
  buffer_store_dword v2, v8, s[32:35], s60 offen sc1
  s_mov_b64 exec, -1
  s_add_u32 m0, s46, 16384
  s_add_u32 s49, s48, 0
  buffer_load_dwordx4 v4, s[24:27], s49 offen lds
  s_add_u32 s48, s48, 65536
  buffer_load_dwordx4 v5, s[24:27], s49 offen offset:1024 lds
  s_add_u32 m0, s46, 24576
  s_add_u32 s49, s48, 0
  buffer_load_dwordx4 v4, s[24:27], s49 offen lds
  s_add_u32 s48, s48, 65536
  buffer_load_dwordx4 v5, s[24:27], s49 offen offset:1024 lds
  s_add_u32 m0, s46, 32768
  s_add_u32 s49, s48, 0
  buffer_load_dwordx4 v4, s[24:27], s49 offen lds
  s_add_u32 s48, s48, 65536
  buffer_load_dwordx4 v5, s[24:27], s49 offen offset:1024 lds
  s_add_u32 m0, s46, 40960
  s_add_u32 s49, s48, 0
  buffer_load_dwordx4 v4, s[24:27], s49 offen lds
  s_add_u32 s48, s48, 65536
  buffer_load_dwordx4 v5, s[24:27], s49 offen offset:1024 lds
  s_lshl_b32 s16, s22, 3
  s_lshl_b32 s17, s20, 1
  s_add_u32 s16, s16, s17
  s_mul_i32 s16, s16, 112
  s_mul_i32 s17, s21, 56
  s_add_u32 s16, s16, s17
  s_lshl_b32 s44, s16, 10
  s_add_u32 s44, s44, 16777216
  v_add_u32 v10, 114688, v3
  v_lshrrev_b32 v2, 4, v1
  v_lshlrev_b32 v12, 10, v2
  v_bfe_u32 v9, v1, 2, 2
  v_lshl_add_u32 v12, v9, 8, v12
  v_bfe_u32 v8, v1, 2, 3
  v_lshl_add_u32 v12, v8, 5, v12
  v_and_b32 v9, 3, v1
  v_lshl_add_u32 v12, v9, 3, v12
  v_xor_b32 v13, 32, v12
  v_xor_b32 v14, 64, v12
  v_xor_b32 v15, 96, v12
  v_xor_b32 v16, 128, v12
  v_xor_b32 v17, 160, v12
  v_xor_b32 v18, 192, v12
  v_xor_b32 v19, 224, v12
  s_lshl_b32 s16, s20, 8
  s_add_u32 s16, s16, 148480
  v_lshl_add_u32 v20, v1, 2, s16
  v_and_b32 v2, 3, v1
  v_lshlrev_b32 v21, 8, v2
  v_lshl_add_u32 v21, v1, 2, v21
  v_add_u32 v21, 148480, v21
  v_mov_b32 v22, 1
  s_mov_b32 s53, 0
  s_lshl_b32 s40, s21, 20
  s_add_u32 s40, s40, 524288
  s_and_b32 s16, s20, 1
  s_lshl_b32 s16, s16, 15
  s_add_u32 s40, s40, s16
  s_lshr_b32 s16, s20, 1
  s_lshl_b32 s16, s16, 14
  s_add_u32 s40, s40, s16
  s_lshl_b32 s16, s20, 14
  s_sub_u32 s40, s40, s16
  s_lshl_b32 s16, s22, 2
  s_add_u32 s16, s16, s20
  s_lshl_b32 s41, s16, 16
  s_lshl_b32 s16, s21, 14
  s_add_u32 s41, s41, s16
  s_add_u32 s41, s41, 9445376
  v_add_u32 v27, 0x8000, v3
  v_add_u32 v2, 8, v1
  v_and_b32 v8, 3, v2
  v_lshlrev_b32 v28, 8, v8
  v_bfe_u32 v8, v2, 2, 2
  v_lshl_add_u32 v28, v8, 5, v28
  s_lshr_b32 s16, s22, 1
  s_lshl_b32 s43, s16, 10
  s_and_b32 s16, s22, 1
  s_lshl_b32 s16, s16, 1
  s_lshr_b32 s17, s20, 1
  s_add_u32 s16, s16, s17
  s_lshl_b32 s16, s16, 2
  s_add_u32 s43, s43, s16
  s_lshl_b32 s16, s21, 7
  s_add_u32 s43, s43, s16
  s_add_u32 s43, s43, 4739072
  v_lshrrev_b32 v2, 4, v1
  v_bfe_u32 v8, v1, 2, 2
  v_lshl_add_u32 v9, v8, 3, v2
  v_lshlrev_b32 v9, 5, v9
  v_and_b32 v2, 3, v1
  v_lshl_add_u32 v9, v2, 2, v9
  s_lshr_b32 s18, s22, 1
  s_lshl_b32 s18, s18, 5
  s_lshl_b32 s16, s21, 2
  s_add_u32 s18, s18, s16
  s_lshl_b32 s18, s18, 5
  s_add_u32 s18, s18, 4730896
  s_mov_b32 exec_lo, 0xff
  s_mov_b32 exec_hi, 0x0
  s_mov_b32 s17, 0x40000
POLL8:
  buffer_load_dword v2, v9, s[32:35], s18 offen sc1
  s_waitcnt vmcnt(0)
  v_cmp_ne_u32 vcc, s55, v2
  s_nop 0
  s_cbranch_vccz POLL8_D
  s_sleep 2
  s_sub_u32 s17, s17, 1
  s_cmp_lg_u32 s17, 0
  s_cbranch_scc1 POLL8
POLL8_D:
  s_mov_b64 exec, -1
  buffer_load_dwordx4 v[192:195], v3, s[32:35], s44 offen
  buffer_load_dwordx4 v[196:199], v10, s[32:35], s44 offen
  s_add_u32 s44, s44, 1024
  buffer_load_dwordx4 v[200:203], v3, s[32:35], s44 offen
  buffer_load_dwordx4 v[204:207], v10, s[32:35], s44 offen
  s_add_u32 s44, s44, 1024
  buffer_load_dwordx4 v[208:211], v3, s[32:35], s44 offen
  buffer_load_dwordx4 v[212:215], v10, s[32:35], s44 offen
  s_add_u32 s44, s44, 1024
  buffer_load_dwordx4 v[216:219], v3, s[32:35], s44 offen
  buffer_load_dwordx4 v[220:223], v10, s[32:35], s44 offen
  s_add_u32 s44, s44, 1024
  buffer_load_dwordx4 v[224:227], v3, s[32:35], s44 offen
  buffer_load_dwordx4 v[228:231], v10, s[32:35], s44 offen
  s_add_u32 s44, s44, 1024
  buffer_load_dwordx4 v[232:235], v3, s[32:35], s44 offen
  buffer_load_dwordx4 v[236:239], v10, s[32:35], s44 offen
  s_add_u32 s44, s44, 1024
  buffer_load_dwordx4 v[240:243], v3, s[32:35], s44 offen
  buffer_load_dwordx4 v[244:247], v10, s[32:35], s44 offen
  s_add_u32 s44, s44, 1024
  buffer_load_dword v24, v9, s[32:35], s18 offen sc1
  s_mov_b32 s45, 44
  ds_add_u32 v20, v22
  s_add_u32 s53, s53, 1
SY9:
  ds_read_b32 v23, v21
  s_waitcnt lgkmcnt(0)
  v_cmp_gt_u32 vcc, s53, v23
  s_nop 0
  s_cbranch_vccnz SY9
  ds_read_b64_tr_b16 v[32:33], v12 offset:0
  ds_read_b64_tr_b16 v[34:35], v12 offset:4096
  ds_read_b64_tr_b16 v[36:37], v13 offset:0
  ds_read_b64_tr_b16 v[38:39], v13 offset:4096
  ds_read_b64_tr_b16 v[40:41], v14 offset:0
  ds_read_b64_tr_b16 v[42:43], v14 offset:4096
  ds_read_b64_tr_b16 v[44:45], v15 offset:0
  ds_read_b64_tr_b16 v[46:47], v15 offset:4096
  ds_read_b64_tr_b16 v[48:49], v16 offset:0
  ds_read_b64_tr_b16 v[50:51], v16 offset:4096
  ds_read_b64_tr_b16 v[52:53], v17 offset:0
  ds_read_b64_tr_b16 v[54:55], v17 offset:4096
  ds_read_b64_tr_b16 v[56:57], v18 offset:0
  ds_read_b64_tr_b16 v[58:59], v18 offset:4096
  ds_read_b64_tr_b16 v[60:61], v19 offset:0
  ds_read_b64_tr_b16 v[62:63], v19 offset:4096
  ds_read_b32 v23, v21
  s_mov_b32 s53, 0
  s_setprio 1
  s_setprio 3
  s_waitcnt vmcnt(0) lgkmcnt(0)
  v_cmp_gt_i32 vcc, s53, v23
  s_setprio 1
  ds_add_u32 v20, v22
  s_add_u32 s53, s53, 1
  v_mfma_f32_16x16x32_bf16 v[128:131], v[32:35], v[192:195], 0
  v_mfma_f32_16x16x32_bf16 v[160:163], v[32:35], v[196:199], 0
  s_nop 0
  s_cbranch_vccnz DN_SP0
DN_CT0:
  s_lshr_b64 s[28:29], -1, s45
  s_setprio 3
  v_cmp_ne_u32 vcc, s55, v24
  s_setprio 1
  s_sub_u32 s45, s45, 10
  s_max_i32 s45, s45, 0
  s_and_b64 vcc, vcc, s[28:29]
  s_cbranch_scc1 DN_FS0
DN_FC0:
  v_mfma_f32_16x16x32_bf16 v[132:135], v[36:39], v[192:195], 0
  ds_read_b64_tr_b16 v[64:65], v12 offset:8192
  ds_read_b64_tr_b16 v[66:67], v12 offset:12288
  v_mfma_f32_16x16x32_bf16 v[164:167], v[36:39], v[196:199], 0
  ds_read_b64_tr_b16 v[68:69], v13 offset:8192
  ds_read_b64_tr_b16 v[70:71], v13 offset:12288
  v_mfma_f32_16x16x32_bf16 v[136:139], v[40:43], v[192:195], 0
  ds_read_b64_tr_b16 v[72:73], v14 offset:8192
  ds_read_b64_tr_b16 v[74:75], v14 offset:12288
  v_mfma_f32_16x16x32_bf16 v[168:171], v[40:43], v[196:199], 0
  ds_read_b64_tr_b16 v[76:77], v15 offset:8192
  ds_read_b64_tr_b16 v[78:79], v15 offset:12288
  s_add_u32 m0, s46, 49152
  s_add_u32 s49, s48, 0
  buffer_load_dwordx4 v4, s[24:27], s49 offen lds
  v_mfma_f32_16x16x32_bf16 v[140:143], v[44:47], v[192:195], 0
  ds_read_b64_tr_b16 v[80:81], v16 offset:8192
  ds_read_b64_tr_b16 v[82:83], v16 offset:12288
  v_mfma_f32_16x16x32_bf16 v[172:175], v[44:47], v[196:199], 0
  ds_read_b64_tr_b16 v[84:85], v17 offset:8192
  ds_read_b64_tr_b16 v[86:87], v17 offset:12288
  v_mfma_f32_16x16x32_bf16 v[144:147], v[48:51], v[192:195], 0
  ds_read_b64_tr_b16 v[88:89], v18 offset:8192
  ds_read_b64_tr_b16 v[90:91], v18 offset:12288
  s_add_u32 s48, s48, 65536
  buffer_load_dwordx4 v5, s[24:27], s49 offen offset:1024 lds
  v_mfma_f32_16x16x32_bf16 v[176:179], v[48:51], v[196:199], 0
  ds_read_b64_tr_b16 v[92:93], v19 offset:8192
  ds_read_b64_tr_b16 v[94:95], v19 offset:12288
  ds_read_b32 v23, v21
  v_mfma_f32_16x16x32_bf16 v[148:151], v[52:55], v[192:195], 0
  v_mfma_f32_16x16x32_bf16 v[180:183], v[52:55], v[196:199], 0
  v_mfma_f32_16x16x32_bf16 v[152:155], v[56:59], v[192:195], 0
  buffer_load_dwordx4 v[248:251], v3, s[32:35], s44 offen
  v_mfma_f32_16x16x32_bf16 v[184:187], v[56:59], v[196:199], 0
  v_mfma_f32_16x16x32_bf16 v[156:159], v[60:63], v[192:195], 0
  v_mfma_f32_16x16x32_bf16 v[188:191], v[60:63], v[196:199], 0
  buffer_load_dwordx4 v[252:255], v10, s[32:35], s44 offen
  s_add_u32 s44, s44, 1024
  s_setprio 3
  s_waitcnt vmcnt(4) lgkmcnt(0)
  v_cmp_gt_i32 vcc, s53, v23
  s_setprio 1
  ds_add_u32 v20, v22
  s_add_u32 s53, s53, 1
  v_mfma_f32_16x16x32_bf16 v[128:131], v[64:67], v[200:203], v[128:131]
  v_mfma_f32_16x16x32_bf16 v[160:163], v[64:67], v[204:207], v[160:163]
  s_nop 0
  s_cbranch_vccnz DN_SP1
DN_CT1:
  v_mfma_f32_16x16x32_bf16 v[132:135], v[68:71], v[200:203], v[132:135]
  ds_read_b64_tr_b16 v[32:33], v12 offset:16384
  ds_read_b64_tr_b16 v[34:35], v12 offset:20480
  v_mfma_f32_16x16x32_bf16 v[164:167], v[68:71], v[204:207], v[164:167]
  ds_read_b64_tr_b16 v[36:37], v13 offset:16384
  ds_read_b64_tr_b16 v[38:39], v13 offset:20480
  v_mfma_f32_16x16x32_bf16 v[136:139], v[72:75], v[200:203], v[136:139]
  ds_read_b64_tr_b16 v[40:41], v14 offset:16384
  ds_read_b64_tr_b16 v[42:43], v14 offset:20480
  v_mfma_f32_16x16x32_bf16 v[168:171], v[72:75], v[204:207], v[168:171]
  ds_read_b64_tr_b16 v[44:45], v15 offset:16384
  ds_read_b64_tr_b16 v[46:47], v15 offset:20480
  s_add_u32 m0, s46, 57344
  s_add_u32 s49, s48, 0
  buffer_load_dwordx4 v4, s[24:27], s49 offen lds
  v_mfma_f32_16x16x32_bf16 v[140:143], v[76:79], v[200:203], v[140:143]
  ds_read_b64_tr_b16 v[48:49], v16 offset:16384
  ds_read_b64_tr_b16 v[50:51], v16 offset:20480
  v_mfma_f32_16x16x32_bf16 v[172:175], v[76:79], v[204:207], v[172:175]
  ds_read_b64_tr_b16 v[52:53], v17 offset:16384
  ds_read_b64_tr_b16 v[54:55], v17 offset:20480
  v_mfma_f32_16x16x32_bf16 v[144:147], v[80:83], v[200:203], v[144:147]
  ds_read_b64_tr_b16 v[56:57], v18 offset:16384
  ds_read_b64_tr_b16 v[58:59], v18 offset:20480
  s_add_u32 s48, s48, 65536
  buffer_load_dwordx4 v5, s[24:27], s49 offen offset:1024 lds
  v_mfma_f32_16x16x32_bf16 v[176:179], v[80:83], v[204:207], v[176:179]
  ds_read_b64_tr_b16 v[60:61], v19 offset:16384
  ds_read_b64_tr_b16 v[62:63], v19 offset:20480
  ds_read_b32 v23, v21
  v_mfma_f32_16x16x32_bf16 v[148:151], v[84:87], v[200:203], v[148:151]
  v_mfma_f32_16x16x32_bf16 v[180:183], v[84:87], v[204:207], v[180:183]
  v_mfma_f32_16x16x32_bf16 v[152:155], v[88:91], v[200:203], v[152:155]
  buffer_load_dwordx4 v[192:195], v3, s[32:35], s44 offen
  v_mfma_f32_16x16x32_bf16 v[184:187], v[88:91], v[204:207], v[184:187]
  v_mfma_f32_16x16x32_bf16 v[156:159], v[92:95], v[200:203], v[156:159]
  v_mfma_f32_16x16x32_bf16 v[188:191], v[92:95], v[204:207], v[188:191]
  buffer_load_dwordx4 v[196:199], v10, s[32:35], s44 offen
  s_add_u32 s44, s44, 1024
  s_setprio 3
  s_waitcnt vmcnt(8) lgkmcnt(0)
  v_cmp_gt_i32 vcc, s53, v23
  s_setprio 1
  ds_add_u32 v20, v22
  s_add_u32 s53, s53, 1
  v_mfma_f32_16x16x32_bf16 v[128:131], v[32:35], v[208:211], v[128:131]
  v_mfma_f32_16x16x32_bf16 v[160:163], v[32:35], v[212:215], v[160:163]
  s_nop 0
  s_cbranch_vccnz DN_SP2
DN_CT2:
  v_mfma_f32_16x16x32_bf16 v[132:135], v[36:39], v[208:211], v[132:135]
  ds_read_b64_tr_b16 v[64:65], v12 offset:24576
  ds_read_b64_tr_b16 v[66:67], v12 offset:28672
  v_mfma_f32_16x16x32_bf16 v[164:167], v[36:39], v[212:215], v[164:167]
  ds_read_b64_tr_b16 v[68:69], v13 offset:24576
  ds_read_b64_tr_b16 v[70:71], v13 offset:28672
  v_mfma_f32_16x16x32_bf16 v[136:139], v[40:43], v[208:211], v[136:139]
  ds_read_b64_tr_b16 v[72:73], v14 offset:24576
  ds_read_b64_tr_b16 v[74:75], v14 offset:28672
  v_mfma_f32_16x16x32_bf16 v[168:171], v[40:43], v[212:215], v[168:171]
  ds_read_b64_tr_b16 v[76:77], v15 offset:24576
  ds_read_b64_tr_b16 v[78:79], v15 offset:28672
  s_add_u32 m0, s46, 0
  s_add_u32 s49, s48, 0
  buffer_load_dwordx4 v4, s[24:27], s49 offen lds
  v_mfma_f32_16x16x32_bf16 v[140:143], v[44:47], v[208:211], v[140:143]
  ds_read_b64_tr_b16 v[80:81], v16 offset:24576
  ds_read_b64_tr_b16 v[82:83], v16 offset:28672
  v_mfma_f32_16x16x32_bf16 v[172:175], v[44:47], v[212:215], v[172:175]
  ds_read_b64_tr_b16 v[84:85], v17 offset:24576
  ds_read_b64_tr_b16 v[86:87], v17 offset:28672
  v_mfma_f32_16x16x32_bf16 v[144:147], v[48:51], v[208:211], v[144:147]
  ds_read_b64_tr_b16 v[88:89], v18 offset:24576
  ds_read_b64_tr_b16 v[90:91], v18 offset:28672
  s_add_u32 s48, s48, 65536
  buffer_load_dwordx4 v5, s[24:27], s49 offen offset:1024 lds
  v_mfma_f32_16x16x32_bf16 v[176:179], v[48:51], v[212:215], v[176:179]
  ds_read_b64_tr_b16 v[92:93], v19 offset:24576
  ds_read_b64_tr_b16 v[94:95], v19 offset:28672
  ds_read_b32 v23, v21
  v_mfma_f32_16x16x32_bf16 v[148:151], v[52:55], v[208:211], v[148:151]
  v_mfma_f32_16x16x32_bf16 v[180:183], v[52:55], v[212:215], v[180:183]
  v_mfma_f32_16x16x32_bf16 v[152:155], v[56:59], v[208:211], v[152:155]
  buffer_load_dwordx4 v[200:203], v3, s[32:35], s44 offen
  v_mfma_f32_16x16x32_bf16 v[184:187], v[56:59], v[212:215], v[184:187]
  v_mfma_f32_16x16x32_bf16 v[156:159], v[60:63], v[208:211], v[156:159]
  v_mfma_f32_16x16x32_bf16 v[188:191], v[60:63], v[212:215], v[188:191]
  buffer_load_dwordx4 v[204:207], v10, s[32:35], s44 offen
  s_add_u32 s44, s44, 1024
  s_mov_b32 s51, 5
DN_LOOP:
  s_setprio 3
  s_waitcnt vmcnt(10) lgkmcnt(0)
  v_cmp_gt_i32 vcc, s53, v23
  s_setprio 1
  ds_add_u32 v20, v22
  s_add_u32 s53, s53, 1
  v_mfma_f32_16x16x32_bf16 v[128:131], v[64:67], v[216:219], v[128:131]
  v_mfma_f32_16x16x32_bf16 v[160:163], v[64:67], v[220:223], v[160:163]
  s_nop 0
  s_cbranch_vccnz DN_SP3
DN_CT3:
  v_mfma_f32_16x16x32_bf16 v[132:135], v[68:71], v[216:219], v[132:135]
  ds_read_b64_tr_b16 v[32:33], v12 offset:32768
  ds_read_b64_tr_b16 v[34:35], v12 offset:36864
  v_mfma_f32_16x16x32_bf16 v[164:167], v[68:71], v[220:223], v[164:167]
  ds_read_b64_tr_b16 v[36:37], v13 offset:32768
  ds_read_b64_tr_b16 v[38:39], v13 offset:36864
  v_mfma_f32_16x16x32_bf16 v[136:139], v[72:75], v[216:219], v[136:139]
  ds_read_b64_tr_b16 v[40:41], v14 offset:32768
  ds_read_b64_tr_b16 v[42:43], v14 offset:36864
  v_mfma_f32_16x16x32_bf16 v[168:171], v[72:75], v[220:223], v[168:171]
  ds_read_b64_tr_b16 v[44:45], v15 offset:32768
  ds_read_b64_tr_b16 v[46:47], v15 offset:36864
  s_add_u32 m0, s46, 8192
  s_add_u32 s49, s48, 0
  buffer_load_dwordx4 v4, s[24:27], s49 offen lds
  v_mfma_f32_16x16x32_bf16 v[140:143], v[76:79], v[216:219], v[140:143]
  ds_read_b64_tr_b16 v[48:49], v16 offset:32768
  ds_read_b64_tr_b16 v[50:51], v16 offset:36864
  v_mfma_f32_16x16x32_bf16 v[172:175], v[76:79], v[220:223], v[172:175]
  ds_read_b64_tr_b16 v[52:53], v17 offset:32768
  ds_read_b64_tr_b16 v[54:55], v17 offset:36864
  v_mfma_f32_16x16x32_bf16 v[144:147], v[80:83], v[216:219], v[144:147]
  ds_read_b64_tr_b16 v[56:57], v18 offset:32768
  ds_read_b64_tr_b16 v[58:59], v18 offset:36864
  s_add_u32 s48, s48, 65536
  buffer_load_dwordx4 v5, s[24:27], s49 offen offset:1024 lds
  v_mfma_f32_16x16x32_bf16 v[176:179], v[80:83], v[220:223], v[176:179]
  ds_read_b64_tr_b16 v[60:61], v19 offset:32768
  ds_read_b64_tr_b16 v[62:63], v19 offset:36864
  ds_read_b32 v23, v21
  v_mfma_f32_16x16x32_bf16 v[148:151], v[84:87], v[216:219], v[148:151]
  v_mfma_f32_16x16x32_bf16 v[180:183], v[84:87], v[220:223], v[180:183]
  v_mfma_f32_16x16x32_bf16 v[152:155], v[88:91], v[216:219], v[152:155]
  buffer_load_dwordx4 v[208:211], v3, s[32:35], s44 offen
  v_mfma_f32_16x16x32_bf16 v[184:187], v[88:91], v[220:223], v[184:187]
  v_mfma_f32_16x16x32_bf16 v[156:159], v[92:95], v[216:219], v[156:159]
  v_mfma_f32_16x16x32_bf16 v[188:191], v[92:95], v[220:223], v[188:191]
  buffer_load_dwordx4 v[212:215], v10, s[32:35], s44 offen
  s_add_u32 s44, s44, 1024
  s_setprio 3
  s_waitcnt vmcnt(10) lgkmcnt(0)
  v_cmp_gt_i32 vcc, s53, v23
  s_setprio 1
  ds_add_u32 v20, v22
  s_add_u32 s53, s53, 1
  v_mfma_f32_16x16x32_bf16 v[128:131], v[32:35], v[224:227], v[128:131]
  v_mfma_f32_16x16x32_bf16 v[160:163], v[32:35], v[228:231], v[160:163]
  s_nop 0
  s_cbranch_vccnz DN_SP4
DN_CT4:
  v_mfma_f32_16x16x32_bf16 v[132:135], v[36:39], v[224:227], v[132:135]
  ds_read_b64_tr_b16 v[64:65], v12 offset:40960
  ds_read_b64_tr_b16 v[66:67], v12 offset:45056
  v_mfma_f32_16x16x32_bf16 v[164:167], v[36:39], v[228:231], v[164:167]
  ds_read_b64_tr_b16 v[68:69], v13 offset:40960
  ds_read_b64_tr_b16 v[70:71], v13 offset:45056
  v_mfma_f32_16x16x32_bf16 v[136:139], v[40:43], v[224:227], v[136:139]
  ds_read_b64_tr_b16 v[72:73], v14 offset:40960
  ds_read_b64_tr_b16 v[74:75], v14 offset:45056
  s_add_u32 m0, s46, 16384
  s_add_u32 s49, s48, 0
  buffer_load_dwordx4 v4, s[24:27], s49 offen lds
  v_mfma_f32_16x16x32_bf16 v[168:171], v[40:43], v[228:231], v[168:171]
  ds_read_b64_tr_b16 v[76:77], v15 offset:40960
  ds_read_b64_tr_b16 v[78:79], v15 offset:45056
  v_mfma_f32_16x16x32_bf16 v[140:143], v[44:47], v[224:227], v[140:143]
  ds_read_b64_tr_b16 v[80:81], v16 offset:40960
  ds_read_b64_tr_b16 v[82:83], v16 offset:45056
  v_mfma_f32_16x16x32_bf16 v[172:175], v[44:47], v[228:231], v[172:175]
  ds_read_b64_tr_b16 v[84:85], v17 offset:40960
  ds_read_b64_tr_b16 v[86:87], v17 offset:45056
  s_add_u32 s48, s48, 65536
  buffer_load_dwordx4 v5, s[24:27], s49 offen offset:1024 lds
  v_mfma_f32_16x16x32_bf16 v[144:147], v[48:51], v[224:227], v[144:147]
  ds_read_b64_tr_b16 v[88:89], v18 offset:40960
  ds_read_b64_tr_b16 v[90:91], v18 offset:45056
  v_mfma_f32_16x16x32_bf16 v[176:179], v[48:51], v[228:231], v[176:179]
  ds_read_b64_tr_b16 v[92:93], v19 offset:40960
  ds_read_b64_tr_b16 v[94:95], v19 offset:45056
  ds_read_b32 v23, v21
  v_mfma_f32_16x16x32_bf16 v[148:151], v[52:55], v[224:227], v[148:151]
  buffer_load_dwordx4 v[216:219], v3, s[32:35], s44 offen
  v_mfma_f32_16x16x32_bf16 v[180:183], v[52:55], v[228:231], v[180:183]
  v_mfma_f32_16x16x32_bf16 v[152:155], v[56:59], v[224:227], v[152:155]
  v_mfma_f32_16x16x32_bf16 v[184:187], v[56:59], v[228:231], v[184:187]
  buffer_load_dwordx4 v[220:223], v10, s[32:35], s44 offen
  v_mfma_f32_16x16x32_bf16 v[156:159], v[60:63], v[224:227], v[156:159]
  v_mfma_f32_16x16x32_bf16 v[188:191], v[60:63], v[228:231], v[188:191]
  s_add_u32 s44, s44, 1024
  buffer_load_dword v24, v9, s[32:35], s18 offen sc1
  s_setprio 3
  s_waitcnt vmcnt(11) lgkmcnt(0)
  v_cmp_gt_i32 vcc, s53, v23
  s_setprio 1
  ds_add_u32 v20, v22
  s_add_u32 s53, s53, 1
  v_mfma_f32_16x16x32_bf16 v[128:131], v[64:67], v[232:235], v[128:131]
  v_mfma_f32_16x16x32_bf16 v[160:163], v[64:67], v[236:239], v[160:163]
  s_nop 0
  s_cbranch_vccnz DN_SP5
DN_CT5:
  v_mfma_f32_16x16x32_bf16 v[132:135], v[68:71], v[232:235], v[132:135]
  ds_read_b64_tr_b16 v[32:33], v12 offset:49152
  ds_read_b64_tr_b16 v[34:35], v12 offset:53248
  v_mfma_f32_16x16x32_bf16 v[164:167], v[68:71], v[236:239], v[164:167]
  ds_read_b64_tr_b16 v[36:37], v13 offset:49152
  ds_read_b64_tr_b16 v[38:39], v13 offset:53248
  v_mfma_f32_16x16x32_bf16 v[136:139], v[72:75], v[232:235], v[136:139]
  ds_read_b64_tr_b16 v[40:41], v14 offset:49152
  ds_read_b64_tr_b16 v[42:43], v14 offset:53248
  v_mfma_f32_16x16x32_bf16 v[168:171], v[72:75], v[236:239], v[168:171]
  ds_read_b64_tr_b16 v[44:45], v15 offset:49152
  ds_read_b64_tr_b16 v[46:47], v15 offset:53248
  s_add_u32 m0, s46, 24576
  s_add_u32 s49, s48, 0
  buffer_load_dwordx4 v4, s[24:27], s49 offen lds
  v_mfma_f32_16x16x32_bf16 v[140:143], v[76:79], v[232:235], v[140:143]
  ds_read_b64_tr_b16 v[48:49], v16 offset:49152
  ds_read_b64_tr_b16 v[50:51], v16 offset:53248
  v_mfma_f32_16x16x32_bf16 v[172:175], v[76:79], v[236:239], v[172:175]
  ds_read_b64_tr_b16 v[52:53], v17 offset:49152
  ds_read_b64_tr_b16 v[54:55], v17 offset:53248
  v_mfma_f32_16x16x32_bf16 v[144:147], v[80:83], v[232:235], v[144:147]
  ds_read_b64_tr_b16 v[56:57], v18 offset:49152
  ds_read_b64_tr_b16 v[58:59], v18 offset:53248
  s_add_u32 s48, s48, 65536
  buffer_load_dwordx4 v5, s[24:27], s49 offen offset:1024 lds
  v_mfma_f32_16x16x32_bf16 v[176:179], v[80:83], v[236:239], v[176:179]
  ds_read_b64_tr_b16 v[60:61], v19 offset:49152
  ds_read_b64_tr_b16 v[62:63], v19 offset:53248
  ds_read_b32 v23, v21
  v_mfma_f32_16x16x32_bf16 v[148:151], v[84:87], v[232:235], v[148:151]
  v_mfma_f32_16x16x32_bf16 v[180:183], v[84:87], v[236:239], v[180:183]
  v_mfma_f32_16x16x32_bf16 v[152:155], v[88:91], v[232:235], v[152:155]
  buffer_load_dwordx4 v[224:227], v3, s[32:35], s44 offen
  v_mfma_f32_16x16x32_bf16 v[184:187], v[88:91], v[236:239], v[184:187]
  v_mfma_f32_16x16x32_bf16 v[156:159], v[92:95], v[232:235], v[156:159]
  v_mfma_f32_16x16x32_bf16 v[188:191], v[92:95], v[236:239], v[188:191]
  buffer_load_dwordx4 v[228:231], v10, s[32:35], s44 offen
  s_add_u32 s44, s44, 1024
  s_setprio 3
  s_waitcnt vmcnt(11) lgkmcnt(0)
  v_cmp_gt_i32 vcc, s53, v23
  s_setprio 1
  ds_add_u32 v20, v22
  s_add_u32 s53, s53, 1
  v_mfma_f32_16x16x32_bf16 v[128:131], v[32:35], v[240:243], v[128:131]
  v_mfma_f32_16x16x32_bf16 v[160:163], v[32:35], v[244:247], v[160:163]
  s_nop 0
  s_cbranch_vccnz DN_SP6
DN_CT6:
  v_mfma_f32_16x16x32_bf16 v[132:135], v[36:39], v[240:243], v[132:135]
  ds_read_b64_tr_b16 v[64:65], v12 offset:57344
  ds_read_b64_tr_b16 v[66:67], v12 offset:61440
  v_mfma_f32_16x16x32_bf16 v[164:167], v[36:39], v[244:247], v[164:167]
  ds_read_b64_tr_b16 v[68:69], v13 offset:57344
  ds_read_b64_tr_b16 v[70:71], v13 offset:61440
  v_mfma_f32_16x16x32_bf16 v[136:139], v[40:43], v[240:243], v[136:139]
  ds_read_b64_tr_b16 v[72:73], v14 offset:57344
  ds_read_b64_tr_b16 v[74:75], v14 offset:61440
  v_mfma_f32_16x16x32_bf16 v[168:171], v[40:43], v[244:247], v[168:171]
  ds_read_b64_tr_b16 v[76:77], v15 offset:57344
  ds_read_b64_tr_b16 v[78:79], v15 offset:61440
  s_add_u32 m0, s46, 32768
  s_add_u32 s49, s48, 0
  buffer_load_dwordx4 v4, s[24:27], s49 offen lds
  v_mfma_f32_16x16x32_bf16 v[140:143], v[44:47], v[240:243], v[140:143]
  ds_read_b64_tr_b16 v[80:81], v16 offset:57344
  ds_read_b64_tr_b16 v[82:83], v16 offset:61440
  v_mfma_f32_16x16x32_bf16 v[172:175], v[44:47], v[244:247], v[172:175]
  ds_read_b64_tr_b16 v[84:85], v17 offset:57344
  ds_read_b64_tr_b16 v[86:87], v17 offset:61440
  v_mfma_f32_16x16x32_bf16 v[144:147], v[48:51], v[240:243], v[144:147]
  ds_read_b64_tr_b16 v[88:89], v18 offset:57344
  ds_read_b64_tr_b16 v[90:91], v18 offset:61440
  s_add_u32 s48, s48, 65536
  buffer_load_dwordx4 v5, s[24:27], s49 offen offset:1024 lds
  v_mfma_f32_16x16x32_bf16 v[176:179], v[48:51], v[244:247], v[176:179]
  ds_read_b64_tr_b16 v[92:93], v19 offset:57344
  ds_read_b64_tr_b16 v[94:95], v19 offset:61440
  ds_read_b32 v23, v21
  v_mfma_f32_16x16x32_bf16 v[148:151], v[52:55], v[240:243], v[148:151]
  v_mfma_f32_16x16x32_bf16 v[180:183], v[52:55], v[244:247], v[180:183]
  v_mfma_f32_16x16x32_bf16 v[152:155], v[56:59], v[240:243], v[152:155]
  buffer_load_dwordx4 v[232:235], v3, s[32:35], s44 offen
  v_mfma_f32_16x16x32_bf16 v[184:187], v[56:59], v[244:247], v[184:187]
  v_mfma_f32_16x16x32_bf16 v[156:159], v[60:63], v[240:243], v[156:159]
  v_mfma_f32_16x16x32_bf16 v[188:191], v[60:63], v[244:247], v[188:191]
  buffer_load_dwordx4 v[236:239], v10, s[32:35], s44 offen
  s_add_u32 s44, s44, 1024
  s_setprio 3
  s_waitcnt vmcnt(11) lgkmcnt(0)
  v_cmp_gt_i32 vcc, s53, v23
  s_setprio 1
  ds_add_u32 v20, v22
  s_add_u32 s53, s53, 1
  v_mfma_f32_16x16x32_bf16 v[128:131], v[64:67], v[248:251], v[128:131]
  v_mfma_f32_16x16x32_bf16 v[160:163], v[64:67], v[252:255], v[160:163]
  s_nop 0
  s_cbranch_vccnz DN_SP7
DN_CT7:
  v_mfma_f32_16x16x32_bf16 v[132:135], v[68:71], v[248:251], v[132:135]
  ds_read_b64_tr_b16 v[32:33], v12 offset:0
  ds_read_b64_tr_b16 v[34:35], v12 offset:4096
  v_mfma_f32_16x16x32_bf16 v[164:167], v[68:71], v[252:255], v[164:167]
  ds_read_b64_tr_b16 v[36:37], v13 offset:0
  ds_read_b64_tr_b16 v[38:39], v13 offset:4096
  v_mfma_f32_16x16x32_bf16 v[136:139], v[72:75], v[248:251], v[136:139]
  ds_read_b64_tr_b16 v[40:41], v14 offset:0
  ds_read_b64_tr_b16 v[42:43], v14 offset:4096
  v_mfma_f32_16x16x32_bf16 v[168:171], v[72:75], v[252:255], v[168:171]
  ds_read_b64_tr_b16 v[44:45], v15 offset:0
  ds_read_b64_tr_b16 v[46:47], v15 offset:4096
  s_add_u32 m0, s46, 40960
  s_add_u32 s49, s48, 0
  buffer_load_dwordx4 v4, s[24:27], s49 offen lds
  v_mfma_f32_16x16x32_bf16 v[140:143], v[76:79], v[248:251], v[140:143]
  ds_read_b64_tr_b16 v[48:49], v16 offset:0
  ds_read_b64_tr_b16 v[50:51], v16 offset:4096
  v_mfma_f32_16x16x32_bf16 v[172:175], v[76:79], v[252:255], v[172:175]
  ds_read_b64_tr_b16 v[52:53], v17 offset:0
  ds_read_b64_tr_b16 v[54:55], v17 offset:4096
  v_mfma_f32_16x16x32_bf16 v[144:147], v[80:83], v[248:251], v[144:147]
  ds_read_b64_tr_b16 v[56:57], v18 offset:0
  ds_read_b64_tr_b16 v[58:59], v18 offset:4096
  s_add_u32 s48, s48, 65536
  buffer_load_dwordx4 v5, s[24:27], s49 offen offset:1024 lds
  v_mfma_f32_16x16x32_bf16 v[176:179], v[80:83], v[252:255], v[176:179]
  ds_read_b64_tr_b16 v[60:61], v19 offset:0
  ds_read_b64_tr_b16 v[62:63], v19 offset:4096
  ds_read_b32 v23, v21
  v_mfma_f32_16x16x32_bf16 v[148:151], v[84:87], v[248:251], v[148:151]
  v_mfma_f32_16x16x32_bf16 v[180:183], v[84:87], v[252:255], v[180:183]
  v_mfma_f32_16x16x32_bf16 v[152:155], v[88:91], v[248:251], v[152:155]
  buffer_load_dwordx4 v[240:243], v3, s[32:35], s44 offen
  v_mfma_f32_16x16x32_bf16 v[184:187], v[88:91], v[252:255], v[184:187]
  v_mfma_f32_16x16x32_bf16 v[156:159], v[92:95], v[248:251], v[156:159]
  v_mfma_f32_16x16x32_bf16 v[188:191], v[92:95], v[252:255], v[188:191]
  buffer_load_dwordx4 v[244:247], v10, s[32:35], s44 offen
  s_add_u32 s44, s44, 1024
  s_setprio 3
  s_waitcnt vmcnt(10) lgkmcnt(0)
  v_cmp_gt_i32 vcc, s53, v23
  s_setprio 1
  ds_add_u32 v20, v22
  s_add_u32 s53, s53, 1
  v_mfma_f32_16x16x32_bf16 v[128:131], v[32:35], v[192:195], v[128:131]
  v_mfma_f32_16x16x32_bf16 v[160:163], v[32:35], v[196:199], v[160:163]
  s_nop 0
  s_cbranch_vccnz DN_SP8
DN_CT8:
  s_lshr_b64 s[28:29], -1, s45
  s_setprio 3
  v_cmp_ne_u32 vcc, s55, v24
  s_setprio 1
  s_sub_u32 s45, s45, 10
  s_max_i32 s45, s45, 0
  s_and_b64 vcc, vcc, s[28:29]
  s_cbranch_scc1 DN_FS8
DN_FC8:
  v_mfma_f32_16x16x32_bf16 v[132:135], v[36:39], v[192:195], v[132:135]
  ds_read_b64_tr_b16 v[64:65], v12 offset:8192
  ds_read_b64_tr_b16 v[66:67], v12 offset:12288
  v_mfma_f32_16x16x32_bf16 v[164:167], v[36:39], v[196:199], v[164:167]
  ds_read_b64_tr_b16 v[68:69], v13 offset:8192
  ds_read_b64_tr_b16 v[70:71], v13 offset:12288
  v_mfma_f32_16x16x32_bf16 v[136:139], v[40:43], v[192:195], v[136:139]
  ds_read_b64_tr_b16 v[72:73], v14 offset:8192
  ds_read_b64_tr_b16 v[74:75], v14 offset:12288
  v_mfma_f32_16x16x32_bf16 v[168:171], v[40:43], v[196:199], v[168:171]
  ds_read_b64_tr_b16 v[76:77], v15 offset:8192
  ds_read_b64_tr_b16 v[78:79], v15 offset:12288
  s_add_u32 m0, s46, 49152
  s_add_u32 s49, s48, 0
  buffer_load_dwordx4 v4, s[24:27], s49 offen lds
  v_mfma_f32_16x16x32_bf16 v[140:143], v[44:47], v[192:195], v[140:143]
  ds_read_b64_tr_b16 v[80:81], v16 offset:8192
  ds_read_b64_tr_b16 v[82:83], v16 offset:12288
  v_mfma_f32_16x16x32_bf16 v[172:175], v[44:47], v[196:199], v[172:175]
  ds_read_b64_tr_b16 v[84:85], v17 offset:8192
  ds_read_b64_tr_b16 v[86:87], v17 offset:12288
  v_mfma_f32_16x16x32_bf16 v[144:147], v[48:51], v[192:195], v[144:147]
  ds_read_b64_tr_b16 v[88:89], v18 offset:8192
  ds_read_b64_tr_b16 v[90:91], v18 offset:12288
  s_add_u32 s48, s48, 65536
  buffer_load_dwordx4 v5, s[24:27], s49 offen offset:1024 lds
  v_mfma_f32_16x16x32_bf16 v[176:179], v[48:51], v[196:199], v[176:179]
  ds_read_b64_tr_b16 v[92:93], v19 offset:8192
  ds_read_b64_tr_b16 v[94:95], v19 offset:12288
  ds_read_b32 v23, v21
  v_mfma_f32_16x16x32_bf16 v[148:151], v[52:55], v[192:195], v[148:151]
  v_mfma_f32_16x16x32_bf16 v[180:183], v[52:55], v[196:199], v[180:183]
  v_mfma_f32_16x16x32_bf16 v[152:155], v[56:59], v[192:195], v[152:155]
  buffer_load_dwordx4 v[248:251], v3, s[32:35], s44 offen
  v_mfma_f32_16x16x32_bf16 v[184:187], v[56:59], v[196:199], v[184:187]
  v_mfma_f32_16x16x32_bf16 v[156:159], v[60:63], v[192:195], v[156:159]
  v_mfma_f32_16x16x32_bf16 v[188:191], v[60:63], v[196:199], v[188:191]
  buffer_load_dwordx4 v[252:255], v10, s[32:35], s44 offen
  s_add_u32 s44, s44, 1024
  s_setprio 3
  s_waitcnt vmcnt(10) lgkmcnt(0)
  v_cmp_gt_i32 vcc, s53, v23
  s_setprio 1
  ds_add_u32 v20, v22
  s_add_u32 s53, s53, 1
  v_mfma_f32_16x16x32_bf16 v[128:131], v[64:67], v[200:203], v[128:131]
  v_mfma_f32_16x16x32_bf16 v[160:163], v[64:67], v[204:207], v[160:163]
  s_nop 0
  s_cbranch_vccnz DN_SP9
DN_CT9:
  v_mfma_f32_16x16x32_bf16 v[132:135], v[68:71], v[200:203], v[132:135]
  ds_read_b64_tr_b16 v[32:33], v12 offset:16384
  ds_read_b64_tr_b16 v[34:35], v12 offset:20480
  v_mfma_f32_16x16x32_bf16 v[164:167], v[68:71], v[204:207], v[164:167]
  ds_read_b64_tr_b16 v[36:37], v13 offset:16384
  ds_read_b64_tr_b16 v[38:39], v13 offset:20480
  v_mfma_f32_16x16x32_bf16 v[136:139], v[72:75], v[200:203], v[136:139]
  ds_read_b64_tr_b16 v[40:41], v14 offset:16384
  ds_read_b64_tr_b16 v[42:43], v14 offset:20480
  v_mfma_f32_16x16x32_bf16 v[168:171], v[72:75], v[204:207], v[168:171]
  ds_read_b64_tr_b16 v[44:45], v15 offset:16384
  ds_read_b64_tr_b16 v[46:47], v15 offset:20480
  s_add_u32 m0, s46, 57344
  s_add_u32 s49, s48, 0
  buffer_load_dwordx4 v4, s[24:27], s49 offen lds
  v_mfma_f32_16x16x32_bf16 v[140:143], v[76:79], v[200:203], v[140:143]
  ds_read_b64_tr_b16 v[48:49], v16 offset:16384
  ds_read_b64_tr_b16 v[50:51], v16 offset:20480
  v_mfma_f32_16x16x32_bf16 v[172:175], v[76:79], v[204:207], v[172:175]
  ds_read_b64_tr_b16 v[52:53], v17 offset:16384
  ds_read_b64_tr_b16 v[54:55], v17 offset:20480
  v_mfma_f32_16x16x32_bf16 v[144:147], v[80:83], v[200:203], v[144:147]
  ds_read_b64_tr_b16 v[56:57], v18 offset:16384
  ds_read_b64_tr_b16 v[58:59], v18 offset:20480
  s_add_u32 s48, s48, 65536
  buffer_load_dwordx4 v5, s[24:27], s49 offen offset:1024 lds
  v_mfma_f32_16x16x32_bf16 v[176:179], v[80:83], v[204:207], v[176:179]
  ds_read_b64_tr_b16 v[60:61], v19 offset:16384
  ds_read_b64_tr_b16 v[62:63], v19 offset:20480
  ds_read_b32 v23, v21
  v_mfma_f32_16x16x32_bf16 v[148:151], v[84:87], v[200:203], v[148:151]
  v_mfma_f32_16x16x32_bf16 v[180:183], v[84:87], v[204:207], v[180:183]
  v_mfma_f32_16x16x32_bf16 v[152:155], v[88:91], v[200:203], v[152:155]
  buffer_load_dwordx4 v[192:195], v3, s[32:35], s44 offen
  v_mfma_f32_16x16x32_bf16 v[184:187], v[88:91], v[204:207], v[184:187]
  v_mfma_f32_16x16x32_bf16 v[156:159], v[92:95], v[200:203], v[156:159]
  v_mfma_f32_16x16x32_bf16 v[188:191], v[92:95], v[204:207], v[188:191]
  buffer_load_dwordx4 v[196:199], v10, s[32:35], s44 offen
  s_add_u32 s44, s44, 1024
  s_setprio 3
  s_waitcnt vmcnt(10) lgkmcnt(0)
  v_cmp_gt_i32 vcc, s53, v23
  s_setprio 1
  ds_add_u32 v20, v22
  s_add_u32 s53, s53, 1
  v_mfma_f32_16x16x32_bf16 v[128:131], v[32:35], v[208:211], v[128:131]
  v_mfma_f32_16x16x32_bf16 v[160:163], v[32:35], v[212:215], v[160:163]
  s_nop 0
  s_cbranch_vccnz DN_SP10
DN_CT10:
  v_mfma_f32_16x16x32_bf16 v[132:135], v[36:39], v[208:211], v[132:135]
  ds_read_b64_tr_b16 v[64:65], v12 offset:24576
  ds_read_b64_tr_b16 v[66:67], v12 offset:28672
  v_mfma_f32_16x16x32_bf16 v[164:167], v[36:39], v[212:215], v[164:167]
  ds_read_b64_tr_b16 v[68:69], v13 offset:24576
  ds_read_b64_tr_b16 v[70:71], v13 offset:28672
  v_mfma_f32_16x16x32_bf16 v[136:139], v[40:43], v[208:211], v[136:139]
  ds_read_b64_tr_b16 v[72:73], v14 offset:24576
  ds_read_b64_tr_b16 v[74:75], v14 offset:28672
  v_mfma_f32_16x16x32_bf16 v[168:171], v[40:43], v[212:215], v[168:171]
  ds_read_b64_tr_b16 v[76:77], v15 offset:24576
  ds_read_b64_tr_b16 v[78:79], v15 offset:28672
  s_add_u32 m0, s46, 0
  s_add_u32 s49, s48, 0
  buffer_load_dwordx4 v4, s[24:27], s49 offen lds
  v_mfma_f32_16x16x32_bf16 v[140:143], v[44:47], v[208:211], v[140:143]
  ds_read_b64_tr_b16 v[80:81], v16 offset:24576
  ds_read_b64_tr_b16 v[82:83], v16 offset:28672
  v_mfma_f32_16x16x32_bf16 v[172:175], v[44:47], v[212:215], v[172:175]
  ds_read_b64_tr_b16 v[84:85], v17 offset:24576
  ds_read_b64_tr_b16 v[86:87], v17 offset:28672
  v_mfma_f32_16x16x32_bf16 v[144:147], v[48:51], v[208:211], v[144:147]
  ds_read_b64_tr_b16 v[88:89], v18 offset:24576
  ds_read_b64_tr_b16 v[90:91], v18 offset:28672
  s_add_u32 s48, s48, 65536
  buffer_load_dwordx4 v5, s[24:27], s49 offen offset:1024 lds
  v_mfma_f32_16x16x32_bf16 v[176:179], v[48:51], v[212:215], v[176:179]
  ds_read_b64_tr_b16 v[92:93], v19 offset:24576
  ds_read_b64_tr_b16 v[94:95], v19 offset:28672
  ds_read_b32 v23, v21
  v_mfma_f32_16x16x32_bf16 v[148:151], v[52:55], v[208:211], v[148:151]
  v_mfma_f32_16x16x32_bf16 v[180:183], v[52:55], v[212:215], v[180:183]
  v_mfma_f32_16x16x32_bf16 v[152:155], v[56:59], v[208:211], v[152:155]
  buffer_load_dwordx4 v[200:203], v3, s[32:35], s44 offen
  v_mfma_f32_16x16x32_bf16 v[184:187], v[56:59], v[212:215], v[184:187]
  v_mfma_f32_16x16x32_bf16 v[156:159], v[60:63], v[208:211], v[156:159]
  v_mfma_f32_16x16x32_bf16 v[188:191], v[60:63], v[212:215], v[188:191]
  buffer_load_dwordx4 v[204:207], v10, s[32:35], s44 offen
  s_add_u32 s44, s44, 1024
  s_sub_u32 s51, s51, 1
  s_cmp_lg_u32 s51, 0
  s_cbranch_scc1 DN_LOOP
  s_setprio 3
  s_waitcnt vmcnt(10) lgkmcnt(0)
  v_cmp_gt_i32 vcc, s53, v23
  s_setprio 1
  ds_add_u32 v20, v22
  s_add_u32 s53, s53, 1
  v_mfma_f32_16x16x32_bf16 v[128:131], v[64:67], v[216:219], v[128:131]
  v_mfma_f32_16x16x32_bf16 v[160:163], v[64:67], v[220:223], v[160:163]
  s_nop 0
  s_cbranch_vccnz DN_SP43
DN_CT43:
  v_mfma_f32_16x16x32_bf16 v[132:135], v[68:71], v[216:219], v[132:135]
  ds_read_b64_tr_b16 v[32:33], v12 offset:32768
  ds_read_b64_tr_b16 v[34:35], v12 offset:36864
  v_mfma_f32_16x16x32_bf16 v[164:167], v[68:71], v[220:223], v[164:167]
  ds_read_b64_tr_b16 v[36:37], v13 offset:32768
  ds_read_b64_tr_b16 v[38:39], v13 offset:36864
  v_mfma_f32_16x16x32_bf16 v[136:139], v[72:75], v[216:219], v[136:139]
  ds_read_b64_tr_b16 v[40:41], v14 offset:32768
  ds_read_b64_tr_b16 v[42:43], v14 offset:36864
  v_mfma_f32_16x16x32_bf16 v[168:171], v[72:75], v[220:223], v[168:171]
  ds_read_b64_tr_b16 v[44:45], v15 offset:32768
  ds_read_b64_tr_b16 v[46:47], v15 offset:36864
  s_add_u32 m0, s46, 8192
  s_add_u32 s49, s48, 0
  buffer_load_dwordx4 v4, s[24:27], s49 offen lds
  v_mfma_f32_16x16x32_bf16 v[140:143], v[76:79], v[216:219], v[140:143]
  ds_read_b64_tr_b16 v[48:49], v16 offset:32768
  ds_read_b64_tr_b16 v[50:51], v16 offset:36864
  v_mfma_f32_16x16x32_bf16 v[172:175], v[76:79], v[220:223], v[172:175]
  ds_read_b64_tr_b16 v[52:53], v17 offset:32768
  ds_read_b64_tr_b16 v[54:55], v17 offset:36864
  v_mfma_f32_16x16x32_bf16 v[144:147], v[80:83], v[216:219], v[144:147]
  ds_read_b64_tr_b16 v[56:57], v18 offset:32768
  ds_read_b64_tr_b16 v[58:59], v18 offset:36864
  s_add_u32 s48, s48, 65536
  buffer_load_dwordx4 v5, s[24:27], s49 offen offset:1024 lds
  v_mfma_f32_16x16x32_bf16 v[176:179], v[80:83], v[220:223], v[176:179]
  ds_read_b64_tr_b16 v[60:61], v19 offset:32768
  ds_read_b64_tr_b16 v[62:63], v19 offset:36864
  ds_read_b32 v23, v21
  v_mfma_f32_16x16x32_bf16 v[148:151], v[84:87], v[216:219], v[148:151]
  v_mfma_f32_16x16x32_bf16 v[180:183], v[84:87], v[220:223], v[180:183]
  v_mfma_f32_16x16x32_bf16 v[152:155], v[88:91], v[216:219], v[152:155]
  buffer_load_dwordx4 v[208:211], v3, s[32:35], s44 offen
  v_mfma_f32_16x16x32_bf16 v[184:187], v[88:91], v[220:223], v[184:187]
  v_mfma_f32_16x16x32_bf16 v[156:159], v[92:95], v[216:219], v[156:159]
  v_mfma_f32_16x16x32_bf16 v[188:191], v[92:95], v[220:223], v[188:191]
  buffer_load_dwordx4 v[212:215], v10, s[32:35], s44 offen
  s_add_u32 s44, s44, 1024
  s_setprio 3
  s_waitcnt vmcnt(10) lgkmcnt(0)
  v_cmp_gt_i32 vcc, s53, v23
  s_setprio 1
  ds_add_u32 v20, v22
  s_add_u32 s53, s53, 1
  v_mfma_f32_16x16x32_bf16 v[128:131], v[32:35], v[224:227], v[128:131]
  v_mfma_f32_16x16x32_bf16 v[160:163], v[32:35], v[228:231], v[160:163]
  s_nop 0
  s_cbranch_vccnz DN_SP44
DN_CT44:
  v_mfma_f32_16x16x32_bf16 v[132:135], v[36:39], v[224:227], v[132:135]
  ds_read_b64_tr_b16 v[64:65], v12 offset:40960
  ds_read_b64_tr_b16 v[66:67], v12 offset:45056
  v_mfma_f32_16x16x32_bf16 v[164:167], v[36:39], v[228:231], v[164:167]
  ds_read_b64_tr_b16 v[68:69], v13 offset:40960
  ds_read_b64_tr_b16 v[70:71], v13 offset:45056
  v_mfma_f32_16x16x32_bf16 v[136:139], v[40:43], v[224:227], v[136:139]
  ds_read_b64_tr_b16 v[72:73], v14 offset:40960
  ds_read_b64_tr_b16 v[74:75], v14 offset:45056
  s_add_u32 m0, s46, 16384
  s_add_u32 s49, s48, 0
  buffer_load_dwordx4 v4, s[24:27], s49 offen lds
  v_mfma_f32_16x16x32_bf16 v[168:171], v[40:43], v[228:231], v[168:171]
  ds_read_b64_tr_b16 v[76:77], v15 offset:40960
  ds_read_b64_tr_b16 v[78:79], v15 offset:45056
  v_mfma_f32_16x16x32_bf16 v[140:143], v[44:47], v[224:227], v[140:143]
  ds_read_b64_tr_b16 v[80:81], v16 offset:40960
  ds_read_b64_tr_b16 v[82:83], v16 offset:45056
  v_mfma_f32_16x16x32_bf16 v[172:175], v[44:47], v[228:231], v[172:175]
  ds_read_b64_tr_b16 v[84:85], v17 offset:40960
  ds_read_b64_tr_b16 v[86:87], v17 offset:45056
  s_add_u32 s48, s48, 65536
  buffer_load_dwordx4 v5, s[24:27], s49 offen offset:1024 lds
  v_mfma_f32_16x16x32_bf16 v[144:147], v[48:51], v[224:227], v[144:147]
  ds_read_b64_tr_b16 v[88:89], v18 offset:40960
  ds_read_b64_tr_b16 v[90:91], v18 offset:45056
  v_mfma_f32_16x16x32_bf16 v[176:179], v[48:51], v[228:231], v[176:179]
  ds_read_b64_tr_b16 v[92:93], v19 offset:40960
  ds_read_b64_tr_b16 v[94:95], v19 offset:45056
  ds_read_b32 v23, v21
  v_mfma_f32_16x16x32_bf16 v[148:151], v[52:55], v[224:227], v[148:151]
  buffer_load_dwordx4 v[216:219], v3, s[32:35], s44 offen
  v_mfma_f32_16x16x32_bf16 v[180:183], v[52:55], v[228:231], v[180:183]
  v_mfma_f32_16x16x32_bf16 v[152:155], v[56:59], v[224:227], v[152:155]
  v_mfma_f32_16x16x32_bf16 v[184:187], v[56:59], v[228:231], v[184:187]
  buffer_load_dwordx4 v[220:223], v10, s[32:35], s44 offen
  v_mfma_f32_16x16x32_bf16 v[156:159], v[60:63], v[224:227], v[156:159]
  v_mfma_f32_16x16x32_bf16 v[188:191], v[60:63], v[228:231], v[188:191]
  s_add_u32 s44, s44, 1024
  buffer_load_dword v24, v9, s[32:35], s18 offen sc1
  s_setprio 3
  s_waitcnt vmcnt(11) lgkmcnt(0)
  v_cmp_gt_i32 vcc, s53, v23
  s_setprio 1
  ds_add_u32 v20, v22
  s_add_u32 s53, s53, 1
  v_mfma_f32_16x16x32_bf16 v[128:131], v[64:67], v[232:235], v[128:131]
  v_mfma_f32_16x16x32_bf16 v[160:163], v[64:67], v[236:239], v[160:163]
  s_nop 0
  s_cbranch_vccnz DN_SP45
DN_CT45:
  v_mfma_f32_16x16x32_bf16 v[132:135], v[68:71], v[232:235], v[132:135]
  ds_read_b64_tr_b16 v[32:33], v12 offset:49152
  ds_read_b64_tr_b16 v[34:35], v12 offset:53248
  v_mfma_f32_16x16x32_bf16 v[164:167], v[68:71], v[236:239], v[164:167]
  ds_read_b64_tr_b16 v[36:37], v13 offset:49152
  ds_read_b64_tr_b16 v[38:39], v13 offset:53248
  v_mfma_f32_16x16x32_bf16 v[136:139], v[72:75], v[232:235], v[136:139]
  ds_read_b64_tr_b16 v[40:41], v14 offset:49152
  ds_read_b64_tr_b16 v[42:43], v14 offset:53248
  v_mfma_f32_16x16x32_bf16 v[168:171], v[72:75], v[236:239], v[168:171]
  ds_read_b64_tr_b16 v[44:45], v15 offset:49152
  ds_read_b64_tr_b16 v[46:47], v15 offset:53248
  s_add_u32 m0, s46, 24576
  s_add_u32 s49, s48, 0
  buffer_load_dwordx4 v4, s[24:27], s49 offen lds
  v_mfma_f32_16x16x32_bf16 v[140:143], v[76:79], v[232:235], v[140:143]
  ds_read_b64_tr_b16 v[48:49], v16 offset:49152
  ds_read_b64_tr_b16 v[50:51], v16 offset:53248
  v_mfma_f32_16x16x32_bf16 v[172:175], v[76:79], v[236:239], v[172:175]
  ds_read_b64_tr_b16 v[52:53], v17 offset:49152
  ds_read_b64_tr_b16 v[54:55], v17 offset:53248
  v_mfma_f32_16x16x32_bf16 v[144:147], v[80:83], v[232:235], v[144:147]
  ds_read_b64_tr_b16 v[56:57], v18 offset:49152
  ds_read_b64_tr_b16 v[58:59], v18 offset:53248
  s_add_u32 s48, s48, 65536
  buffer_load_dwordx4 v5, s[24:27], s49 offen offset:1024 lds
  v_mfma_f32_16x16x32_bf16 v[176:179], v[80:83], v[236:239], v[176:179]
  ds_read_b64_tr_b16 v[60:61], v19 offset:49152
  ds_read_b64_tr_b16 v[62:63], v19 offset:53248
  ds_read_b32 v23, v21
  v_mfma_f32_16x16x32_bf16 v[148:151], v[84:87], v[232:235], v[148:151]
  v_mfma_f32_16x16x32_bf16 v[180:183], v[84:87], v[236:239], v[180:183]
  v_mfma_f32_16x16x32_bf16 v[152:155], v[88:91], v[232:235], v[152:155]
  buffer_load_dwordx4 v[224:227], v3, s[32:35], s44 offen
  v_mfma_f32_16x16x32_bf16 v[184:187], v[88:91], v[236:239], v[184:187]
  v_mfma_f32_16x16x32_bf16 v[156:159], v[92:95], v[232:235], v[156:159]
  v_mfma_f32_16x16x32_bf16 v[188:191], v[92:95], v[236:239], v[188:191]
  buffer_load_dwordx4 v[228:231], v10, s[32:35], s44 offen
  s_add_u32 s44, s44, 1024
  s_setprio 3
  s_waitcnt vmcnt(11) lgkmcnt(0)
  v_cmp_gt_i32 vcc, s53, v23
  s_setprio 1
  ds_add_u32 v20, v22
  s_add_u32 s53, s53, 1
  v_mfma_f32_16x16x32_bf16 v[128:131], v[32:35], v[240:243], v[128:131]
  v_mfma_f32_16x16x32_bf16 v[160:163], v[32:35], v[244:247], v[160:163]
  s_nop 0
  s_cbranch_vccnz DN_SP46
DN_CT46:
  v_mfma_f32_16x16x32_bf16 v[132:135], v[36:39], v[240:243], v[132:135]
  ds_read_b64_tr_b16 v[64:65], v12 offset:57344
  ds_read_b64_tr_b16 v[66:67], v12 offset:61440
  v_mfma_f32_16x16x32_bf16 v[164:167], v[36:39], v[244:247], v[164:167]
  ds_read_b64_tr_b16 v[68:69], v13 offset:57344
  ds_read_b64_tr_b16 v[70:71], v13 offset:61440
  v_mfma_f32_16x16x32_bf16 v[136:139], v[40:43], v[240:243], v[136:139]
  ds_read_b64_tr_b16 v[72:73], v14 offset:57344
  ds_read_b64_tr_b16 v[74:75], v14 offset:61440
  v_mfma_f32_16x16x32_bf16 v[168:171], v[40:43], v[244:247], v[168:171]
  ds_read_b64_tr_b16 v[76:77], v15 offset:57344
  ds_read_b64_tr_b16 v[78:79], v15 offset:61440
  s_add_u32 m0, s46, 32768
  s_add_u32 s49, s48, 0
  buffer_load_dwordx4 v4, s[24:27], s49 offen lds
  v_mfma_f32_16x16x32_bf16 v[140:143], v[44:47], v[240:243], v[140:143]
  ds_read_b64_tr_b16 v[80:81], v16 offset:57344
  ds_read_b64_tr_b16 v[82:83], v16 offset:61440
  v_mfma_f32_16x16x32_bf16 v[172:175], v[44:47], v[244:247], v[172:175]
  ds_read_b64_tr_b16 v[84:85], v17 offset:57344
  ds_read_b64_tr_b16 v[86:87], v17 offset:61440
  v_mfma_f32_16x16x32_bf16 v[144:147], v[48:51], v[240:243], v[144:147]
  ds_read_b64_tr_b16 v[88:89], v18 offset:57344
  ds_read_b64_tr_b16 v[90:91], v18 offset:61440
  s_add_u32 s48, s48, 65536
  buffer_load_dwordx4 v5, s[24:27], s49 offen offset:1024 lds
  v_mfma_f32_16x16x32_bf16 v[176:179], v[48:51], v[244:247], v[176:179]
  ds_read_b64_tr_b16 v[92:93], v19 offset:57344
  ds_read_b64_tr_b16 v[94:95], v19 offset:61440
  ds_read_b32 v23, v21
  v_mfma_f32_16x16x32_bf16 v[148:151], v[52:55], v[240:243], v[148:151]
  v_mfma_f32_16x16x32_bf16 v[180:183], v[52:55], v[244:247], v[180:183]
  v_mfma_f32_16x16x32_bf16 v[152:155], v[56:59], v[240:243], v[152:155]
  buffer_load_dwordx4 v[232:235], v3, s[32:35], s44 offen
  v_mfma_f32_16x16x32_bf16 v[184:187], v[56:59], v[244:247], v[184:187]
  v_mfma_f32_16x16x32_bf16 v[156:159], v[60:63], v[240:243], v[156:159]
  v_mfma_f32_16x16x32_bf16 v[188:191], v[60:63], v[244:247], v[188:191]
  buffer_load_dwordx4 v[236:239], v10, s[32:35], s44 offen
  s_add_u32 s44, s44, 1024
  s_setprio 3
  s_waitcnt vmcnt(11) lgkmcnt(0)
  v_cmp_gt_i32 vcc, s53, v23
  s_setprio 1
  ds_add_u32 v20, v22
  s_add_u32 s53, s53, 1
  v_mfma_f32_16x16x32_bf16 v[128:131], v[64:67], v[248:251], v[128:131]
  v_mfma_f32_16x16x32_bf16 v[160:163], v[64:67], v[252:255], v[160:163]
  s_nop 0
  s_cbranch_vccnz DN_SP47
DN_CT47:
  v_mfma_f32_16x16x32_bf16 v[132:135], v[68:71], v[248:251], v[132:135]
  ds_read_b64_tr_b16 v[32:33], v12 offset:0
  ds_read_b64_tr_b16 v[34:35], v12 offset:4096
  v_mfma_f32_16x16x32_bf16 v[164:167], v[68:71], v[252:255], v[164:167]
  ds_read_b64_tr_b16 v[36:37], v13 offset:0
  ds_read_b64_tr_b16 v[38:39], v13 offset:4096
  v_mfma_f32_16x16x32_bf16 v[136:139], v[72:75], v[248:251], v[136:139]
  ds_read_b64_tr_b16 v[40:41], v14 offset:0
  ds_read_b64_tr_b16 v[42:43], v14 offset:4096
  v_mfma_f32_16x16x32_bf16 v[168:171], v[72:75], v[252:255], v[168:171]
  ds_read_b64_tr_b16 v[44:45], v15 offset:0
  ds_read_b64_tr_b16 v[46:47], v15 offset:4096
  s_add_u32 m0, s46, 40960
  s_add_u32 s49, s48, 0
  buffer_load_dwordx4 v4, s[24:27], s49 offen lds
  v_mfma_f32_16x16x32_bf16 v[140:143], v[76:79], v[248:251], v[140:143]
  ds_read_b64_tr_b16 v[48:49], v16 offset:0
  ds_read_b64_tr_b16 v[50:51], v16 offset:4096
  v_mfma_f32_16x16x32_bf16 v[172:175], v[76:79], v[252:255], v[172:175]
  ds_read_b64_tr_b16 v[52:53], v17 offset:0
  ds_read_b64_tr_b16 v[54:55], v17 offset:4096
  v_mfma_f32_16x16x32_bf16 v[144:147], v[80:83], v[248:251], v[144:147]
  ds_read_b64_tr_b16 v[56:57], v18 offset:0
  ds_read_b64_tr_b16 v[58:59], v18 offset:4096
  s_add_u32 s48, s48, 65536
  buffer_load_dwordx4 v5, s[24:27], s49 offen offset:1024 lds
  v_mfma_f32_16x16x32_bf16 v[176:179], v[80:83], v[252:255], v[176:179]
  ds_read_b64_tr_b16 v[60:61], v19 offset:0
  ds_read_b64_tr_b16 v[62:63], v19 offset:4096
  ds_read_b32 v23, v21
  v_mfma_f32_16x16x32_bf16 v[148:151], v[84:87], v[248:251], v[148:151]
  v_mfma_f32_16x16x32_bf16 v[180:183], v[84:87], v[252:255], v[180:183]
  v_mfma_f32_16x16x32_bf16 v[152:155], v[88:91], v[248:251], v[152:155]
  buffer_load_dwordx4 v[240:243], v3, s[32:35], s44 offen
  v_mfma_f32_16x16x32_bf16 v[184:187], v[88:91], v[252:255], v[184:187]
  v_mfma_f32_16x16x32_bf16 v[156:159], v[92:95], v[248:251], v[156:159]
  v_mfma_f32_16x16x32_bf16 v[188:191], v[92:95], v[252:255], v[188:191]
  buffer_load_dwordx4 v[244:247], v10, s[32:35], s44 offen
  s_add_u32 s44, s44, 1024
  s_setprio 3
  s_waitcnt vmcnt(10) lgkmcnt(0)
  v_cmp_gt_i32 vcc, s53, v23
  s_setprio 1
  ds_add_u32 v20, v22
  s_add_u32 s53, s53, 1
  v_mfma_f32_16x16x32_bf16 v[128:131], v[32:35], v[192:195], v[128:131]
  v_mfma_f32_16x16x32_bf16 v[160:163], v[32:35], v[196:199], v[160:163]
  s_nop 0
  s_cbranch_vccnz DN_SP48
DN_CT48:
  v_mfma_f32_16x16x32_bf16 v[132:135], v[36:39], v[192:195], v[132:135]
  ds_read_b64_tr_b16 v[64:65], v12 offset:8192
  ds_read_b64_tr_b16 v[66:67], v12 offset:12288
  v_mfma_f32_16x16x32_bf16 v[164:167], v[36:39], v[196:199], v[164:167]
  ds_read_b64_tr_b16 v[68:69], v13 offset:8192
  ds_read_b64_tr_b16 v[70:71], v13 offset:12288
  v_mfma_f32_16x16x32_bf16 v[136:139], v[40:43], v[192:195], v[136:139]
  ds_read_b64_tr_b16 v[72:73], v14 offset:8192
  ds_read_b64_tr_b16 v[74:75], v14 offset:12288
  v_mfma_f32_16x16x32_bf16 v[168:171], v[40:43], v[196:199], v[168:171]
  ds_read_b64_tr_b16 v[76:77], v15 offset:8192
  ds_read_b64_tr_b16 v[78:79], v15 offset:12288
  s_add_u32 m0, s46, 49152
  s_add_u32 s49, s48, 0
  buffer_load_dwordx4 v4, s[24:27], s49 offen lds
  v_mfma_f32_16x16x32_bf16 v[140:143], v[44:47], v[192:195], v[140:143]
  ds_read_b64_tr_b16 v[80:81], v16 offset:8192
  ds_read_b64_tr_b16 v[82:83], v16 offset:12288
  v_mfma_f32_16x16x32_bf16 v[172:175], v[44:47], v[196:199], v[172:175]
  ds_read_b64_tr_b16 v[84:85], v17 offset:8192
  ds_read_b64_tr_b16 v[86:87], v17 offset:12288
  v_mfma_f32_16x16x32_bf16 v[144:147], v[48:51], v[192:195], v[144:147]
  ds_read_b64_tr_b16 v[88:89], v18 offset:8192
  ds_read_b64_tr_b16 v[90:91], v18 offset:12288
  s_add_u32 s48, s48, 65536
  buffer_load_dwordx4 v5, s[24:27], s49 offen offset:1024 lds
  v_mfma_f32_16x16x32_bf16 v[176:179], v[48:51], v[196:199], v[176:179]
  ds_read_b64_tr_b16 v[92:93], v19 offset:8192
  ds_read_b64_tr_b16 v[94:95], v19 offset:12288
  ds_read_b32 v23, v21
  v_mfma_f32_16x16x32_bf16 v[148:151], v[52:55], v[192:195], v[148:151]
  v_mfma_f32_16x16x32_bf16 v[180:183], v[52:55], v[196:199], v[180:183]
  v_mfma_f32_16x16x32_bf16 v[152:155], v[56:59], v[192:195], v[152:155]
  buffer_load_dwordx4 v[248:251], v3, s[32:35], s44 offen
  v_mfma_f32_16x16x32_bf16 v[184:187], v[56:59], v[196:199], v[184:187]
  v_mfma_f32_16x16x32_bf16 v[156:159], v[60:63], v[192:195], v[156:159]
  v_mfma_f32_16x16x32_bf16 v[188:191], v[60:63], v[196:199], v[188:191]
  buffer_load_dwordx4 v[252:255], v10, s[32:35], s44 offen
  s_add_u32 s44, s44, 1024
  s_setprio 3
  s_waitcnt vmcnt(10) lgkmcnt(0)
  v_cmp_gt_i32 vcc, s53, v23
  s_setprio 1
  ds_add_u32 v20, v22
  s_add_u32 s53, s53, 1
  v_mfma_f32_16x16x32_bf16 v[128:131], v[64:67], v[200:203], v[128:131]
  v_mfma_f32_16x16x32_bf16 v[160:163], v[64:67], v[204:207], v[160:163]
  s_nop 0
  s_cbranch_vccnz DN_SP49
DN_CT49:
  v_mfma_f32_16x16x32_bf16 v[132:135], v[68:71], v[200:203], v[132:135]
  ds_read_b64_tr_b16 v[32:33], v12 offset:16384
  ds_read_b64_tr_b16 v[34:35], v12 offset:20480
  v_mfma_f32_16x16x32_bf16 v[164:167], v[68:71], v[204:207], v[164:167]
  ds_read_b64_tr_b16 v[36:37], v13 offset:16384
  ds_read_b64_tr_b16 v[38:39], v13 offset:20480
  v_mfma_f32_16x16x32_bf16 v[136:139], v[72:75], v[200:203], v[136:139]
  ds_read_b64_tr_b16 v[40:41], v14 offset:16384
  ds_read_b64_tr_b16 v[42:43], v14 offset:20480
  v_mfma_f32_16x16x32_bf16 v[168:171], v[72:75], v[204:207], v[168:171]
  ds_read_b64_tr_b16 v[44:45], v15 offset:16384
  ds_read_b64_tr_b16 v[46:47], v15 offset:20480
  v_mfma_f32_16x16x32_bf16 v[140:143], v[76:79], v[200:203], v[140:143]
  ds_read_b64_tr_b16 v[48:49], v16 offset:16384
  ds_read_b64_tr_b16 v[50:51], v16 offset:20480
  v_mfma_f32_16x16x32_bf16 v[172:175], v[76:79], v[204:207], v[172:175]
  ds_read_b64_tr_b16 v[52:53], v17 offset:16384
  ds_read_b64_tr_b16 v[54:55], v17 offset:20480
  v_mfma_f32_16x16x32_bf16 v[144:147], v[80:83], v[200:203], v[144:147]
  ds_read_b64_tr_b16 v[56:57], v18 offset:16384
  ds_read_b64_tr_b16 v[58:59], v18 offset:20480
  s_add_u32 m0, s46, 57344
  s_add_u32 s49, s48, 0
  buffer_load_dwordx4 v4, s[24:27], s49 offen lds
  v_mfma_f32_16x16x32_bf16 v[176:179], v[80:83], v[204:207], v[176:179]
  ds_read_b64_tr_b16 v[60:61], v19 offset:16384
  ds_read_b64_tr_b16 v[62:63], v19 offset:20480
  ds_read_b32 v23, v21
  v_mfma_f32_16x16x32_bf16 v[148:151], v[84:87], v[200:203], v[148:151]
  v_mfma_f32_16x16x32_bf16 v[180:183], v[84:87], v[204:207], v[180:183]
  v_mfma_f32_16x16x32_bf16 v[152:155], v[88:91], v[200:203], v[152:155]
  v_mfma_f32_16x16x32_bf16 v[184:187], v[88:91], v[204:207], v[184:187]
  v_mfma_f32_16x16x32_bf16 v[156:159], v[92:95], v[200:203], v[156:159]
  v_mfma_f32_16x16x32_bf16 v[188:191], v[92:95], v[204:207], v[188:191]
  s_add_u32 s48, s48, 65536
  buffer_load_dwordx4 v5, s[24:27], s49 offen offset:1024 lds
  s_setprio 3
  s_waitcnt vmcnt(8) lgkmcnt(0)
  v_cmp_gt_i32 vcc, s53, v23
  s_setprio 1
  ds_add_u32 v20, v22
  s_add_u32 s53, s53, 1
  v_mfma_f32_16x16x32_bf16 v[128:131], v[32:35], v[208:211], v[128:131]
  v_mfma_f32_16x16x32_bf16 v[160:163], v[32:35], v[212:215], v[160:163]
  s_nop 0
  s_cbranch_vccnz DN_SP50
DN_CT50:
  v_mfma_f32_16x16x32_bf16 v[132:135], v[36:39], v[208:211], v[132:135]
  ds_read_b64_tr_b16 v[64:65], v12 offset:24576
  ds_read_b64_tr_b16 v[66:67], v12 offset:28672
  v_mfma_f32_16x16x32_bf16 v[164:167], v[36:39], v[212:215], v[164:167]
  ds_read_b64_tr_b16 v[68:69], v13 offset:24576
  ds_read_b64_tr_b16 v[70:71], v13 offset:28672
  v_mfma_f32_16x16x32_bf16 v[136:139], v[40:43], v[208:211], v[136:139]
  ds_read_b64_tr_b16 v[72:73], v14 offset:24576
  ds_read_b64_tr_b16 v[74:75], v14 offset:28672
  v_mfma_f32_16x16x32_bf16 v[168:171], v[40:43], v[212:215], v[168:171]
  ds_read_b64_tr_b16 v[76:77], v15 offset:24576
  ds_read_b64_tr_b16 v[78:79], v15 offset:28672
  v_mfma_f32_16x16x32_bf16 v[140:143], v[44:47], v[208:211], v[140:143]
  ds_read_b64_tr_b16 v[80:81], v16 offset:24576
  ds_read_b64_tr_b16 v[82:83], v16 offset:28672
  v_mfma_f32_16x16x32_bf16 v[172:175], v[44:47], v[212:215], v[172:175]
  ds_read_b64_tr_b16 v[84:85], v17 offset:24576
  ds_read_b64_tr_b16 v[86:87], v17 offset:28672
  v_mfma_f32_16x16x32_bf16 v[144:147], v[48:51], v[208:211], v[144:147]
  ds_read_b64_tr_b16 v[88:89], v18 offset:24576
  ds_read_b64_tr_b16 v[90:91], v18 offset:28672
  s_mov_b32 s24, s4
  s_mov_b32 s25, s5
  s_mov_b32 s26, 0x200000
  s_mov_b32 s48, s40
  s_add_u32 m0, s46, 0
  s_add_u32 s49, s48, 0
  buffer_load_dwordx4 v4, s[24:27], s49 offen lds
  v_mfma_f32_16x16x32_bf16 v[176:179], v[48:51], v[212:215], v[176:179]
  ds_read_b64_tr_b16 v[92:93], v19 offset:24576
  ds_read_b64_tr_b16 v[94:95], v19 offset:28672
  ds_read_b32 v23, v21
  v_mfma_f32_16x16x32_bf16 v[148:151], v[52:55], v[208:211], v[148:151]
  v_mfma_f32_16x16x32_bf16 v[180:183], v[52:55], v[212:215], v[180:183]
  v_mfma_f32_16x16x32_bf16 v[152:155], v[56:59], v[208:211], v[152:155]
  v_mfma_f32_16x16x32_bf16 v[184:187], v[56:59], v[212:215], v[184:187]
  v_mfma_f32_16x16x32_bf16 v[156:159], v[60:63], v[208:211], v[156:159]
  v_mfma_f32_16x16x32_bf16 v[188:191], v[60:63], v[212:215], v[188:191]
  s_add_u32 s48, s48, 65536
  buffer_load_dwordx4 v5, s[24:27], s49 offen offset:1024 lds
  s_setprio 3
  s_waitcnt vmcnt(6) lgkmcnt(0)
  v_cmp_gt_i32 vcc, s53, v23
  s_setprio 1
  ds_add_u32 v20, v22
  s_add_u32 s53, s53, 1
  v_mfma_f32_16x16x32_bf16 v[128:131], v[64:67], v[216:219], v[128:131]
  v_mfma_f32_16x16x32_bf16 v[160:163], v[64:67], v[220:223], v[160:163]
  s_nop 0
  s_cbranch_vccnz DN_SP51
DN_CT51:
  v_mfma_f32_16x16x32_bf16 v[132:135], v[68:71], v[216:219], v[132:135]
  ds_read_b64_tr_b16 v[32:33], v12 offset:32768
  ds_read_b64_tr_b16 v[34:35], v12 offset:36864
  v_mfma_f32_16x16x32_bf16 v[164:167], v[68:71], v[220:223], v[164:167]
  ds_read_b64_tr_b16 v[36:37], v13 offset:32768
  ds_read_b64_tr_b16 v[38:39], v13 offset:36864
  v_mfma_f32_16x16x32_bf16 v[136:139], v[72:75], v[216:219], v[136:139]
  ds_read_b64_tr_b16 v[40:41], v14 offset:32768
  ds_read_b64_tr_b16 v[42:43], v14 offset:36864
  v_mfma_f32_16x16x32_bf16 v[168:171], v[72:75], v[220:223], v[168:171]
  ds_read_b64_tr_b16 v[44:45], v15 offset:32768
  ds_read_b64_tr_b16 v[46:47], v15 offset:36864
  v_mfma_f32_16x16x32_bf16 v[140:143], v[76:79], v[216:219], v[140:143]
  ds_read_b64_tr_b16 v[48:49], v16 offset:32768
  ds_read_b64_tr_b16 v[50:51], v16 offset:36864
  s_add_u32 m0, s46, 8192
  s_add_u32 s49, s48, 0
  buffer_load_dwordx4 v4, s[24:27], s49 offen lds
  v_mfma_f32_16x16x32_bf16 v[172:175], v[76:79], v[220:223], v[172:175]
  ds_read_b64_tr_b16 v[52:53], v17 offset:32768
  ds_read_b64_tr_b16 v[54:55], v17 offset:36864
  v_mfma_f32_16x16x32_bf16 v[144:147], v[80:83], v[216:219], v[144:147]
  ds_read_b64_tr_b16 v[56:57], v18 offset:32768
  ds_read_b64_tr_b16 v[58:59], v18 offset:36864
  v_mfma_f32_16x16x32_bf16 v[176:179], v[80:83], v[220:223], v[176:179]
  ds_read_b64_tr_b16 v[60:61], v19 offset:32768
  ds_read_b64_tr_b16 v[62:63], v19 offset:36864
  ds_read_b32 v23, v21
  v_mfma_f32_16x16x32_bf16 v[148:151], v[84:87], v[216:219], v[148:151]
  v_mfma_f32_16x16x32_bf16 v[180:183], v[84:87], v[220:223], v[180:183]
  s_add_u32 s48, s48, 65536
  buffer_load_dwordx4 v5, s[24:27], s49 offen offset:1024 lds
  v_mfma_f32_16x16x32_bf16 v[152:155], v[88:91], v[216:219], v[152:155]
  v_mfma_f32_16x16x32_bf16 v[184:187], v[88:91], v[220:223], v[184:187]
  v_mfma_f32_16x16x32_bf16 v[156:159], v[92:95], v[216:219], v[156:159]
  v_mfma_f32_16x16x32_bf16 v[188:191], v[92:95], v[220:223], v[188:191]
  buffer_load_dword v29, v28, s[32:35], s43 offen sc1
  s_setprio 3
  s_waitcnt vmcnt(5) lgkmcnt(0)
  v_cmp_gt_i32 vcc, s53, v23
  s_setprio 1
  ds_add_u32 v20, v22
  s_add_u32 s53, s53, 1
  v_mfma_f32_16x16x32_bf16 v[128:131], v[32:35], v[224:227], v[128:131]
  v_mfma_f32_16x16x32_bf16 v[160:163], v[32:35], v[228:231], v[160:163]
  s_nop 0
  s_cbranch_vccnz DN_SP52
DN_CT52:
  v_mfma_f32_16x16x32_bf16 v[132:135], v[36:39], v[224:227], v[132:135]
  ds_read_b64_tr_b16 v[64:65], v12 offset:40960
  ds_read_b64_tr_b16 v[66:67], v12 offset:45056
  v_mfma_f32_16x16x32_bf16 v[164:167], v[36:39], v[228:231], v[164:167]
  ds_read_b64_tr_b16 v[68:69], v13 offset:40960
  ds_read_b64_tr_b16 v[70:71], v13 offset:45056
  v_mfma_f32_16x16x32_bf16 v[136:139], v[40:43], v[224:227], v[136:139]
  ds_read_b64_tr_b16 v[72:73], v14 offset:40960
  ds_read_b64_tr_b16 v[74:75], v14 offset:45056
  v_mfma_f32_16x16x32_bf16 v[168:171], v[40:43], v[228:231], v[168:171]
  ds_read_b64_tr_b16 v[76:77], v15 offset:40960
  ds_read_b64_tr_b16 v[78:79], v15 offset:45056
  v_mfma_f32_16x16x32_bf16 v[140:143], v[44:47], v[224:227], v[140:143]
  ds_read_b64_tr_b16 v[80:81], v16 offset:40960
  ds_read_b64_tr_b16 v[82:83], v16 offset:45056
  v_mfma_f32_16x16x32_bf16 v[172:175], v[44:47], v[228:231], v[172:175]
  ds_read_b64_tr_b16 v[84:85], v17 offset:40960
  ds_read_b64_tr_b16 v[86:87], v17 offset:45056
  v_mfma_f32_16x16x32_bf16 v[144:147], v[48:51], v[224:227], v[144:147]
  ds_read_b64_tr_b16 v[88:89], v18 offset:40960
  ds_read_b64_tr_b16 v[90:91], v18 offset:45056
  s_add_u32 m0, s46, 16384
  s_add_u32 s49, s48, 0
  buffer_load_dwordx4 v4, s[24:27], s49 offen lds
  v_mfma_f32_16x16x32_bf16 v[176:179], v[48:51], v[228:231], v[176:179]
  ds_read_b64_tr_b16 v[92:93], v19 offset:40960
  ds_read_b64_tr_b16 v[94:95], v19 offset:45056
  ds_read_b32 v23, v21
  v_mfma_f32_16x16x32_bf16 v[148:151], v[52:55], v[224:227], v[148:151]
  v_mfma_f32_16x16x32_bf16 v[180:183], v[52:55], v[228:231], v[180:183]
  v_mfma_f32_16x16x32_bf16 v[152:155], v[56:59], v[224:227], v[152:155]
  v_mfma_f32_16x16x32_bf16 v[184:187], v[56:59], v[228:231], v[184:187]
  v_mfma_f32_16x16x32_bf16 v[156:159], v[60:63], v[224:227], v[156:159]
  v_mfma_f32_16x16x32_bf16 v[188:191], v[60:63], v[228:231], v[188:191]
  s_add_u32 s48, s48, 65536
  buffer_load_dwordx4 v5, s[24:27], s49 offen offset:1024 lds
  s_setprio 3
  s_waitcnt vmcnt(2) lgkmcnt(0)
  v_cmp_gt_i32 vcc, s53, v23
  s_setprio 1
  ds_add_u32 v20, v22
  s_add_u32 s53, s53, 1
  v_mfma_f32_16x16x32_bf16 v[128:131], v[64:67], v[232:235], v[128:131]
  v_mfma_f32_16x16x32_bf16 v[160:163], v[64:67], v[236:239], v[160:163]
  s_nop 0
  s_cbranch_vccnz DN_SP53
DN_CT53:
  s_mov_b32 exec_lo, 0xff
  s_mov_b32 exec_hi, 0x0
  v_cmp_ne_u32 vcc, s55, v29
  s_mov_b64 exec, -1
  s_cbranch_vccnz DN_OS
DN_OC:
  v_mfma_f32_16x16x32_bf16 v[132:135], v[68:71], v[232:235], v[132:135]
  ds_read_b64_tr_b16 v[32:33], v12 offset:49152
  ds_read_b64_tr_b16 v[34:35], v12 offset:53248
  v_mfma_f32_16x16x32_bf16 v[164:167], v[68:71], v[236:239], v[164:167]
  ds_read_b64_tr_b16 v[36:37], v13 offset:49152
  ds_read_b64_tr_b16 v[38:39], v13 offset:53248
  v_mfma_f32_16x16x32_bf16 v[136:139], v[72:75], v[232:235], v[136:139]
  ds_read_b64_tr_b16 v[40:41], v14 offset:49152
  ds_read_b64_tr_b16 v[42:43], v14 offset:53248
  v_mfma_f32_16x16x32_bf16 v[168:171], v[72:75], v[236:239], v[168:171]
  ds_read_b64_tr_b16 v[44:45], v15 offset:49152
  ds_read_b64_tr_b16 v[46:47], v15 offset:53248
  s_add_u32 m0, s46, 24576
  s_add_u32 s49, s48, 0
  buffer_load_dwordx4 v4, s[24:27], s49 offen lds
  v_mfma_f32_16x16x32_bf16 v[140:143], v[76:79], v[232:235], v[140:143]
  ds_read_b64_tr_b16 v[48:49], v16 offset:49152
  ds_read_b64_tr_b16 v[50:51], v16 offset:53248
  v_mfma_f32_16x16x32_bf16 v[172:175], v[76:79], v[236:239], v[172:175]
  ds_read_b64_tr_b16 v[52:53], v17 offset:49152
  ds_read_b64_tr_b16 v[54:55], v17 offset:53248
  v_mfma_f32_16x16x32_bf16 v[144:147], v[80:83], v[232:235], v[144:147]
  ds_read_b64_tr_b16 v[56:57], v18 offset:49152
  ds_read_b64_tr_b16 v[58:59], v18 offset:53248
  s_add_u32 s48, s48, 65536
  buffer_load_dwordx4 v5, s[24:27], s49 offen offset:1024 lds
  v_mfma_f32_16x16x32_bf16 v[176:179], v[80:83], v[236:239], v[176:179]
  ds_read_b64_tr_b16 v[60:61], v19 offset:49152
  ds_read_b64_tr_b16 v[62:63], v19 offset:53248
  ds_read_b32 v23, v21
  v_mfma_f32_16x16x32_bf16 v[148:151], v[84:87], v[232:235], v[148:151]
  v_mfma_f32_16x16x32_bf16 v[180:183], v[84:87], v[236:239], v[180:183]
  v_mfma_f32_16x16x32_bf16 v[152:155], v[88:91], v[232:235], v[152:155]
  s_mov_b32 s44, s41
  buffer_load_dwordx4 v[192:195], v3, s[32:35], s44 offen
  v_mfma_f32_16x16x32_bf16 v[184:187], v[88:91], v[236:239], v[184:187]
  v_mfma_f32_16x16x32_bf16 v[156:159], v[92:95], v[232:235], v[156:159]
  v_mfma_f32_16x16x32_bf16 v[188:191], v[92:95], v[236:239], v[188:191]
  buffer_load_dwordx4 v[196:199], v27, s[32:35], s44 offen
  s_add_u32 s44, s44, 1024
  s_setprio 3
  s_waitcnt vmcnt(6) lgkmcnt(0)
  v_cmp_gt_i32 vcc, s53, v23
  s_setprio 1
  ds_add_u32 v20, v22
  s_add_u32 s53, s53, 1
  v_mfma_f32_16x16x32_bf16 v[128:131], v[32:35], v[240:243], v[128:131]
  v_mfma_f32_16x16x32_bf16 v[160:163], v[32:35], v[244:247], v[160:163]
  s_nop 0
  s_cbranch_vccnz DN_SP54
DN_CT54:
  v_mfma_f32_16x16x32_bf16 v[132:135], v[36:39], v[240:243], v[132:135]
  ds_read_b64_tr_b16 v[64:65], v12 offset:57344
  ds_read_b64_tr_b16 v[66:67], v12 offset:61440
  v_mfma_f32_16x16x32_bf16 v[164:167], v[36:39], v[244:247], v[164:167]
  ds_read_b64_tr_b16 v[68:69], v13 offset:57344
  ds_read_b64_tr_b16 v[70:71], v13 offset:61440
  v_mfma_f32_16x16x32_bf16 v[136:139], v[40:43], v[240:243], v[136:139]
  ds_read_b64_tr_b16 v[72:73], v14 offset:57344
  ds_read_b64_tr_b16 v[74:75], v14 offset:61440
  v_mfma_f32_16x16x32_bf16 v[168:171], v[40:43], v[244:247], v[168:171]
  ds_read_b64_tr_b16 v[76:77], v15 offset:57344
  ds_read_b64_tr_b16 v[78:79], v15 offset:61440
  s_add_u32 m0, s46, 32768
  s_add_u32 s49, s48, 0
  buffer_load_dwordx4 v4, s[24:27], s49 offen lds
  v_mfma_f32_16x16x32_bf16 v[140:143], v[44:47], v[240:243], v[140:143]
  ds_read_b64_tr_b16 v[80:81], v16 offset:57344
  ds_read_b64_tr_b16 v[82:83], v16 offset:61440
  v_mfma_f32_16x16x32_bf16 v[172:175], v[44:47], v[244:247], v[172:175]
  ds_read_b64_tr_b16 v[84:85], v17 offset:57344
  ds_read_b64_tr_b16 v[86:87], v17 offset:61440
  v_mfma_f32_16x16x32_bf16 v[144:147], v[48:51], v[240:243], v[144:147]
  ds_read_b64_tr_b16 v[88:89], v18 offset:57344
  ds_read_b64_tr_b16 v[90:91], v18 offset:61440
  s_add_u32 s48, s48, 65536
  buffer_load_dwordx4 v5, s[24:27], s49 offen offset:1024 lds
  v_mfma_f32_16x16x32_bf16 v[176:179], v[48:51], v[244:247], v[176:179]
  ds_read_b64_tr_b16 v[92:93], v19 offset:57344
  ds_read_b64_tr_b16 v[94:95], v19 offset:61440
  ds_read_b32 v23, v21
  v_mfma_f32_16x16x32_bf16 v[148:151], v[52:55], v[240:243], v[148:151]
  v_mfma_f32_16x16x32_bf16 v[180:183], v[52:55], v[244:247], v[180:183]
  v_mfma_f32_16x16x32_bf16 v[152:155], v[56:59], v[240:243], v[152:155]
  buffer_load_dwordx4 v[200:203], v3, s[32:35], s44 offen
  v_mfma_f32_16x16x32_bf16 v[184:187], v[56:59], v[244:247], v[184:187]
  v_mfma_f32_16x16x32_bf16 v[156:159], v[60:63], v[240:243], v[156:159]
  v_mfma_f32_16x16x32_bf16 v[188:191], v[60:63], v[244:247], v[188:191]
  buffer_load_dwordx4 v[204:207], v27, s[32:35], s44 offen
  s_add_u32 s44, s44, 1024
  s_setprio 3
  s_waitcnt vmcnt(8) lgkmcnt(0)
  v_cmp_gt_i32 vcc, s53, v23
  s_setprio 1
  ds_add_u32 v20, v22
  s_add_u32 s53, s53, 1
  v_mfma_f32_16x16x32_bf16 v[128:131], v[64:67], v[248:251], v[128:131]
  v_mfma_f32_16x16x32_bf16 v[160:163], v[64:67], v[252:255], v[160:163]
  s_nop 0
  s_cbranch_vccnz DN_SP55
DN_CT55:
  v_mfma_f32_16x16x32_bf16 v[132:135], v[68:71], v[248:251], v[132:135]
  ds_read_b64_tr_b16 v[32:33], v12 offset:0
  ds_read_b64_tr_b16 v[34:35], v12 offset:4096
  v_mfma_f32_16x16x32_bf16 v[164:167], v[68:71], v[252:255], v[164:167]
  ds_read_b64_tr_b16 v[36:37], v13 offset:0
  ds_read_b64_tr_b16 v[38:39], v13 offset:4096
  v_mfma_f32_16x16x32_bf16 v[136:139], v[72:75], v[248:251], v[136:139]
  ds_read_b64_tr_b16 v[40:41], v14 offset:0
  ds_read_b64_tr_b16 v[42:43], v14 offset:4096
  v_mfma_f32_16x16x32_bf16 v[168:171], v[72:75], v[252:255], v[168:171]
  ds_read_b64_tr_b16 v[44:45], v15 offset:0
  ds_read_b64_tr_b16 v[46:47], v15 offset:4096
  s_add_u32 m0, s46, 40960
  s_add_u32 s49, s48, 0
  buffer_load_dwordx4 v4, s[24:27], s49 offen lds
  v_mfma_f32_16x16x32_bf16 v[140:143], v[76:79], v[248:251], v[140:143]
  ds_read_b64_tr_b16 v[48:49], v16 offset:0
  ds_read_b64_tr_b16 v[50:51], v16 offset:4096
  v_mfma_f32_16x16x32_bf16 v[172:175], v[76:79], v[252:255], v[172:175]
  ds_read_b64_tr_b16 v[52:53], v17 offset:0
  ds_read_b64_tr_b16 v[54:55], v17 offset:4096
  v_mfma_f32_16x16x32_bf16 v[144:147], v[80:83], v[248:251], v[144:147]
  ds_read_b64_tr_b16 v[56:57], v18 offset:0
  ds_read_b64_tr_b16 v[58:59], v18 offset:4096
  s_add_u32 s48, s48, 65536
  buffer_load_dwordx4 v5, s[24:27], s49 offen offset:1024 lds
  v_mfma_f32_16x16x32_bf16 v[176:179], v[80:83], v[252:255], v[176:179]
  ds_read_b64_tr_b16 v[60:61], v19 offset:0
  ds_read_b64_tr_b16 v[62:63], v19 offset:4096
  ds_read_b32 v23, v21
  v_mfma_f32_16x16x32_bf16 v[148:151], v[84:87], v[248:251], v[148:151]
  v_mfma_f32_16x16x32_bf16 v[180:183], v[84:87], v[252:255], v[180:183]
  v_mfma_f32_16x16x32_bf16 v[152:155], v[88:91], v[248:251], v[152:155]
  buffer_load_dwordx4 v[208:211], v3, s[32:35], s44 offen
  v_mfma_f32_16x16x32_bf16 v[184:187], v[88:91], v[252:255], v[184:187]
  v_mfma_f32_16x16x32_bf16 v[156:159], v[92:95], v[248:251], v[156:159]
  v_mfma_f32_16x16x32_bf16 v[188:191], v[92:95], v[252:255], v[188:191]
  buffer_load_dwordx4 v[212:215], v27, s[32:35], s44 offen
  s_add_u32 s44, s44, 1024
  s_setprio 3
  s_waitcnt vmcnt(8) lgkmcnt(0)
  v_cmp_gt_i32 vcc, s53, v23
  s_setprio 1
  ds_add_u32 v20, v22
  s_add_u32 s53, s53, 1
  v_mfma_f32_16x16x32_bf16 v[128:131], v[32:35], v[192:195], v[128:131]
  v_mfma_f32_16x16x32_bf16 v[160:163], v[32:35], v[196:199], v[160:163]
  s_nop 0
  s_cbranch_vccnz DN_SP56
DN_CT56:
  v_mfma_f32_16x16x32_bf16 v[132:135], v[36:39], v[192:195], v[132:135]
  ds_read_b64_tr_b16 v[64:65], v12 offset:8192
  ds_read_b64_tr_b16 v[66:67], v12 offset:12288
  v_mfma_f32_16x16x32_bf16 v[164:167], v[36:39], v[196:199], v[164:167]
  ds_read_b64_tr_b16 v[68:69], v13 offset:8192
  ds_read_b64_tr_b16 v[70:71], v13 offset:12288
  v_mfma_f32_16x16x32_bf16 v[136:139], v[40:43], v[192:195], v[136:139]
  ds_read_b64_tr_b16 v[72:73], v14 offset:8192
  ds_read_b64_tr_b16 v[74:75], v14 offset:12288
  v_mfma_f32_16x16x32_bf16 v[168:171], v[40:43], v[196:199], v[168:171]
  ds_read_b64_tr_b16 v[76:77], v15 offset:8192
  ds_read_b64_tr_b16 v[78:79], v15 offset:12288
  s_add_u32 m0, s46, 49152
  s_add_u32 s49, s48, 0
  buffer_load_dwordx4 v4, s[24:27], s49 offen lds
  v_mfma_f32_16x16x32_bf16 v[140:143], v[44:47], v[192:195], v[140:143]
  ds_read_b64_tr_b16 v[80:81], v16 offset:8192
  ds_read_b64_tr_b16 v[82:83], v16 offset:12288
  v_mfma_f32_16x16x32_bf16 v[172:175], v[44:47], v[196:199], v[172:175]
  ds_read_b64_tr_b16 v[84:85], v17 offset:8192
  ds_read_b64_tr_b16 v[86:87], v17 offset:12288
  v_mfma_f32_16x16x32_bf16 v[144:147], v[48:51], v[192:195], v[144:147]
  ds_read_b64_tr_b16 v[88:89], v18 offset:8192
  ds_read_b64_tr_b16 v[90:91], v18 offset:12288
  s_add_u32 s48, s48, 65536
  buffer_load_dwordx4 v5, s[24:27], s49 offen offset:1024 lds
  v_mfma_f32_16x16x32_bf16 v[176:179], v[48:51], v[196:199], v[176:179]
  ds_read_b64_tr_b16 v[92:93], v19 offset:8192
  ds_read_b64_tr_b16 v[94:95], v19 offset:12288
  ds_read_b32 v23, v21
  v_mfma_f32_16x16x32_bf16 v[148:151], v[52:55], v[192:195], v[148:151]
  v_mfma_f32_16x16x32_bf16 v[180:183], v[52:55], v[196:199], v[180:183]
  v_mfma_f32_16x16x32_bf16 v[152:155], v[56:59], v[192:195], v[152:155]
  buffer_load_dwordx4 v[216:219], v3, s[32:35], s44 offen
  v_mfma_f32_16x16x32_bf16 v[184:187], v[56:59], v[196:199], v[184:187]
  v_mfma_f32_16x16x32_bf16 v[156:159], v[60:63], v[192:195], v[156:159]
  v_mfma_f32_16x16x32_bf16 v[188:191], v[60:63], v[196:199], v[188:191]
  buffer_load_dwordx4 v[220:223], v27, s[32:35], s44 offen
  s_add_u32 s44, s44, 1024
  s_setprio 3
  s_waitcnt vmcnt(8) lgkmcnt(0)
  v_cmp_gt_i32 vcc, s53, v23
  s_setprio 1
  ds_add_u32 v20, v22
  s_add_u32 s53, s53, 1
  v_mfma_f32_16x16x32_bf16 v[128:131], v[64:67], v[200:203], v[128:131]
  v_mfma_f32_16x16x32_bf16 v[160:163], v[64:67], v[204:207], v[160:163]
  s_nop 0
  s_cbranch_vccnz DN_SP57
DN_CT57:
  v_mfma_f32_16x16x32_bf16 v[132:135], v[68:71], v[200:203], v[132:135]
  ds_read_b64_tr_b16 v[32:33], v12 offset:16384
  ds_read_b64_tr_b16 v[34:35], v12 offset:20480
  v_mfma_f32_16x16x32_bf16 v[164:167], v[68:71], v[204:207], v[164:167]
  ds_read_b64_tr_b16 v[36:37], v13 offset:16384
  ds_read_b64_tr_b16 v[38:39], v13 offset:20480
  v_mfma_f32_16x16x32_bf16 v[136:139], v[72:75], v[200:203], v[136:139]
  ds_read_b64_tr_b16 v[40:41], v14 offset:16384
  ds_read_b64_tr_b16 v[42:43], v14 offset:20480
  v_mfma_f32_16x16x32_bf16 v[168:171], v[72:75], v[204:207], v[168:171]
  ds_read_b64_tr_b16 v[44:45], v15 offset:16384
  ds_read_b64_tr_b16 v[46:47], v15 offset:20480
  s_add_u32 m0, s46, 57344
  s_add_u32 s49, s48, 0
  buffer_load_dwordx4 v4, s[24:27], s49 offen lds
  v_mfma_f32_16x16x32_bf16 v[140:143], v[76:79], v[200:203], v[140:143]
  ds_read_b64_tr_b16 v[48:49], v16 offset:16384
  ds_read_b64_tr_b16 v[50:51], v16 offset:20480
  v_mfma_f32_16x16x32_bf16 v[172:175], v[76:79], v[204:207], v[172:175]
  ds_read_b64_tr_b16 v[52:53], v17 offset:16384
  ds_read_b64_tr_b16 v[54:55], v17 offset:20480
  v_mfma_f32_16x16x32_bf16 v[144:147], v[80:83], v[200:203], v[144:147]
  ds_read_b64_tr_b16 v[56:57], v18 offset:16384
  ds_read_b64_tr_b16 v[58:59], v18 offset:20480
  s_add_u32 s48, s48, 65536
  buffer_load_dwordx4 v5, s[24:27], s49 offen offset:1024 lds
  v_mfma_f32_16x16x32_bf16 v[176:179], v[80:83], v[204:207], v[176:179]
  ds_read_b64_tr_b16 v[60:61], v19 offset:16384
  ds_read_b64_tr_b16 v[62:63], v19 offset:20480
  ds_read_b32 v23, v21
  v_mfma_f32_16x16x32_bf16 v[148:151], v[84:87], v[200:203], v[148:151]
  v_mfma_f32_16x16x32_bf16 v[180:183], v[84:87], v[204:207], v[180:183]
  v_mfma_f32_16x16x32_bf16 v[152:155], v[88:91], v[200:203], v[152:155]
  buffer_load_dwordx4 v[224:227], v3, s[32:35], s44 offen
  v_mfma_f32_16x16x32_bf16 v[184:187], v[88:91], v[204:207], v[184:187]
  v_mfma_f32_16x16x32_bf16 v[156:159], v[92:95], v[200:203], v[156:159]
  v_mfma_f32_16x16x32_bf16 v[188:191], v[92:95], v[204:207], v[188:191]
  buffer_load_dwordx4 v[228:231], v27, s[32:35], s44 offen
  s_add_u32 s44, s44, 1024
  s_setprio 3
  s_waitcnt vmcnt(8) lgkmcnt(0)
  v_cmp_gt_i32 vcc, s53, v23
  s_setprio 1
  ds_add_u32 v20, v22
  s_add_u32 s53, s53, 1
  v_mfma_f32_16x16x32_bf16 v[128:131], v[32:35], v[208:211], v[128:131]
  v_mfma_f32_16x16x32_bf16 v[160:163], v[32:35], v[212:215], v[160:163]
  s_nop 0
  s_cbranch_vccnz DN_SP58
DN_CT58:
  v_mfma_f32_16x16x32_bf16 v[132:135], v[36:39], v[208:211], v[132:135]
  ds_read_b64_tr_b16 v[64:65], v12 offset:24576
  ds_read_b64_tr_b16 v[66:67], v12 offset:28672
  v_mfma_f32_16x16x32_bf16 v[164:167], v[36:39], v[212:215], v[164:167]
  ds_read_b64_tr_b16 v[68:69], v13 offset:24576
  ds_read_b64_tr_b16 v[70:71], v13 offset:28672
  v_mfma_f32_16x16x32_bf16 v[136:139], v[40:43], v[208:211], v[136:139]
  ds_read_b64_tr_b16 v[72:73], v14 offset:24576
  ds_read_b64_tr_b16 v[74:75], v14 offset:28672
  v_mfma_f32_16x16x32_bf16 v[168:171], v[40:43], v[212:215], v[168:171]
  ds_read_b64_tr_b16 v[76:77], v15 offset:24576
  ds_read_b64_tr_b16 v[78:79], v15 offset:28672
  v_mfma_f32_16x16x32_bf16 v[140:143], v[44:47], v[208:211], v[140:143]
  ds_read_b64_tr_b16 v[80:81], v16 offset:24576
  ds_read_b64_tr_b16 v[82:83], v16 offset:28672
  v_mfma_f32_16x16x32_bf16 v[172:175], v[44:47], v[212:215], v[172:175]
  ds_read_b64_tr_b16 v[84:85], v17 offset:24576
  ds_read_b64_tr_b16 v[86:87], v17 offset:28672
  v_mfma_f32_16x16x32_bf16 v[144:147], v[48:51], v[208:211], v[144:147]
  ds_read_b64_tr_b16 v[88:89], v18 offset:24576
  ds_read_b64_tr_b16 v[90:91], v18 offset:28672
  buffer_load_dwordx4 v[232:235], v3, s[32:35], s44 offen
  v_mfma_f32_16x16x32_bf16 v[176:179], v[48:51], v[212:215], v[176:179]
  ds_read_b64_tr_b16 v[92:93], v19 offset:24576
  ds_read_b64_tr_b16 v[94:95], v19 offset:28672
  ds_read_b32 v23, v21
  v_mfma_f32_16x16x32_bf16 v[148:151], v[52:55], v[208:211], v[148:151]
  v_mfma_f32_16x16x32_bf16 v[180:183], v[52:55], v[212:215], v[180:183]
  v_mfma_f32_16x16x32_bf16 v[152:155], v[56:59], v[208:211], v[152:155]
  v_mfma_f32_16x16x32_bf16 v[184:187], v[56:59], v[212:215], v[184:187]
  v_mfma_f32_16x16x32_bf16 v[156:159], v[60:63], v[208:211], v[156:159]
  v_mfma_f32_16x16x32_bf16 v[188:191], v[60:63], v[212:215], v[188:191]
  buffer_load_dwordx4 v[236:239], v27, s[32:35], s44 offen
  s_add_u32 s44, s44, 1024
  s_setprio 3
  s_waitcnt vmcnt(6) lgkmcnt(0)
  v_cmp_gt_i32 vcc, s53, v23
  s_setprio 1
  ds_add_u32 v20, v22
  s_add_u32 s53, s53, 1
  v_mfma_f32_16x16x32_bf16 v[128:131], v[64:67], v[216:219], v[128:131]
  v_mfma_f32_16x16x32_bf16 v[160:163], v[64:67], v[220:223], v[160:163]
  s_nop 0
  s_cbranch_vccnz DN_SP59
DN_CT59:
  v_mfma_f32_16x16x32_bf16 v[132:135], v[68:71], v[216:219], v[132:135]
  ds_read_b64_tr_b16 v[32:33], v12 offset:32768
  ds_read_b64_tr_b16 v[34:35], v12 offset:36864
  v_mfma_f32_16x16x32_bf16 v[164:167], v[68:71], v[220:223], v[164:167]
  ds_read_b64_tr_b16 v[36:37], v13 offset:32768
  ds_read_b64_tr_b16 v[38:39], v13 offset:36864
  v_mfma_f32_16x16x32_bf16 v[136:139], v[72:75], v[216:219], v[136:139]
  ds_read_b64_tr_b16 v[40:41], v14 offset:32768
  ds_read_b64_tr_b16 v[42:43], v14 offset:36864
  v_mfma_f32_16x16x32_bf16 v[168:171], v[72:75], v[220:223], v[168:171]
  ds_read_b64_tr_b16 v[44:45], v15 offset:32768
  ds_read_b64_tr_b16 v[46:47], v15 offset:36864
  v_mfma_f32_16x16x32_bf16 v[140:143], v[76:79], v[216:219], v[140:143]
  ds_read_b64_tr_b16 v[48:49], v16 offset:32768
  ds_read_b64_tr_b16 v[50:51], v16 offset:36864
  v_mfma_f32_16x16x32_bf16 v[172:175], v[76:79], v[220:223], v[172:175]
  ds_read_b64_tr_b16 v[52:53], v17 offset:32768
  ds_read_b64_tr_b16 v[54:55], v17 offset:36864
  v_mfma_f32_16x16x32_bf16 v[144:147], v[80:83], v[216:219], v[144:147]
  ds_read_b64_tr_b16 v[56:57], v18 offset:32768
  ds_read_b64_tr_b16 v[58:59], v18 offset:36864
  buffer_load_dwordx4 v[240:243], v3, s[32:35], s44 offen
  v_mfma_f32_16x16x32_bf16 v[176:179], v[80:83], v[220:223], v[176:179]
  ds_read_b64_tr_b16 v[60:61], v19 offset:32768
  ds_read_b64_tr_b16 v[62:63], v19 offset:36864
  ds_read_b32 v23, v21
  v_mfma_f32_16x16x32_bf16 v[148:151], v[84:87], v[216:219], v[148:151]
  v_mfma_f32_16x16x32_bf16 v[180:183], v[84:87], v[220:223], v[180:183]
  v_mfma_f32_16x16x32_bf16 v[152:155], v[88:91], v[216:219], v[152:155]
  v_mfma_f32_16x16x32_bf16 v[184:187], v[88:91], v[220:223], v[184:187]
  v_mfma_f32_16x16x32_bf16 v[156:159], v[92:95], v[216:219], v[156:159]
  v_mfma_f32_16x16x32_bf16 v[188:191], v[92:95], v[220:223], v[188:191]
  buffer_load_dwordx4 v[244:247], v27, s[32:35], s44 offen
  s_add_u32 s44, s44, 1024
  s_setprio 3
  s_waitcnt vmcnt(4) lgkmcnt(0)
  v_cmp_gt_i32 vcc, s53, v23
  s_setprio 1
  ds_add_u32 v20, v22
  s_add_u32 s53, s53, 1
  v_mfma_f32_16x16x32_bf16 v[128:131], v[32:35], v[224:227], v[128:131]
  v_mfma_f32_16x16x32_bf16 v[160:163], v[32:35], v[228:231], v[160:163]
  s_nop 0
  s_cbranch_vccnz DN_SP60
DN_CT60:
  v_mfma_f32_16x16x32_bf16 v[132:135], v[36:39], v[224:227], v[132:135]
  ds_read_b64_tr_b16 v[64:65], v12 offset:40960
  ds_read_b64_tr_b16 v[66:67], v12 offset:45056
  v_mfma_f32_16x16x32_bf16 v[164:167], v[36:39], v[228:231], v[164:167]
  ds_read_b64_tr_b16 v[68:69], v13 offset:40960
  ds_read_b64_tr_b16 v[70:71], v13 offset:45056
  v_mfma_f32_16x16x32_bf16 v[136:139], v[40:43], v[224:227], v[136:139]
  ds_read_b64_tr_b16 v[72:73], v14 offset:40960
  ds_read_b64_tr_b16 v[74:75], v14 offset:45056
  v_mfma_f32_16x16x32_bf16 v[168:171], v[40:43], v[228:231], v[168:171]
  ds_read_b64_tr_b16 v[76:77], v15 offset:40960
  ds_read_b64_tr_b16 v[78:79], v15 offset:45056
  v_mfma_f32_16x16x32_bf16 v[140:143], v[44:47], v[224:227], v[140:143]
  ds_read_b64_tr_b16 v[80:81], v16 offset:40960
  ds_read_b64_tr_b16 v[82:83], v16 offset:45056
  v_mfma_f32_16x16x32_bf16 v[172:175], v[44:47], v[228:231], v[172:175]
  ds_read_b64_tr_b16 v[84:85], v17 offset:40960
  ds_read_b64_tr_b16 v[86:87], v17 offset:45056
  v_mfma_f32_16x16x32_bf16 v[144:147], v[48:51], v[224:227], v[144:147]
  ds_read_b64_tr_b16 v[88:89], v18 offset:40960
  ds_read_b64_tr_b16 v[90:91], v18 offset:45056
  buffer_load_dwordx4 v[248:251], v3, s[32:35], s44 offen
  v_mfma_f32_16x16x32_bf16 v[176:179], v[48:51], v[228:231], v[176:179]
  ds_read_b64_tr_b16 v[92:93], v19 offset:40960
  ds_read_b64_tr_b16 v[94:95], v19 offset:45056
  ds_read_b32 v23, v21
  v_mfma_f32_16x16x32_bf16 v[148:151], v[52:55], v[224:227], v[148:151]
  v_mfma_f32_16x16x32_bf16 v[180:183], v[52:55], v[228:231], v[180:183]
  v_mfma_f32_16x16x32_bf16 v[152:155], v[56:59], v[224:227], v[152:155]
  v_mfma_f32_16x16x32_bf16 v[184:187], v[56:59], v[228:231], v[184:187]
  v_mfma_f32_16x16x32_bf16 v[156:159], v[60:63], v[224:227], v[156:159]
  v_mfma_f32_16x16x32_bf16 v[188:191], v[60:63], v[228:231], v[188:191]
  buffer_load_dwordx4 v[252:255], v27, s[32:35], s44 offen
  s_add_u32 s44, s44, 1024
  s_setprio 3
  s_waitcnt vmcnt(4) lgkmcnt(0)
  v_cmp_gt_i32 vcc, s53, v23
  s_setprio 1
  ds_add_u32 v20, v22
  s_add_u32 s53, s53, 1
  v_mfma_f32_16x16x32_bf16 v[128:131], v[64:67], v[232:235], v[128:131]
  v_mfma_f32_16x16x32_bf16 v[160:163], v[64:67], v[236:239], v[160:163]
  s_nop 0
  s_cbranch_vccnz DN_SP61
DN_CT61:
  v_mfma_f32_16x16x32_bf16 v[132:135], v[68:71], v[232:235], v[132:135]
  ds_read_b64_tr_b16 v[32:33], v12 offset:49152
  ds_read_b64_tr_b16 v[34:35], v12 offset:53248
  v_mfma_f32_16x16x32_bf16 v[164:167], v[68:71], v[236:239], v[164:167]
  ds_read_b64_tr_b16 v[36:37], v13 offset:49152
  ds_read_b64_tr_b16 v[38:39], v13 offset:53248
  v_mfma_f32_16x16x32_bf16 v[136:139], v[72:75], v[232:235], v[136:139]
  ds_read_b64_tr_b16 v[40:41], v14 offset:49152
  ds_read_b64_tr_b16 v[42:43], v14 offset:53248
  v_mfma_f32_16x16x32_bf16 v[168:171], v[72:75], v[236:239], v[168:171]
  ds_read_b64_tr_b16 v[44:45], v15 offset:49152
  ds_read_b64_tr_b16 v[46:47], v15 offset:53248
  v_mfma_f32_16x16x32_bf16 v[140:143], v[76:79], v[232:235], v[140:143]
  ds_read_b64_tr_b16 v[48:49], v16 offset:49152
  ds_read_b64_tr_b16 v[50:51], v16 offset:53248
  v_mfma_f32_16x16x32_bf16 v[172:175], v[76:79], v[236:239], v[172:175]
  ds_read_b64_tr_b16 v[52:53], v17 offset:49152
  ds_read_b64_tr_b16 v[54:55], v17 offset:53248
  v_mfma_f32_16x16x32_bf16 v[144:147], v[80:83], v[232:235], v[144:147]
  ds_read_b64_tr_b16 v[56:57], v18 offset:49152
  ds_read_b64_tr_b16 v[58:59], v18 offset:53248
  v_mfma_f32_16x16x32_bf16 v[176:179], v[80:83], v[236:239], v[176:179]
  ds_read_b64_tr_b16 v[60:61], v19 offset:49152
  ds_read_b64_tr_b16 v[62:63], v19 offset:53248
  ds_read_b32 v23, v21
  v_mfma_f32_16x16x32_bf16 v[148:151], v[84:87], v[232:235], v[148:151]
  v_mfma_f32_16x16x32_bf16 v[180:183], v[84:87], v[236:239], v[180:183]
  v_mfma_f32_16x16x32_bf16 v[152:155], v[88:91], v[232:235], v[152:155]
  v_mfma_f32_16x16x32_bf16 v[184:187], v[88:91], v[236:239], v[184:187]
  v_mfma_f32_16x16x32_bf16 v[156:159], v[92:95], v[232:235], v[156:159]
  v_mfma_f32_16x16x32_bf16 v[188:191], v[92:95], v[236:239], v[188:191]
  s_setprio 3
  s_waitcnt vmcnt(2) lgkmcnt(0)
  v_cmp_gt_i32 vcc, s53, v23
  s_setprio 1
  ds_add_u32 v20, v22
  s_add_u32 s53, s53, 1
  v_mfma_f32_16x16x32_bf16 v[128:131], v[32:35], v[240:243], v[128:131]
  v_mfma_f32_16x16x32_bf16 v[160:163], v[32:35], v[244:247], v[160:163]
  s_nop 0
  s_cbranch_vccnz DN_SP62
DN_CT62:
  v_mfma_f32_16x16x32_bf16 v[132:135], v[36:39], v[240:243], v[132:135]
  ds_read_b64_tr_b16 v[64:65], v12 offset:57344
  ds_read_b64_tr_b16 v[66:67], v12 offset:61440
  v_mfma_f32_16x16x32_bf16 v[164:167], v[36:39], v[244:247], v[164:167]
  ds_read_b64_tr_b16 v[68:69], v13 offset:57344
  ds_read_b64_tr_b16 v[70:71], v13 offset:61440
  v_mfma_f32_16x16x32_bf16 v[136:139], v[40:43], v[240:243], v[136:139]
  ds_read_b64_tr_b16 v[72:73], v14 offset:57344
  ds_read_b64_tr_b16 v[74:75], v14 offset:61440
  v_mfma_f32_16x16x32_bf16 v[168:171], v[40:43], v[244:247], v[168:171]
  ds_read_b64_tr_b16 v[76:77], v15 offset:57344
  ds_read_b64_tr_b16 v[78:79], v15 offset:61440
  v_mfma_f32_16x16x32_bf16 v[140:143], v[44:47], v[240:243], v[140:143]
  ds_read_b64_tr_b16 v[80:81], v16 offset:57344
  ds_read_b64_tr_b16 v[82:83], v16 offset:61440
  v_mfma_f32_16x16x32_bf16 v[172:175], v[44:47], v[244:247], v[172:175]
  ds_read_b64_tr_b16 v[84:85], v17 offset:57344
  ds_read_b64_tr_b16 v[86:87], v17 offset:61440
  v_mfma_f32_16x16x32_bf16 v[144:147], v[48:51], v[240:243], v[144:147]
  ds_read_b64_tr_b16 v[88:89], v18 offset:57344
  ds_read_b64_tr_b16 v[90:91], v18 offset:61440
  v_mfma_f32_16x16x32_bf16 v[176:179], v[48:51], v[244:247], v[176:179]
  ds_read_b64_tr_b16 v[92:93], v19 offset:57344
  ds_read_b64_tr_b16 v[94:95], v19 offset:61440
  ds_read_b32 v23, v21
  v_mfma_f32_16x16x32_bf16 v[148:151], v[52:55], v[240:243], v[148:151]
  v_mfma_f32_16x16x32_bf16 v[180:183], v[52:55], v[244:247], v[180:183]
  v_mfma_f32_16x16x32_bf16 v[152:155], v[56:59], v[240:243], v[152:155]
  v_mfma_f32_16x16x32_bf16 v[184:187], v[56:59], v[244:247], v[184:187]
  v_mfma_f32_16x16x32_bf16 v[156:159], v[60:63], v[240:243], v[156:159]
  v_mfma_f32_16x16x32_bf16 v[188:191], v[60:63], v[244:247], v[188:191]
  s_waitcnt vmcnt(0) lgkmcnt(0)
  v_mfma_f32_16x16x32_bf16 v[128:131], v[64:67], v[248:251], v[128:131]
  v_mfma_f32_16x16x32_bf16 v[160:163], v[64:67], v[252:255], v[160:163]
  v_mfma_f32_16x16x32_bf16 v[132:135], v[68:71], v[248:251], v[132:135]
  v_mfma_f32_16x16x32_bf16 v[164:167], v[68:71], v[252:255], v[164:167]
  v_mfma_f32_16x16x32_bf16 v[136:139], v[72:75], v[248:251], v[136:139]
  v_mfma_f32_16x16x32_bf16 v[168:171], v[72:75], v[252:255], v[168:171]
  v_mfma_f32_16x16x32_bf16 v[140:143], v[76:79], v[248:251], v[140:143]
  v_mfma_f32_16x16x32_bf16 v[172:175], v[76:79], v[252:255], v[172:175]
  v_mfma_f32_16x16x32_bf16 v[144:147], v[80:83], v[248:251], v[144:147]
  v_mfma_f32_16x16x32_bf16 v[176:179], v[80:83], v[252:255], v[176:179]
  v_mfma_f32_16x16x32_bf16 v[148:151], v[84:87], v[248:251], v[148:151]
  v_mfma_f32_16x16x32_bf16 v[180:183], v[84:87], v[252:255], v[180:183]
  v_mfma_f32_16x16x32_bf16 v[152:155], v[88:91], v[248:251], v[152:155]
  v_mfma_f32_16x16x32_bf16 v[184:187], v[88:91], v[252:255], v[184:187]
  v_mfma_f32_16x16x32_bf16 v[156:159], v[92:95], v[248:251], v[156:159]
  v_mfma_f32_16x16x32_bf16 v[188:191], v[92:95], v[252:255], v[188:191]
  s_setprio 3
  s_load_dwordx2 s[10:11], s[0:1], 0
  s_load_dwordx2 s[12:13], s[0:1], 72
  s_lshl_b32 s16, s22, 2
  s_add_u32 s16, s16, s20
  s_lshl_b32 s16, s16, 16
  s_lshl_b32 s17, s23, 8
  s_add_u32 s42, s16, s17
  s_lshl_b32 s17, s23, 12
  s_add_u32 s43, s16, s17
  s_add_u32 s43, s43, 33554432
  s_add_u32 s44, s43, 0x8000
  s_lshl_b32 s16, s20, 14
  s_add_u32 s16, s16, 65536
  v_add_u32 v9, s16, v3
  v_subrev_u32 v26, 1024, v21
  s_mov_b32 s53, 21
  s_mov_b32 s19, 0xffff0000
  s_lshr_b32 s40, s20, 1
  v_and_b32 v2, 15, v1
  v_lshlrev_b32 v24, 11, v2
  v_bfe_u32 v2, v1, 4, 1
  v_lshl_add_u32 v24, v2, 5, v24
  v_lshrrev_b32 v2, 5, v1
  v_lshl_add_u32 v24, v2, 4, v24
  s_lshl_b32 s60, s2, 3
  s_add_u32 s60, s60, s54
  s_lshl_b32 s60, s60, 2
  s_add_u32 s60, s60, 4739072
  s_waitcnt lgkmcnt(0)
  s_mov_b32 s28, s10
  s_mov_b32 s29, s11
  s_mov_b32 s30, 0x400000
  s_mov_b32 s31, 0x20000
  s_mov_b32 s36, s12
  s_mov_b32 s37, s13
  s_mov_b32 s38, 0x400000
  s_mov_b32 s39, 0x20000
  s_cmp_lg_u32 s40, s21
  s_cbranch_scc1 DN_NX
  s_add_u32 s17, s42, 0x8000
  buffer_load_dwordx4 v[32:35], v24, s[28:31], s42 offen offset:0
  buffer_load_dwordx4 v[36:39], v24, s[28:31], s42 offen offset:64
  buffer_load_dwordx4 v[40:43], v24, s[28:31], s42 offen offset:128
  buffer_load_dwordx4 v[44:47], v24, s[28:31], s42 offen offset:192
  buffer_load_dwordx4 v[48:51], v24, s[28:31], s17 offen offset:0
  buffer_load_dwordx4 v[52:55], v24, s[28:31], s17 offen offset:64
  buffer_load_dwordx4 v[56:59], v24, s[28:31], s17 offen offset:128
  buffer_load_dwordx4 v[60:63], v24, s[28:31], s17 offen offset:192
DN_NX:
  ds_read_b32 v23, v26
  s_waitcnt lgkmcnt(0)
  v_cmp_gt_u32 vcc, s53, v23
  s_nop 0
  s_cbranch_vccz DN_AOK
  s_sleep 1
  s_branch DN_NX
DN_AOK:
  ds_read_b128 v[192:195], v9 offset:0
  ds_read_b128 v[196:199], v9 offset:1024
  ds_read_b128 v[200:203], v9 offset:2048
  ds_read_b128 v[204:207], v9 offset:3072
  ds_read_b128 v[208:211], v9 offset:4096
  ds_read_b128 v[212:215], v9 offset:5120
  ds_read_b128 v[216:219], v9 offset:6144
  ds_read_b128 v[220:223], v9 offset:7168
  ds_read_b128 v[224:227], v9 offset:8192
  ds_read_b128 v[228:231], v9 offset:9216
  ds_read_b128 v[232:235], v9 offset:10240
  ds_read_b128 v[236:239], v9 offset:11264
  ds_read_b128 v[240:243], v9 offset:12288
  ds_read_b128 v[244:247], v9 offset:13312
  ds_read_b128 v[248:251], v9 offset:14336
  ds_read_b128 v[252:255], v9 offset:15360
  s_waitcnt lgkmcnt(12)
  v_add_f32 v128, v128, v192
  v_add_f32 v129, v129, v193
  v_add_f32 v130, v130, v194
  v_add_f32 v131, v131, v195
  v_add_f32 v132, v132, v196
  v_add_f32 v133, v133, v197
  v_add_f32 v134, v134, v198
  v_add_f32 v135, v135, v199
  v_add_f32 v136, v136, v200
  v_add_f32 v137, v137, v201
  v_add_f32 v138, v138, v202
  v_add_f32 v139, v139, v203
  v_add_f32 v140, v140, v204
  v_add_f32 v141, v141, v205
  v_add_f32 v142, v142, v206
  v_add_f32 v143, v143, v207
  s_waitcnt lgkmcnt(8)
  v_add_f32 v144, v144, v208
  v_add_f32 v145, v145, v209
  v_add_f32 v146, v146, v210
  v_add_f32 v147, v147, v211
  v_add_f32 v148, v148, v212
  v_add_f32 v149, v149, v213
  v_add_f32 v150, v150, v214
  v_add_f32 v151, v151, v215
  v_add_f32 v152, v152, v216
  v_add_f32 v153, v153, v217
  v_add_f32 v154, v154, v218
  v_add_f32 v155, v155, v219
  v_add_f32 v156, v156, v220
  v_add_f32 v157, v157, v221
  v_add_f32 v158, v158, v222
  v_add_f32 v159, v159, v223
  s_waitcnt lgkmcnt(4)
  v_add_f32 v160, v160, v224
  v_add_f32 v161, v161, v225
  v_add_f32 v162, v162, v226
  v_add_f32 v163, v163, v227
  v_add_f32 v164, v164, v228
  v_add_f32 v165, v165, v229
  v_add_f32 v166, v166, v230
  v_add_f32 v167, v167, v231
  v_add_f32 v168, v168, v232
  v_add_f32 v169, v169, v233
  v_add_f32 v170, v170, v234
  v_add_f32 v171, v171, v235
  v_add_f32 v172, v172, v236
  v_add_f32 v173, v173, v237
  v_add_f32 v174, v174, v238
  v_add_f32 v175, v175, v239
  s_waitcnt lgkmcnt(0)
  v_add_f32 v176, v176, v240
  v_add_f32 v177, v177, v241
  v_add_f32 v178, v178, v242
  v_add_f32 v179, v179, v243
  v_add_f32 v180, v180, v244
  v_add_f32 v181, v181, v245
  v_add_f32 v182, v182, v246
  v_add_f32 v183, v183, v247
  v_add_f32 v184, v184, v248
  v_add_f32 v185, v185, v249
  v_add_f32 v186, v186, v250
  v_add_f32 v187, v187, v251
  v_add_f32 v188, v188, v252
  v_add_f32 v189, v189, v253
  v_add_f32 v190, v190, v254
  v_add_f32 v191, v191, v255
  s_cmp_eq_u32 s40, s21
  s_cbranch_scc1 DN_FIN
  v_cvt_pk_bf16_f32 v192, v128, v129
  v_cvt_pk_bf16_f32 v193, v130, v131
  v_cvt_pk_bf16_f32 v194, v132, v133
  v_cvt_pk_bf16_f32 v195, v134, v135
  buffer_store_dwordx4 v[192:195], v3, s[32:35], s43 offen offset:0 sc1
  v_cvt_pk_bf16_f32 v196, v136, v137
  v_cvt_pk_bf16_f32 v197, v138, v139
  v_cvt_pk_bf16_f32 v198, v140, v141
  v_cvt_pk_bf16_f32 v199, v142, v143
  buffer_store_dwordx4 v[196:199], v3, s[32:35], s43 offen offset:1024 sc1
  v_cvt_pk_bf16_f32 v200, v144, v145
  v_cvt_pk_bf16_f32 v201, v146, v147
  v_cvt_pk_bf16_f32 v202, v148, v149
  v_cvt_pk_bf16_f32 v203, v150, v151
  buffer_store_dwordx4 v[200:203], v3, s[32:35], s43 offen offset:2048 sc1
  v_cvt_pk_bf16_f32 v204, v152, v153
  v_cvt_pk_bf16_f32 v205, v154, v155
  v_cvt_pk_bf16_f32 v206, v156, v157
  v_cvt_pk_bf16_f32 v207, v158, v159
  buffer_store_dwordx4 v[204:207], v3, s[32:35], s43 offen offset:3072 sc1
  v_cvt_pk_bf16_f32 v208, v160, v161
  v_cvt_pk_bf16_f32 v209, v162, v163
  v_cvt_pk_bf16_f32 v210, v164, v165
  v_cvt_pk_bf16_f32 v211, v166, v167
  buffer_store_dwordx4 v[208:211], v3, s[32:35], s44 offen offset:0 sc1
  v_cvt_pk_bf16_f32 v212, v168, v169
  v_cvt_pk_bf16_f32 v213, v170, v171
  v_cvt_pk_bf16_f32 v214, v172, v173
  v_cvt_pk_bf16_f32 v215, v174, v175
  buffer_store_dwordx4 v[212:215], v3, s[32:35], s44 offen offset:1024 sc1
  v_cvt_pk_bf16_f32 v216, v176, v177
  v_cvt_pk_bf16_f32 v217, v178, v179
  v_cvt_pk_bf16_f32 v218, v180, v181
  v_cvt_pk_bf16_f32 v219, v182, v183
  buffer_store_dwordx4 v[216:219], v3, s[32:35], s44 offen offset:2048 sc1
  v_cvt_pk_bf16_f32 v220, v184, v185
  v_cvt_pk_bf16_f32 v221, v186, v187
  v_cvt_pk_bf16_f32 v222, v188, v189
  v_cvt_pk_bf16_f32 v223, v190, v191
  buffer_store_dwordx4 v[220:223], v3, s[32:35], s44 offen offset:3072 sc1
  s_waitcnt vmcnt(0)
  v_mov_b32 v2, s55
  v_mov_b32 v8, 0
  s_mov_b64 exec, 1
  buffer_store_dword v2, v8, s[32:35], s60 offen sc1
  s_mov_b64 exec, -1
  s_endpgm
DN_FIN:
  s_xor_b32 s18, s60, 32
  v_mov_b32 v25, 0
  s_waitcnt vmcnt(0)
  v_permlane16_swap_b32 v32, v34
  v_permlane16_swap_b32 v33, v35
  v_permlane16_swap_b32 v36, v38
  v_permlane16_swap_b32 v37, v39
  v_permlane16_swap_b32 v40, v42
  v_permlane16_swap_b32 v41, v43
  v_permlane16_swap_b32 v44, v46
  v_permlane16_swap_b32 v45, v47
  v_permlane16_swap_b32 v48, v50
  v_permlane16_swap_b32 v49, v51
  v_permlane16_swap_b32 v52, v54
  v_permlane16_swap_b32 v53, v55
  v_permlane16_swap_b32 v56, v58
  v_permlane16_swap_b32 v57, v59
  v_permlane16_swap_b32 v60, v62
  v_permlane16_swap_b32 v61, v63
  s_mov_b32 exec_lo, 0x1
  s_mov_b32 exec_hi, 0x0
  buffer_load_dword v27, v25, s[32:35], s18 offen sc1
  s_mov_b64 exec, -1
  v_lshlrev_b32 v192, 16, v32
  v_and_b32 v193, s19, v32
  v_lshlrev_b32 v194, 16, v33
  v_and_b32 v195, s19, v33
  v_lshlrev_b32 v196, 16, v34
  v_and_b32 v197, s19, v34
  v_lshlrev_b32 v198, 16, v35
  v_and_b32 v199, s19, v35
  v_lshlrev_b32 v200, 16, v36
  v_and_b32 v201, s19, v36
  v_lshlrev_b32 v202, 16, v37
  v_and_b32 v203, s19, v37
  v_lshlrev_b32 v204, 16, v38
  v_and_b32 v205, s19, v38
  v_lshlrev_b32 v206, 16, v39
  v_and_b32 v207, s19, v39
  v_lshlrev_b32 v208, 16, v40
  v_and_b32 v209, s19, v40
  v_lshlrev_b32 v210, 16, v41
  v_and_b32 v211, s19, v41
  v_lshlrev_b32 v212, 16, v42
  v_and_b32 v213, s19, v42
  v_lshlrev_b32 v214, 16, v43
  v_and_b32 v215, s19, v43
  v_lshlrev_b32 v216, 16, v44
  v_and_b32 v217, s19, v44
  v_lshlrev_b32 v218, 16, v45
  v_and_b32 v219, s19, v45
  v_lshlrev_b32 v220, 16, v46
  v_and_b32 v221, s19, v46
  v_lshlrev_b32 v222, 16, v47
  v_and_b32 v223, s19, v47
  v_lshlrev_b32 v224, 16, v48
  v_and_b32 v225, s19, v48
  v_lshlrev_b32 v226, 16, v49
  v_and_b32 v227, s19, v49
  v_lshlrev_b32 v228, 16, v50
  v_and_b32 v229, s19, v50
  v_lshlrev_b32 v230, 16, v51
  v_and_b32 v231, s19, v51
  v_lshlrev_b32 v232, 16, v52
  v_and_b32 v233, s19, v52
  v_lshlrev_b32 v234, 16, v53
  v_and_b32 v235, s19, v53
  v_lshlrev_b32 v236, 16, v54
  v_and_b32 v237, s19, v54
  v_lshlrev_b32 v238, 16, v55
  v_and_b32 v239, s19, v55
  v_lshlrev_b32 v240, 16, v56
  v_and_b32 v241, s19, v56
  v_lshlrev_b32 v242, 16, v57
  v_and_b32 v243, s19, v57
  v_lshlrev_b32 v244, 16, v58
  v_and_b32 v245, s19, v58
  v_lshlrev_b32 v246, 16, v59
  v_and_b32 v247, s19, v59
  v_lshlrev_b32 v248, 16, v60
  v_and_b32 v249, s19, v60
  v_lshlrev_b32 v250, 16, v61
  v_and_b32 v251, s19, v61
  v_lshlrev_b32 v252, 16, v62
  v_and_b32 v253, s19, v62
  v_lshlrev_b32 v254, 16, v63
  v_and_b32 v255, s19, v63
  v_add_f32 v128, v128, v192
  v_add_f32 v129, v129, v193
  v_add_f32 v130, v130, v194
  v_add_f32 v131, v131, v195
  v_add_f32 v132, v132, v196
  v_add_f32 v133, v133, v197
  v_add_f32 v134, v134, v198
  v_add_f32 v135, v135, v199
  v_add_f32 v136, v136, v200
  v_add_f32 v137, v137, v201
  v_add_f32 v138, v138, v202
  v_add_f32 v139, v139, v203
  v_add_f32 v140, v140, v204
  v_add_f32 v141, v141, v205
  v_add_f32 v142, v142, v206
  v_add_f32 v143, v143, v207
  v_add_f32 v144, v144, v208
  v_add_f32 v145, v145, v209
  v_add_f32 v146, v146, v210
  v_add_f32 v147, v147, v211
  v_add_f32 v148, v148, v212
  v_add_f32 v149, v149, v213
  v_add_f32 v150, v150, v214
  v_add_f32 v151, v151, v215
  v_add_f32 v152, v152, v216
  v_add_f32 v153, v153, v217
  v_add_f32 v154, v154, v218
  v_add_f32 v155, v155, v219
  v_add_f32 v156, v156, v220
  v_add_f32 v157, v157, v221
  v_add_f32 v158, v158, v222
  v_add_f32 v159, v159, v223
  v_add_f32 v160, v160, v224
  v_add_f32 v161, v161, v225
  v_add_f32 v162, v162, v226
  v_add_f32 v163, v163, v227
  v_add_f32 v164, v164, v228
  v_add_f32 v165, v165, v229
  v_add_f32 v166, v166, v230
  v_add_f32 v167, v167, v231
  v_add_f32 v168, v168, v232
  v_add_f32 v169, v169, v233
  v_add_f32 v170, v170, v234
  v_add_f32 v171, v171, v235
  v_add_f32 v172, v172, v236
  v_add_f32 v173, v173, v237
  v_add_f32 v174, v174, v238
  v_add_f32 v175, v175, v239
  v_add_f32 v176, v176, v240
  v_add_f32 v177, v177, v241
  v_add_f32 v178, v178, v242
  v_add_f32 v179, v179, v243
  v_add_f32 v180, v180, v244
  v_add_f32 v181, v181, v245
  v_add_f32 v182, v182, v246
  v_add_f32 v183, v183, v247
  v_add_f32 v184, v184, v248
  v_add_f32 v185, v185, v249
  v_add_f32 v186, v186, v250
  v_add_f32 v187, v187, v251
  v_add_f32 v188, v188, v252
  v_add_f32 v189, v189, v253
  v_add_f32 v190, v190, v254
  v_add_f32 v191, v191, v255
  s_mov_b32 exec_lo, 0x1
  s_mov_b32 exec_hi, 0x0
  s_waitcnt vmcnt(0)
  v_cmp_ne_u32 vcc, s55, v27
  s_nop 0
  s_cbranch_vccz POLL10_D
  s_mov_b32 s17, 0x40000
POLL10:
  buffer_load_dword v27, v25, s[32:35], s18 offen sc1
  s_waitcnt vmcnt(0)
  v_cmp_ne_u32 vcc, s55, v27
  s_nop 0
  s_cbranch_vccz POLL10_D
  s_sleep 1
  s_sub_u32 s17, s17, 1
  s_cmp_lg_u32 s17, 0
  s_cbranch_scc1 POLL10
POLL10_D:
  s_mov_b64 exec, -1
  buffer_load_dwordx4 v[64:67], v3, s[32:35], s43 offen offset:0
  buffer_load_dwordx4 v[68:71], v3, s[32:35], s43 offen offset:1024
  buffer_load_dwordx4 v[72:75], v3, s[32:35], s43 offen offset:2048
  buffer_load_dwordx4 v[76:79], v3, s[32:35], s43 offen offset:3072
  buffer_load_dwordx4 v[80:83], v3, s[32:35], s44 offen offset:0
  buffer_load_dwordx4 v[84:87], v3, s[32:35], s44 offen offset:1024
  buffer_load_dwordx4 v[88:91], v3, s[32:35], s44 offen offset:2048
  buffer_load_dwordx4 v[92:95], v3, s[32:35], s44 offen offset:3072
  s_waitcnt vmcnt(7)
  v_lshlrev_b32 v192, 16, v64
  v_and_b32 v193, s19, v64
  v_lshlrev_b32 v194, 16, v65
  v_and_b32 v195, s19, v65
  v_lshlrev_b32 v196, 16, v66
  v_and_b32 v197, s19, v66
  v_lshlrev_b32 v198, 16, v67
  v_and_b32 v199, s19, v67
  v_add_f32 v128, v128, v192
  v_add_f32 v129, v129, v193
  v_add_f32 v130, v130, v194
  v_add_f32 v131, v131, v195
  v_add_f32 v132, v132, v196
  v_add_f32 v133, v133, v197
  v_add_f32 v134, v134, v198
  v_add_f32 v135, v135, v199
  v_cvt_pk_bf16_f32 v32, v128, v129
  v_cvt_pk_bf16_f32 v33, v130, v131
  v_cvt_pk_bf16_f32 v34, v132, v133
  v_cvt_pk_bf16_f32 v35, v134, v135
  s_nop 0
  v_permlane16_swap_b32 v32, v34
  v_permlane16_swap_b32 v33, v35
  buffer_store_dwordx4 v[32:35], v24, s[36:39], s42 offen offset:0
  s_waitcnt vmcnt(7)
  v_lshlrev_b32 v192, 16, v68
  v_and_b32 v193, s19, v68
  v_lshlrev_b32 v194, 16, v69
  v_and_b32 v195, s19, v69
  v_lshlrev_b32 v196, 16, v70
  v_and_b32 v197, s19, v70
  v_lshlrev_b32 v198, 16, v71
  v_and_b32 v199, s19, v71
  v_add_f32 v136, v136, v192
  v_add_f32 v137, v137, v193
  v_add_f32 v138, v138, v194
  v_add_f32 v139, v139, v195
  v_add_f32 v140, v140, v196
  v_add_f32 v141, v141, v197
  v_add_f32 v142, v142, v198
  v_add_f32 v143, v143, v199
  v_cvt_pk_bf16_f32 v36, v136, v137
  v_cvt_pk_bf16_f32 v37, v138, v139
  v_cvt_pk_bf16_f32 v38, v140, v141
  v_cvt_pk_bf16_f32 v39, v142, v143
  s_nop 0
  v_permlane16_swap_b32 v36, v38
  v_permlane16_swap_b32 v37, v39
  buffer_store_dwordx4 v[36:39], v24, s[36:39], s42 offen offset:64
  s_waitcnt vmcnt(7)
  v_lshlrev_b32 v192, 16, v72
  v_and_b32 v193, s19, v72
  v_lshlrev_b32 v194, 16, v73
  v_and_b32 v195, s19, v73
  v_lshlrev_b32 v196, 16, v74
  v_and_b32 v197, s19, v74
  v_lshlrev_b32 v198, 16, v75
  v_and_b32 v199, s19, v75
  v_add_f32 v144, v144, v192
  v_add_f32 v145, v145, v193
  v_add_f32 v146, v146, v194
  v_add_f32 v147, v147, v195
  v_add_f32 v148, v148, v196
  v_add_f32 v149, v149, v197
  v_add_f32 v150, v150, v198
  v_add_f32 v151, v151, v199
  v_cvt_pk_bf16_f32 v40, v144, v145
  v_cvt_pk_bf16_f32 v41, v146, v147
  v_cvt_pk_bf16_f32 v42, v148, v149
  v_cvt_pk_bf16_f32 v43, v150, v151
  s_nop 0
  v_permlane16_swap_b32 v40, v42
  v_permlane16_swap_b32 v41, v43
  buffer_store_dwordx4 v[40:43], v24, s[36:39], s42 offen offset:128
  s_waitcnt vmcnt(7)
  v_lshlrev_b32 v192, 16, v76
  v_and_b32 v193, s19, v76
  v_lshlrev_b32 v194, 16, v77
  v_and_b32 v195, s19, v77
  v_lshlrev_b32 v196, 16, v78
  v_and_b32 v197, s19, v78
  v_lshlrev_b32 v198, 16, v79
  v_and_b32 v199, s19, v79
  v_add_f32 v152, v152, v192
  v_add_f32 v153, v153, v193
  v_add_f32 v154, v154, v194
  v_add_f32 v155, v155, v195
  v_add_f32 v156, v156, v196
  v_add_f32 v157, v157, v197
  v_add_f32 v158, v158, v198
  v_add_f32 v159, v159, v199
  v_cvt_pk_bf16_f32 v44, v152, v153
  v_cvt_pk_bf16_f32 v45, v154, v155
  v_cvt_pk_bf16_f32 v46, v156, v157
  v_cvt_pk_bf16_f32 v47, v158, v159
  s_nop 0
  v_permlane16_swap_b32 v44, v46
  v_permlane16_swap_b32 v45, v47
  buffer_store_dwordx4 v[44:47], v24, s[36:39], s42 offen offset:192
  s_add_u32 s42, s42, 0x8000
  s_waitcnt vmcnt(7)
  v_lshlrev_b32 v192, 16, v80
  v_and_b32 v193, s19, v80
  v_lshlrev_b32 v194, 16, v81
  v_and_b32 v195, s19, v81
  v_lshlrev_b32 v196, 16, v82
  v_and_b32 v197, s19, v82
  v_lshlrev_b32 v198, 16, v83
  v_and_b32 v199, s19, v83
  v_add_f32 v160, v160, v192
  v_add_f32 v161, v161, v193
  v_add_f32 v162, v162, v194
  v_add_f32 v163, v163, v195
  v_add_f32 v164, v164, v196
  v_add_f32 v165, v165, v197
  v_add_f32 v166, v166, v198
  v_add_f32 v167, v167, v199
  v_cvt_pk_bf16_f32 v48, v160, v161
  v_cvt_pk_bf16_f32 v49, v162, v163
  v_cvt_pk_bf16_f32 v50, v164, v165
  v_cvt_pk_bf16_f32 v51, v166, v167
  s_nop 0
  v_permlane16_swap_b32 v48, v50
  v_permlane16_swap_b32 v49, v51
  buffer_store_dwordx4 v[48:51], v24, s[36:39], s42 offen offset:0
  s_waitcnt vmcnt(7)
  v_lshlrev_b32 v192, 16, v84
  v_and_b32 v193, s19, v84
  v_lshlrev_b32 v194, 16, v85
  v_and_b32 v195, s19, v85
  v_lshlrev_b32 v196, 16, v86
  v_and_b32 v197, s19, v86
  v_lshlrev_b32 v198, 16, v87
  v_and_b32 v199, s19, v87
  v_add_f32 v168, v168, v192
  v_add_f32 v169, v169, v193
  v_add_f32 v170, v170, v194
  v_add_f32 v171, v171, v195
  v_add_f32 v172, v172, v196
  v_add_f32 v173, v173, v197
  v_add_f32 v174, v174, v198
  v_add_f32 v175, v175, v199
  v_cvt_pk_bf16_f32 v52, v168, v169
  v_cvt_pk_bf16_f32 v53, v170, v171
  v_cvt_pk_bf16_f32 v54, v172, v173
  v_cvt_pk_bf16_f32 v55, v174, v175
  s_nop 0
  v_permlane16_swap_b32 v52, v54
  v_permlane16_swap_b32 v53, v55
  buffer_store_dwordx4 v[52:55], v24, s[36:39], s42 offen offset:64
  s_waitcnt vmcnt(7)
  v_lshlrev_b32 v192, 16, v88
  v_and_b32 v193, s19, v88
  v_lshlrev_b32 v194, 16, v89
  v_and_b32 v195, s19, v89
  v_lshlrev_b32 v196, 16, v90
  v_and_b32 v197, s19, v90
  v_lshlrev_b32 v198, 16, v91
  v_and_b32 v199, s19, v91
  v_add_f32 v176, v176, v192
  v_add_f32 v177, v177, v193
  v_add_f32 v178, v178, v194
  v_add_f32 v179, v179, v195
  v_add_f32 v180, v180, v196
  v_add_f32 v181, v181, v197
  v_add_f32 v182, v182, v198
  v_add_f32 v183, v183, v199
  v_cvt_pk_bf16_f32 v56, v176, v177
  v_cvt_pk_bf16_f32 v57, v178, v179
  v_cvt_pk_bf16_f32 v58, v180, v181
  v_cvt_pk_bf16_f32 v59, v182, v183
  s_nop 0
  v_permlane16_swap_b32 v56, v58
  v_permlane16_swap_b32 v57, v59
  buffer_store_dwordx4 v[56:59], v24, s[36:39], s42 offen offset:128
  s_waitcnt vmcnt(7)
  v_lshlrev_b32 v192, 16, v92
  v_and_b32 v193, s19, v92
  v_lshlrev_b32 v194, 16, v93
  v_and_b32 v195, s19, v93
  v_lshlrev_b32 v196, 16, v94
  v_and_b32 v197, s19, v94
  v_lshlrev_b32 v198, 16, v95
  v_and_b32 v199, s19, v95
  v_add_f32 v184, v184, v192
  v_add_f32 v185, v185, v193
  v_add_f32 v186, v186, v194
  v_add_f32 v187, v187, v195
  v_add_f32 v188, v188, v196
  v_add_f32 v189, v189, v197
  v_add_f32 v190, v190, v198
  v_add_f32 v191, v191, v199
  v_cvt_pk_bf16_f32 v60, v184, v185
  v_cvt_pk_bf16_f32 v61, v186, v187
  v_cvt_pk_bf16_f32 v62, v188, v189
  v_cvt_pk_bf16_f32 v63, v190, v191
  s_nop 0
  v_permlane16_swap_b32 v60, v62
  v_permlane16_swap_b32 v61, v63
  buffer_store_dwordx4 v[60:63], v24, s[36:39], s42 offen offset:192
  s_endpgm
DN_OS:
  s_mov_b32 exec_lo, 0xff
  s_mov_b32 exec_hi, 0x0
  s_mov_b32 s17, 0x40000
POLL11:
  buffer_load_dword v29, v28, s[32:35], s43 offen sc1
  s_waitcnt vmcnt(0)
  v_cmp_ne_u32 vcc, s55, v29
  s_nop 0
  s_cbranch_vccz POLL11_D
  s_sleep 2
  s_sub_u32 s17, s17, 1
  s_cmp_lg_u32 s17, 0
  s_cbranch_scc1 POLL11
POLL11_D:
  s_mov_b64 exec, -1
  s_branch DN_OC
DN_FS0:
  s_mov_b32 s17, 0x40000
DN_FL0:
  buffer_load_dword v24, v9, s[32:35], s18 offen sc1
  s_waitcnt vmcnt(0)
  v_cmp_ne_u32 vcc, s55, v24
  s_nop 0
  s_and_b64 vcc, vcc, s[28:29]
  s_cbranch_scc0 DN_FC0
  s_sleep 2
  s_sub_u32 s17, s17, 1
  s_cmp_lg_u32 s17, 0
  s_cbranch_scc1 DN_FL0
  s_branch DN_FC0
DN_SP0:
  ds_read_b32 v23, v21
  s_waitcnt lgkmcnt(0)
  v_add_u32 v23, 1, v23
  v_cmp_gt_i32 vcc, s53, v23
  s_nop 0
  s_cbranch_vccnz DN_SP0
  s_branch DN_CT0
DN_SP1:
  ds_read_b32 v23, v21
  s_waitcnt lgkmcnt(0)
  v_add_u32 v23, 1, v23
  v_cmp_gt_i32 vcc, s53, v23
  s_nop 0
  s_cbranch_vccnz DN_SP1
  s_branch DN_CT1
DN_SP2:
  ds_read_b32 v23, v21
  s_waitcnt lgkmcnt(0)
  v_add_u32 v23, 1, v23
  v_cmp_gt_i32 vcc, s53, v23
  s_nop 0
  s_cbranch_vccnz DN_SP2
  s_branch DN_CT2
DN_SP3:
  ds_read_b32 v23, v21
  s_waitcnt lgkmcnt(0)
  v_add_u32 v23, 1, v23
  v_cmp_gt_i32 vcc, s53, v23
  s_nop 0
  s_cbranch_vccnz DN_SP3
  s_branch DN_CT3
DN_SP4:
  ds_read_b32 v23, v21
  s_waitcnt lgkmcnt(0)
  v_add_u32 v23, 1, v23
  v_cmp_gt_i32 vcc, s53, v23
  s_nop 0
  s_cbranch_vccnz DN_SP4
  s_branch DN_CT4
DN_SP5:
  ds_read_b32 v23, v21
  s_waitcnt lgkmcnt(0)
  v_add_u32 v23, 1, v23
  v_cmp_gt_i32 vcc, s53, v23
  s_nop 0
  s_cbranch_vccnz DN_SP5
  s_branch DN_CT5
DN_SP6:
  ds_read_b32 v23, v21
  s_waitcnt lgkmcnt(0)
  v_add_u32 v23, 1, v23
  v_cmp_gt_i32 vcc, s53, v23
  s_nop 0
  s_cbranch_vccnz DN_SP6
  s_branch DN_CT6
DN_SP7:
  ds_read_b32 v23, v21
  s_waitcnt lgkmcnt(0)
  v_add_u32 v23, 1, v23
  v_cmp_gt_i32 vcc, s53, v23
  s_nop 0
  s_cbranch_vccnz DN_SP7
  s_branch DN_CT7
DN_FS8:
  s_mov_b32 s17, 0x40000
DN_FL8:
  buffer_load_dword v24, v9, s[32:35], s18 offen sc1
  s_waitcnt vmcnt(0)
  v_cmp_ne_u32 vcc, s55, v24
  s_nop 0
  s_and_b64 vcc, vcc, s[28:29]
  s_cbranch_scc0 DN_FC8
  s_sleep 2
  s_sub_u32 s17, s17, 1
  s_cmp_lg_u32 s17, 0
  s_cbranch_scc1 DN_FL8
  s_branch DN_FC8
DN_SP8:
  ds_read_b32 v23, v21
  s_waitcnt lgkmcnt(0)
  v_add_u32 v23, 1, v23
  v_cmp_gt_i32 vcc, s53, v23
  s_nop 0
  s_cbranch_vccnz DN_SP8
  s_branch DN_CT8
DN_SP9:
  ds_read_b32 v23, v21
  s_waitcnt lgkmcnt(0)
  v_add_u32 v23, 1, v23
  v_cmp_gt_i32 vcc, s53, v23
  s_nop 0
  s_cbranch_vccnz DN_SP9
  s_branch DN_CT9
DN_SP10:
  ds_read_b32 v23, v21
  s_waitcnt lgkmcnt(0)
  v_add_u32 v23, 1, v23
  v_cmp_gt_i32 vcc, s53, v23
  s_nop 0
  s_cbranch_vccnz DN_SP10
  s_branch DN_CT10
DN_SP43:
  ds_read_b32 v23, v21
  s_waitcnt lgkmcnt(0)
  v_add_u32 v23, 1, v23
  v_cmp_gt_i32 vcc, s53, v23
  s_nop 0
  s_cbranch_vccnz DN_SP43
  s_branch DN_CT43
DN_SP44:
  ds_read_b32 v23, v21
  s_waitcnt lgkmcnt(0)
  v_add_u32 v23, 1, v23
  v_cmp_gt_i32 vcc, s53, v23
  s_nop 0
  s_cbranch_vccnz DN_SP44
  s_branch DN_CT44
DN_SP45:
  ds_read_b32 v23, v21
  s_waitcnt lgkmcnt(0)
  v_add_u32 v23, 1, v23
  v_cmp_gt_i32 vcc, s53, v23
  s_nop 0
  s_cbranch_vccnz DN_SP45
  s_branch DN_CT45
DN_SP46:
  ds_read_b32 v23, v21
  s_waitcnt lgkmcnt(0)
  v_add_u32 v23, 1, v23
  v_cmp_gt_i32 vcc, s53, v23
  s_nop 0
  s_cbranch_vccnz DN_SP46
  s_branch DN_CT46
DN_SP47:
  ds_read_b32 v23, v21
  s_waitcnt lgkmcnt(0)
  v_add_u32 v23, 1, v23
  v_cmp_gt_i32 vcc, s53, v23
  s_nop 0
  s_cbranch_vccnz DN_SP47
  s_branch DN_CT47
DN_SP48:
  ds_read_b32 v23, v21
  s_waitcnt lgkmcnt(0)
  v_add_u32 v23, 1, v23
  v_cmp_gt_i32 vcc, s53, v23
  s_nop 0
  s_cbranch_vccnz DN_SP48
  s_branch DN_CT48
DN_SP49:
  ds_read_b32 v23, v21
  s_waitcnt lgkmcnt(0)
  v_add_u32 v23, 1, v23
  v_cmp_gt_i32 vcc, s53, v23
  s_nop 0
  s_cbranch_vccnz DN_SP49
  s_branch DN_CT49
DN_SP50:
  ds_read_b32 v23, v21
  s_waitcnt lgkmcnt(0)
  v_add_u32 v23, 1, v23
  v_cmp_gt_i32 vcc, s53, v23
  s_nop 0
  s_cbranch_vccnz DN_SP50
  s_branch DN_CT50
DN_SP51:
  ds_read_b32 v23, v21
  s_waitcnt lgkmcnt(0)
  v_add_u32 v23, 1, v23
  v_cmp_gt_i32 vcc, s53, v23
  s_nop 0
  s_cbranch_vccnz DN_SP51
  s_branch DN_CT51
DN_SP52:
  ds_read_b32 v23, v21
  s_waitcnt lgkmcnt(0)
  v_add_u32 v23, 1, v23
  v_cmp_gt_i32 vcc, s53, v23
  s_nop 0
  s_cbranch_vccnz DN_SP52
  s_branch DN_CT52
DN_SP53:
  ds_read_b32 v23, v21
  s_waitcnt lgkmcnt(0)
  v_add_u32 v23, 1, v23
  v_cmp_gt_i32 vcc, s53, v23
  s_nop 0
  s_cbranch_vccnz DN_SP53
  s_branch DN_CT53
DN_SP54:
  ds_read_b32 v23, v21
  s_waitcnt lgkmcnt(0)
  v_add_u32 v23, 1, v23
  v_cmp_gt_i32 vcc, s53, v23
  s_nop 0
  s_cbranch_vccnz DN_SP54
  s_branch DN_CT54
DN_SP55:
  ds_read_b32 v23, v21
  s_waitcnt lgkmcnt(0)
  v_add_u32 v23, 1, v23
  v_cmp_gt_i32 vcc, s53, v23
  s_nop 0
  s_cbranch_vccnz DN_SP55
  s_branch DN_CT55
DN_SP56:
  ds_read_b32 v23, v21
  s_waitcnt lgkmcnt(0)
  v_add_u32 v23, 1, v23
  v_cmp_gt_i32 vcc, s53, v23
  s_nop 0
  s_cbranch_vccnz DN_SP56
  s_branch DN_CT56
DN_SP57:
  ds_read_b32 v23, v21
  s_waitcnt lgkmcnt(0)
  v_add_u32 v23, 1, v23
  v_cmp_gt_i32 vcc, s53, v23
  s_nop 0
  s_cbranch_vccnz DN_SP57
  s_branch DN_CT57
DN_SP58:
  ds_read_b32 v23, v21
  s_waitcnt lgkmcnt(0)
  v_add_u32 v23, 1, v23
  v_cmp_gt_i32 vcc, s53, v23
  s_nop 0
  s_cbranch_vccnz DN_SP58
  s_branch DN_CT58
DN_SP59:
  ds_read_b32 v23, v21
  s_waitcnt lgkmcnt(0)
  v_add_u32 v23, 1, v23
  v_cmp_gt_i32 vcc, s53, v23
  s_nop 0
  s_cbranch_vccnz DN_SP59
  s_branch DN_CT59
DN_SP60:
  ds_read_b32 v23, v21
  s_waitcnt lgkmcnt(0)
  v_add_u32 v23, 1, v23
  v_cmp_gt_i32 vcc, s53, v23
  s_nop 0
  s_cbranch_vccnz DN_SP60
  s_branch DN_CT60
DN_SP61:
  ds_read_b32 v23, v21
  s_waitcnt lgkmcnt(0)
  v_add_u32 v23, 1, v23
  v_cmp_gt_i32 vcc, s53, v23
  s_nop 0
  s_cbranch_vccnz DN_SP61
  s_branch DN_CT61
DN_SP62:
  ds_read_b32 v23, v21
  s_waitcnt lgkmcnt(0)
  v_add_u32 v23, 1, v23
  v_cmp_gt_i32 vcc, s53, v23
  s_nop 0
  s_cbranch_vccnz DN_SP62
  s_branch DN_CT62
F_END:
  s_endpgm
.section .rodata,"a"
.p2align 6
.amdhsa_kernel parallel_sum__grouped_kv_mqa__glu_gated_reglu__prompt_kernel
  .amdhsa_next_free_vgpr 256
  .amdhsa_next_free_sgpr 102
  .amdhsa_accum_offset 256
  .amdhsa_group_segment_fixed_size 0
  .amdhsa_kernarg_size 96
  .amdhsa_user_sgpr_count 2
  .amdhsa_user_sgpr_kernarg_segment_ptr 1
  .amdhsa_system_sgpr_workgroup_id_x 1
.end_amdhsa_kernel
```
